```python
import torch

def _softmax(x, axis=-1):
    return torch.softmax(x, dim=axis)

def _gelu(x):
    return torch.nn.functional.gelu(x, approximate='tanh')

def _silu(x):
    return torch.nn.functional.silu(x)

def _sigmoid(x):
    return torch.sigmoid(x)

def _layernorm(x, axis=-1, eps=1e-05):
    m = x.mean(dim=axis, keepdim=True)
    v = x.var(dim=axis, keepdim=True, unbiased=False)
    return (x - m) / torch.sqrt(v + eps)

def _scatter_add(tgt, idx, src, axis=0):
    return tgt.clone().index_add_(axis, idx, src)

def _segment_sum(src, seg, n):
    out = torch.zeros((n,) + src.shape[1:], dtype=src.dtype)
    return out.index_add_(0, seg, src)

def _pad(x, pw):
    flat = tuple((v for pair in reversed(pw) for v in pair))
    return torch.nn.functional.pad(x, flat)
kernel_name = 'recurrent_scan__ssm_conv_s4d__mixer_gmlp__prompt'

def setup_inputs():

    _w = lambda a: (lambda t: t.to(torch.bfloat16) if t.is_floating_point() else t)(torch.as_tensor(a))

    def _A_setup():
        Bsz, L, D, N = (1, 2048, 448, 256)
        return {'u': _w((lambda *s: torch.randn(*s, dtype=torch.bfloat16) * 0.05)(Bsz, L, D)), 'log_A_real': _w((lambda *s: torch.randn(*s, dtype=torch.bfloat16) * 6.4)(D, N) * 0.5), 'A_imag': _w((lambda *s: torch.randn(*s, dtype=torch.bfloat16) * 0.05)(D, N) * 3.14), 'C_real': _w((lambda *s: torch.randn(*s, dtype=torch.bfloat16) * 0.05)(D, N) / N ** 0.5), 'C_imag': _w((lambda *s: torch.randn(*s, dtype=torch.bfloat16) * 0.05)(D, N) / N ** 0.5), 'log_dt': _w((lambda *s: torch.randn(*s, dtype=torch.bfloat16) * 0.05)(D) * 0.5 - 4.0), 'D_skip': _w((lambda *s: torch.randn(*s, dtype=torch.bfloat16) * 0.05)(D))}
    _A_in = _A_setup()

    def _B_setup():
        B, S, D, F = (1, 2048, 448, 1792)
        Fh = F // 2
        return {'x': _w((lambda *s: torch.randn(*s, dtype=torch.bfloat16) * 0.05)(B, S, D)), 'w_in': _w((lambda *s: torch.randn(*s, dtype=torch.bfloat16) * 0.4)(D, 2 * Fh)), 'w_sp': _w(0.01 * (lambda *s: torch.randn(*s, dtype=torch.bfloat16) * 0.4)(S, S)), 'b_sp': _w(1.0 + 0.01 * (lambda *s: torch.randn(*s, dtype=torch.bfloat16) * 0.05)(S)), 'w_out': _w((lambda *s: torch.randn(*s, dtype=torch.bfloat16) * 0.05)(Fh, D))}
    _B_in = _B_setup()
    return {'A_u': _A_in['u'], 'A_log_A_real': _A_in['log_A_real'], 'A_A_imag': _A_in['A_imag'], 'A_C_real': _A_in['C_real'], 'A_C_imag': _A_in['C_imag'], 'A_log_dt': _A_in['log_dt'], 'A_D_skip': _A_in['D_skip'], 'B_x': _B_in['x'], 'B_w_in': _B_in['w_in'], 'B_w_sp': _B_in['w_sp'], 'B_b_sp': _B_in['b_sp'], 'B_w_out': _B_in['w_out']}

def reference(A_u, A_log_A_real, A_A_imag, A_C_real, A_C_imag, A_log_dt, A_D_skip, B_x, B_w_in, B_w_sp, B_b_sp, B_w_out):

    def _A_ref(u, log_A_real, A_imag, C_real, C_imag, log_dt, D_skip):
        L = u.shape[1]
        dt = torch.exp(log_dt)
        A = -torch.exp(log_A_real) + 1j * A_imag
        C = (C_real + 1j * C_imag) * dt[:, None]
        pos = (lambda x, dt: x.to(dt))(torch.arange(L), log_dt.dtype)
        P = torch.exp((A * dt[:, None])[:, :, None] * pos[None, None, :])
        K = 2.0 * torch.einsum('dn,dnl->dl', C, P).real
        L2 = 2 * L
        u_t = (lambda x, *d: x.permute(*d))(u, 0, 2, 1)
        Kf = (lambda x, *a, **k: torch.fft.rfft(x.float(), *a, **k))(K, L2)
        Uf = (lambda x, *a, **k: torch.fft.rfft(x.float(), *a, **k))(u_t, L2)
        y = (lambda x, *a, **k: torch.fft.irfft(x, *a, **k).to(torch.bfloat16))(Uf * Kf[None, :, :], L2)[:, :, :L]
        y = (lambda x, *d: x.permute(*d))(y, 0, 2, 1)
        return y + u * D_skip[None, None, :]

    def _B_ref(x, w_in, w_sp, b_sp, w_out):
        B, S, D = x.shape
        F = w_in.shape[-1]
        Fh = F // 2
        z = _gelu(torch.einsum('bsd,df->bsf', x, w_in))
        z1 = z[..., :Fh].clone()
        z2 = _layernorm(z[..., Fh:], axis=-1)
        g = torch.einsum('ts,bsf->btf', w_sp, z2) + b_sp[None, :, None]
        return torch.einsum('bsf,fd->bsd', z1 * g, w_out)
    x = A_u
    xn = _layernorm(x, axis=-1)
    s = _A_ref(xn, A_log_A_real, A_A_imag, A_C_real, A_C_imag, A_log_dt, A_D_skip)
    g = _silu(_B_ref(xn, B_w_in, B_w_sp, B_b_sp, B_w_out))
    return x + s * g
```

```asm
; @launch grid=(256,1,1) block=(256,1,1) lds=163840
.amdgcn_target "amdgcn-amd-amdhsa--gfx950"
.text
.globl recurrent_scan__ssm_conv_s4d__mixer_gmlp__prompt_kernel
.p2align 12
.fill 768, 4, 0xbf810000
.p2align 8
.type recurrent_scan__ssm_conv_s4d__mixer_gmlp__prompt_kernel,@function
recurrent_scan__ssm_conv_s4d__mixer_gmlp__prompt_kernel:
    s_cmp_ge_u32 s2, 256
    s_cbranch_scc1 L_exit
    s_load_dwordx16 s[64:79], s[0:1], 0
    s_load_dwordx8 s[80:87], s[0:1], 64
    s_load_dwordx4 s[88:91], s[0:1], 96
    s_load_dwordx2 s[92:93], s[0:1], 112
    s_memrealtime s[100:101]
    s_getpc_b64 s[56:57]
    s_and_b32 s56, s56, 0xffffff00
    s_mov_b32 s58, 38160
    s_mov_b32 s59, 0x20000
    s_lshr_b32 s61, s2, 3
    s_lshl_b32 s60, s61, 11
    v_lshl_add_u32 v88, v0, 3, s60
    buffer_load_dwordx2 v[212:213], v88, s[56:59], 0 offen
    v_lshrrev_b32 v89, 6, v0
    v_and_b32 v1, 63, v0
    v_readfirstlane_b32 s3, v89
    s_and_b32 s60, s2, 7
    s_sub_u32 s62, s61, 4
    s_cmp_ge_u32 s61, 28
    s_cselect_b32 s62, s62, s61
    s_mul_i32 s63, s60, 28
    s_add_u32 s46, s63, s62
    s_lshl_b32 s62, s46, 10
    v_lshl_add_u32 v90, v0, 2, s62
    v_xor_b32 v91, 256, v90
    v_lshrrev_b32 v92, 7, v0
    s_lshl_b32 s62, s46, 2
    v_lshl_add_u32 v92, v92, 1, s62
    s_and_b32 s63, s61, 3
    s_lshl2_add_u32 s4, s60, s63
    s_lshr_b32 s5, s61, 2
    s_and_b32 s62, s5, 3
    s_lshr_b32 s7, s5, 2
    s_lshl1_add_u32 s62, s62, s7
    s_lshr_b32 s7, s5, 1
    s_add_u32 s7, s7, s63
    s_and_b32 s7, s7, 3
    s_and_b32 s63, s5, 1
    s_lshl2_add_u32 s7, s63, s7
    s_and_b32 s63, s4, 7
    s_add_u32 s6, s62, s63
    s_sub_u32 s62, s6, 7
    s_min_u32 s6, s6, s62
    s_sub_u32 s62, s6, 7
    s_min_u32 s6, s6, s62
    s_lshl_b32 s7, s7, 1
    v_lshrrev_b32 v93, 3, v1
    v_lshrrev_b32 v94, 4, v1
    v_and_b32 v95, 7, v1
    v_xor_b32 v94, v94, v95
    v_lshl_add_u32 v93, v89, 4, v93
    v_mul_u32_u24 v2, 896, v93
    v_lshl_add_u32 v2, v94, 4, v2
    v_xor_b32 v3, 64, v2
    v_add_u32 v3, 6144, v3
    s_mul_i32 s53, s4, 57344
    s_add_u32 s96, s53, 896
    s_lshl_b32 s62, s6, 7
    s_add_u32 s52, s53, s62
    s_mul_i32 s44, s3, 14336
    s_lshl3_add_u32 s97, s4, s5
    s_mov_b32 s10, 1835008
    s_mov_b32 s11, 0x20000
    s_mov_b32 s26, 268435456
    s_mov_b32 s27, 0x20000
    v_lshlrev_b32 v233, 4, v1
    s_waitcnt lgkmcnt(0)
    s_mov_b64 s[8:9], s[64:65]
    s_mov_b64 s[24:25], s[92:93]
    global_load_dword v104, v90, s[66:67] nt
    global_load_dword v105, v90, s[68:69] nt
    global_load_dword v106, v90, s[70:71] nt
    global_load_dword v107, v90, s[72:73] nt
    global_load_dword v108, v91, s[70:71] nt
    global_load_dword v109, v91, s[72:73] nt
    global_load_ushort v110, v92, s[74:75]
    s_add_u32 m0, s44, 0
    global_load_ushort v111, v92, s[76:77]
    buffer_load_dwordx4 v2, s[8:11], s52 offen  lds
    buffer_load_dwordx4 v3, s[8:11], s52 offen offset:1024  lds
    s_add_u32 s52, s52, 128
    s_cmp_eq_u32 s52, s96
    s_cselect_b32 s52, s53, s52
    s_add_u32 m0, s44, 2048
    s_nop 0
    buffer_load_dwordx4 v2, s[8:11], s52 offen  lds
    buffer_load_dwordx4 v3, s[8:11], s52 offen offset:1024  lds
    s_add_u32 s52, s52, 128
    s_cmp_eq_u32 s52, s96
    s_cselect_b32 s52, s53, s52
    s_mov_b64 s[12:13], s[80:81]
    s_mov_b32 s14, 1605632
    s_mov_b32 s15, 0x20000
    s_mov_b64 s[32:33], s[90:91]
    s_mov_b32 s34, 256
    s_mov_b32 s35, 0x20000
    s_or_b32 s56, s2, s3
    s_cbranch_scc1 L_notag
    s_or_b32 s100, s100, 1
    s_bitset1_b32 s101, 31
    v_mov_b32 v214, 0
    v_mov_b32 v216, s100
    v_mov_b32 v217, s101
    s_mov_b64 exec, 1
    buffer_store_dwordx2 v[216:217], v214, s[32:35], 0 offen sc1
    s_mov_b64 exec, -1
L_notag:
    v_min_u32 v206, 12, v1
    v_lshlrev_b32 v206, 7, v206
    s_lshr_b32 s90, s2, 1
    s_mul_i32 s90, s90, 12544
    s_and_b32 s91, s2, 1
    s_mul_i32 s91, s91, 896
    s_add_u32 s90, s90, s91
    v_lshrrev_b32 v206, 2, v0
    v_lshrrev_b32 v207, 3, v206
    v_min_u32 v207, 6, v207
    v_mul_u32_u24 v207, 1792, v207
    v_and_b32 v206, 7, v206
    v_min_u32 v206, 6, v206
    v_lshl_add_u32 v206, v206, 7, v207
    buffer_load_dword v229, v206, s[12:15], s90 offen
    s_mov_b64 s[16:17], s[82:83]
    s_mov_b32 s18, 8388608
    s_mov_b32 s19, 0x20000
    v_lshrrev_b32 v91, 3, v1
    v_lshlrev_b32 v91, 12, v91
    v_lshl_add_u32 v224, v94, 4, v91
    v_xor_b32 v225, 64, v224
    v_add_u32 v225, 31744, v225
    s_lshl_b32 s94, s4, 18
    s_mul_i32 s56, s3, 66560
    s_add_u32 s94, s94, s56
    s_mov_b64 s[20:21], s[86:87]
    s_mov_b32 s22, 802816
    s_mov_b32 s23, 0x20000
    s_mov_b64 s[28:29], s[88:89]
    s_mov_b32 s30, 1835008
    s_mov_b32 s31, 0x20000
    s_mov_b32 s54, 0xffff0000
    s_mov_b32 s55, 0x3f803f80
    s_lshl_b32 s97, s97, 7
    s_lshl2_add_u32 s97, s3, s97
    s_and_b32 s56, s61, 3
    s_lshl2_add_u32 s48, s60, s56
    s_lshr_b32 s49, s61, 2
    s_lshl3_add_u32 s47, s48, s49
    s_mul_i32 s45, s3, 7168
    s_add_u32 s45, s45, 57344
    s_lshl_b32 s56, s4, 7
    s_lshl_b32 s57, s3, 5
    s_add_u32 s56, s56, s57
    v_and_b32 v88, 15, v1
    v_lshl_add_u32 v90, v88, 1, s56
    global_load_ushort v232, v90, s[84:85]
    s_mul_i32 s60, s5, 224
    s_xor_b32 s61, s5, 1
    s_mul_i32 s61, s61, 224
    s_add_u32 s61, s61, 1792
    s_and_b32 s62, s3, 1
    s_mul_i32 s62, s62, 114688
    s_add_u32 s60, s60, s62
    s_add_u32 s61, s61, s62
    s_lshr_b32 s62, s3, 1
    s_add_u32 s62, s62, s6
    s_add_u32 s56, s62, 0
    s_sub_u32 s57, s56, 7
    s_min_u32 s56, s56, s57
    s_mul_i32 s56, s56, 229376
    s_add_u32 s36, s56, s61
    s_add_u32 s40, s56, s60
    s_add_u32 s56, s62, 2
    s_sub_u32 s57, s56, 7
    s_min_u32 s56, s56, s57
    s_mul_i32 s56, s56, 229376
    s_add_u32 s37, s56, s61
    s_add_u32 s41, s56, s60
    s_add_u32 s56, s62, 4
    s_sub_u32 s57, s56, 7
    s_min_u32 s56, s56, s57
    s_mul_i32 s56, s56, 229376
    s_add_u32 s38, s56, s61
    s_add_u32 s42, s56, s60
    s_add_u32 s56, s62, 5
    s_sub_u32 s57, s56, 7
    s_min_u32 s56, s56, s57
    s_mul_i32 s56, s56, 229376
    s_add_u32 s39, s56, s61
    s_add_u32 s56, s62, 6
    s_sub_u32 s57, s56, 7
    s_min_u32 s56, s56, s57
    s_mul_i32 s56, s56, 229376
    s_add_u32 s43, s56, s60
    v_add_u32 v96, 0, v1
    v_mul_u32_u24 v97, 4682, v96
    v_lshrrev_b32 v97, 16, v97
    v_mul_u32_u24 v98, 14, v97
    v_sub_u32 v98, v96, v98
    v_and_b32 v99, 7, v97
    v_and_b32 v100, 8, v97
    v_lshl_or_b32 v99, v100, 1, v99
    v_and_b32 v100, 16, v97
    v_lshrrev_b32 v100, 1, v100
    v_or_b32 v99, v99, v100
    v_mul_u32_u24 v99, 3584, v99
    v_lshl_add_u32 v6, v98, 4, v99
    v_add_u32 v96, 64, v1
    v_mul_u32_u24 v97, 4682, v96
    v_lshrrev_b32 v97, 16, v97
    v_mul_u32_u24 v98, 14, v97
    v_sub_u32 v98, v96, v98
    v_and_b32 v99, 7, v97
    v_and_b32 v100, 8, v97
    v_lshl_or_b32 v99, v100, 1, v99
    v_and_b32 v100, 16, v97
    v_lshrrev_b32 v100, 1, v100
    v_or_b32 v99, v99, v100
    v_mul_u32_u24 v99, 3584, v99
    v_lshl_add_u32 v7, v98, 4, v99
    v_subrev_u32 v7, 1024, v7
    v_add_u32 v96, 128, v1
    v_mul_u32_u24 v97, 4682, v96
    v_lshrrev_b32 v97, 16, v97
    v_mul_u32_u24 v98, 14, v97
    v_sub_u32 v98, v96, v98
    v_and_b32 v99, 7, v97
    v_and_b32 v100, 8, v97
    v_lshl_or_b32 v99, v100, 1, v99
    v_and_b32 v100, 16, v97
    v_lshrrev_b32 v100, 1, v100
    v_or_b32 v99, v99, v100
    v_mul_u32_u24 v99, 3584, v99
    v_lshl_add_u32 v8, v98, 4, v99
    v_subrev_u32 v8, 2048, v8
    v_add_u32 v96, 192, v1
    v_mul_u32_u24 v97, 4682, v96
    v_lshrrev_b32 v97, 16, v97
    v_mul_u32_u24 v98, 14, v97
    v_sub_u32 v98, v96, v98
    v_and_b32 v99, 7, v97
    v_and_b32 v100, 8, v97
    v_lshl_or_b32 v99, v100, 1, v99
    v_and_b32 v100, 16, v97
    v_lshrrev_b32 v100, 1, v100
    v_or_b32 v99, v99, v100
    v_mul_u32_u24 v99, 3584, v99
    v_lshl_add_u32 v9, v98, 4, v99
    v_subrev_u32 v9, 3072, v9
    v_add_u32 v96, 256, v1
    v_mul_u32_u24 v97, 4682, v96
    v_lshrrev_b32 v97, 16, v97
    v_mul_u32_u24 v98, 14, v97
    v_sub_u32 v98, v96, v98
    v_and_b32 v99, 7, v97
    v_and_b32 v100, 8, v97
    v_lshl_or_b32 v99, v100, 1, v99
    v_and_b32 v100, 16, v97
    v_lshrrev_b32 v100, 1, v100
    v_or_b32 v99, v99, v100
    v_mul_u32_u24 v99, 3584, v99
    v_lshl_add_u32 v10, v98, 4, v99
    v_add_u32 v96, 320, v1
    v_mul_u32_u24 v97, 4682, v96
    v_lshrrev_b32 v97, 16, v97
    v_mul_u32_u24 v98, 14, v97
    v_sub_u32 v98, v96, v98
    v_and_b32 v99, 7, v97
    v_and_b32 v100, 8, v97
    v_lshl_or_b32 v99, v100, 1, v99
    v_and_b32 v100, 16, v97
    v_lshrrev_b32 v100, 1, v100
    v_or_b32 v99, v99, v100
    v_mul_u32_u24 v99, 3584, v99
    v_lshl_add_u32 v11, v98, 4, v99
    v_subrev_u32 v11, 1024, v11
    v_add_u32 v96, 384, v1
    v_mul_u32_u24 v97, 4682, v96
    v_lshrrev_b32 v97, 16, v97
    v_mul_u32_u24 v98, 14, v97
    v_sub_u32 v98, v96, v98
    v_and_b32 v99, 7, v97
    v_and_b32 v100, 8, v97
    v_lshl_or_b32 v99, v100, 1, v99
    v_and_b32 v100, 16, v97
    v_lshrrev_b32 v100, 1, v100
    v_or_b32 v99, v99, v100
    v_mul_u32_u24 v99, 3584, v99
    v_lshl_add_u32 v12, v98, 4, v99
    v_subrev_u32 v12, 2048, v12
    v_and_b32 v88, 15, v1
    v_lshrrev_b32 v89, 4, v1
    v_lshrrev_b32 v90, 1, v88
    v_xor_b32 v90, v89, v90
    v_lshlrev_b32 v91, 7, v88
    v_lshl_add_u32 v90, v90, 4, v91
    v_add_u32 v4, s44, v90
    v_xor_b32 v5, 64, v4
    v_lshrrev_b32 v91, 2, v1
    v_and_b32 v92, 7, v91
    v_and_b32 v91, 8, v91
    v_lshl_add_u32 v91, v91, 1, v92
    v_mul_u32_u24 v91, 224, v91
    v_and_b32 v92, 3, v1
    v_lshl_add_u32 v91, v92, 3, v91
    v_add_u32 v13, 57344, v91
    v_add_u32 v14, 122880, v91
    v_and_b32 v91, 1, v1
    v_lshlrev_b32 v91, 4, v91
    v_mov_b32 v92, 0x3f80
    v_lshlrev_b32 v91, v91, v92
    v_lshrrev_b32 v92, 3, v88
    v_sub_u32 v92, v89, v92
    v_bfe_u32 v93, v1, 1, 2
    v_lshl_or_b32 v92, v92, 2, v93
    v_cmp_eq_u32 vcc, 0, v92
    s_nop 1
    v_cndmask_b32 v172, 0, v91, vcc
    v_cmp_eq_u32 vcc, 1, v92
    s_nop 1
    v_cndmask_b32 v173, 0, v91, vcc
    v_cmp_eq_u32 vcc, 2, v92
    s_nop 1
    v_cndmask_b32 v174, 0, v91, vcc
    v_cmp_eq_u32 vcc, 3, v92
    s_nop 1
    v_cndmask_b32 v175, 0, v91, vcc
    v_cmp_eq_u32 vcc, 8, v92
    s_nop 1
    v_cndmask_b32 v176, 0, v91, vcc
    v_cmp_eq_u32 vcc, 9, v92
    s_nop 1
    v_cndmask_b32 v177, 0, v91, vcc
    v_cmp_eq_u32 vcc, 10, v92
    s_nop 1
    v_cndmask_b32 v178, 0, v91, vcc
    v_cmp_eq_u32 vcc, 11, v92
    s_nop 1
    v_cndmask_b32 v179, 0, v91, vcc
    v_lshrrev_b32 v92, 1, v88
    v_lshlrev_b32 v93, 1, v89
    v_sub_u32 v92, v92, v93
    v_mov_b32 v166, 0
    v_mov_b32 v167, 0
    v_cmp_eq_u32 vcc, 0, v92
    v_mov_b32 v170, 0
    v_mov_b32 v171, 0
    v_cndmask_b32 v168, 0, v91, vcc
    v_cmp_eq_u32 vcc, 1, v92
    v_mov_b32 v112, s55
    v_mov_b32 v113, s55
    v_cndmask_b32 v169, 0, v91, vcc
    v_mov_b32 v114, s55
    v_mov_b32 v115, s55
    v_and_b32 v206, 1, v1
    v_lshlrev_b32 v206, 2, v206
    s_add_u32 s56, s45, 71680
    v_lshl_add_u32 v184, v1, 2, s56
    v_xor_b32 v185, 32, v184
    v_xor_b32 v186, 64, v184
    v_xor_b32 v187, 96, v184
    v_xor_b32 v188, 128, v184
    v_xor_b32 v189, 160, v184
    v_xor_b32 v190, 192, v184
    v_xor_b32 v191, 224, v184
    v_and_b32 v72, 15, v1
    v_and_b32 v73, 7, v1
    v_lshlrev_b32 v73, 5, v73
    v_and_b32 v74, 48, v1
    v_xor_b32 v73, v73, v74
    v_lshl_add_u32 v73, v72, 8, v73
    v_add_u32 v220, s56, v73
    v_xor_b32 v221, 64, v220
    v_xor_b32 v222, 128, v220
    v_xor_b32 v223, 192, v220
    s_waitcnt vmcnt(6)
    s_lshl4_add_u32 s78, s3, s7
    s_lshl_b32 s78, s78, 12
    s_lshl_b32 s79, s4, 18
    s_add_u32 s79, s79, s78
    v_lshlrev_b32 v15, 7, v1
    buffer_load_dword v229, v15, s[16:19], s79 offen
    v_lshlrev_b32 v72, 16, v110
    v_mul_f32 v72, 1069066811, v72
    v_exp_f32 v72, v72
    v_lshlrev_b32 v231, 16, v111
    v_cvt_pk_bf16_f32 v72, v72, v72
    v_and_b32 v72, s54, v72
    v_lshlrev_b32 v192, 16, v104
    v_lshlrev_b32 v194, 16, v105
    v_lshlrev_b32 v196, 16, v106
    v_lshlrev_b32 v197, 16, v107
    v_lshlrev_b32 v74, 16, v108
    v_lshlrev_b32 v75, 16, v109
    v_mul_f32 v192, 1069066811, v192
    v_exp_f32 v192, v192
    v_and_b32 v193, s54, v104
    v_and_b32 v195, s54, v105
    v_and_b32 v198, s54, v106
    v_and_b32 v199, s54, v107
    v_and_b32 v76, s54, v108
    v_and_b32 v77, s54, v109
    v_mul_f32 v193, 1069066811, v193
    v_exp_f32 v193, v193
    s_nop 0
    v_cvt_pk_bf16_f32 v73, v192, v193
    v_lshlrev_b32 v192, 16, v73
    v_and_b32 v193, s54, v73
    v_mul_f32 v192, v192, v72
    v_mul_f32 v192, 3216550459, v192
    v_mul_f32 v194, v194, v72
    v_mul_f32 v194, 1042479491, v194
    v_mul_f32 v193, v193, v72
    v_mul_f32 v193, 3216550459, v193
    v_mul_f32 v195, v195, v72
    v_mul_f32 v195, 1042479491, v195
    v_add_f32 v73, abs(v196), abs(v197)
    v_add_f32 v73, v73, abs(v198)
    v_add_f32 v73, v73, abs(v199)
    v_add_f32 v73, v73, abs(v74)
    v_add_f32 v73, v73, abs(v75)
    v_add_f32 v73, v73, abs(v76)
    v_add_f32 v73, v73, abs(v77)
    s_nop 1
    v_add_f32_dpp v73, v73, v73 row_ror:8 row_mask:0xf bank_mask:0xf
    s_nop 1
    v_add_f32_dpp v73, v73, v73 row_ror:4 row_mask:0xf bank_mask:0xf
    s_nop 1
    v_add_f32_dpp v73, v73, v73 row_ror:2 row_mask:0xf bank_mask:0xf
    s_nop 1
    v_add_f32_dpp v73, v73, v73 row_ror:1 row_mask:0xf bank_mask:0xf
    v_mov_b32 v74, v73
    s_nop 1
    v_permlane16_swap_b32 v73, v74
    v_add_f32 v73, v73, v74
    v_mov_b32 v74, v73
    s_nop 1
    v_permlane32_swap_b32 v73, v74
    v_add_f32 v73, v73, v74
    v_mul_f32 v73, v73, v72
    v_fma_f32 v73, abs(v231), 0.5, v73
    v_mul_f32 v73, 1065361605, v73
    v_frexp_exp_i32_f32 v73, v73
    v_sub_u32 v74, 15, v73
    v_subrev_u32 v75, 14, v73
    v_ldexp_f32 v230, 1.0, v75
    v_sub_u32 v75, 14, v73
    v_cmp_eq_u32 vcc, 0, v1
    v_ldexp_f32 v231, v231, v75
    s_nop 0
    v_cndmask_b32 v231, 0, v231, vcc
    v_mul_f32 v196, v196, v72
    v_ldexp_f32 v196, v196, v74
    v_mul_f32 v197, v197, v72
    v_ldexp_f32 v197, v197, v74
    v_mul_f32 v198, v198, v72
    v_ldexp_f32 v198, v198, v74
    v_mul_f32 v199, v199, v72
    v_ldexp_f32 v199, v199, v74
    v_mul_f32 v72, 1065353216, v192
    v_mul_f32 v243, 1065353216, v194
    v_exp_f32 v72, v72
    v_fract_f32 v243, v243
    v_cos_f32 v242, v243
    v_sin_f32 v243, v243
    v_mul_f32 v242, v72, v242
    v_mul_f32 v243, v72, v243
    v_mul_f32 v73, 1090519040, v192
    v_mul_f32 v241, 1090519040, v194
    v_exp_f32 v73, v73
    v_fract_f32 v241, v241
    v_cos_f32 v240, v241
    v_sin_f32 v241, v241
    v_mul_f32 v240, v73, v240
    v_mul_f32 v241, v73, v241
    v_mul_f32 v74, 1124073472, v192
    v_mul_f32 v201, 1124073472, v194
    v_exp_f32 v74, v74
    v_fract_f32 v201, v201
    v_cos_f32 v200, v201
    v_sin_f32 v201, v201
    v_mul_f32 v200, v74, v200
    v_mul_f32 v201, v74, v201
    v_pk_mul_f32 v[244:245], v[242:243], v[242:243] op_sel:[0,0] op_sel_hi:[0,1]
    v_pk_fma_f32 v[244:245], v[242:243], v[242:243], v[244:245] op_sel:[1,1,0] op_sel_hi:[1,0,1] neg_lo:[0,1,0]
    v_pk_mul_f32 v[246:247], v[244:245], v[242:243] op_sel:[0,0] op_sel_hi:[0,1]
    v_pk_fma_f32 v[246:247], v[244:245], v[242:243], v[246:247] op_sel:[1,1,0] op_sel_hi:[1,0,1] neg_lo:[0,1,0]
    v_pk_mul_f32 v[248:249], v[244:245], v[244:245] op_sel:[0,0] op_sel_hi:[0,1]
    v_pk_fma_f32 v[248:249], v[244:245], v[244:245], v[248:249] op_sel:[1,1,0] op_sel_hi:[1,0,1] neg_lo:[0,1,0]
    v_pk_mul_f32 v[250:251], v[248:249], v[242:243] op_sel:[0,0] op_sel_hi:[0,1]
    v_pk_fma_f32 v[250:251], v[248:249], v[242:243], v[250:251] op_sel:[1,1,0] op_sel_hi:[1,0,1] neg_lo:[0,1,0]
    v_pk_mul_f32 v[252:253], v[248:249], v[244:245] op_sel:[0,0] op_sel_hi:[0,1]
    v_pk_fma_f32 v[252:253], v[248:249], v[244:245], v[252:253] op_sel:[1,1,0] op_sel_hi:[1,0,1] neg_lo:[0,1,0]
    v_pk_mul_f32 v[254:255], v[248:249], v[246:247] op_sel:[0,0] op_sel_hi:[0,1]
    v_pk_fma_f32 v[254:255], v[248:249], v[246:247], v[254:255] op_sel:[1,1,0] op_sel_hi:[1,0,1] neg_lo:[0,1,0]
    v_cvt_pk_f16_f32 v84, v196, -v197
    v_pk_mul_f32 v[202:203], v[196:197], v[240:241] op_sel:[0,0] op_sel_hi:[0,1]
    v_pk_fma_f32 v[202:203], v[196:197], v[240:241], v[202:203] op_sel:[1,1,0] op_sel_hi:[1,0,1] neg_lo:[0,1,0]
    v_cvt_pk_f16_f32 v85, v202, -v203
    v_pk_mul_f32 v[204:205], v[202:203], v[240:241] op_sel:[0,0] op_sel_hi:[0,1]
    v_pk_fma_f32 v[204:205], v[202:203], v[240:241], v[204:205] op_sel:[1,1,0] op_sel_hi:[1,0,1] neg_lo:[0,1,0]
    v_cvt_pk_f16_f32 v86, v204, -v205
    v_pk_mul_f32 v[202:203], v[204:205], v[240:241] op_sel:[0,0] op_sel_hi:[0,1]
    v_pk_fma_f32 v[202:203], v[204:205], v[240:241], v[202:203] op_sel:[1,1,0] op_sel_hi:[1,0,1] neg_lo:[0,1,0]
    v_cvt_pk_f16_f32 v87, v202, -v203
    v_pk_mul_f32 v[204:205], v[202:203], v[240:241] op_sel:[0,0] op_sel_hi:[0,1]
    v_pk_fma_f32 v[204:205], v[202:203], v[240:241], v[204:205] op_sel:[1,1,0] op_sel_hi:[1,0,1] neg_lo:[0,1,0]
    v_cvt_pk_f16_f32 v88, v204, -v205
    v_pk_mul_f32 v[202:203], v[204:205], v[240:241] op_sel:[0,0] op_sel_hi:[0,1]
    v_pk_fma_f32 v[202:203], v[204:205], v[240:241], v[202:203] op_sel:[1,1,0] op_sel_hi:[1,0,1] neg_lo:[0,1,0]
    v_cvt_pk_f16_f32 v89, v202, -v203
    v_pk_mul_f32 v[204:205], v[202:203], v[240:241] op_sel:[0,0] op_sel_hi:[0,1]
    v_pk_fma_f32 v[204:205], v[202:203], v[240:241], v[204:205] op_sel:[1,1,0] op_sel_hi:[1,0,1] neg_lo:[0,1,0]
    v_cvt_pk_f16_f32 v90, v204, -v205
    v_pk_mul_f32 v[202:203], v[204:205], v[240:241] op_sel:[0,0] op_sel_hi:[0,1]
    v_pk_fma_f32 v[202:203], v[204:205], v[240:241], v[202:203] op_sel:[1,1,0] op_sel_hi:[1,0,1] neg_lo:[0,1,0]
    v_cvt_pk_f16_f32 v91, v202, -v203
    v_pk_mul_f32 v[204:205], v[202:203], v[240:241] op_sel:[0,0] op_sel_hi:[0,1]
    v_pk_fma_f32 v[204:205], v[202:203], v[240:241], v[204:205] op_sel:[1,1,0] op_sel_hi:[1,0,1] neg_lo:[0,1,0]
    v_cvt_pk_f16_f32 v92, v204, -v205
    ds_write2st64_b32 v184, v84, v92 offset0:0 offset1:8
    v_pk_mul_f32 v[202:203], v[204:205], v[240:241] op_sel:[0,0] op_sel_hi:[0,1]
    v_pk_fma_f32 v[202:203], v[204:205], v[240:241], v[202:203] op_sel:[1,1,0] op_sel_hi:[1,0,1] neg_lo:[0,1,0]
    v_cvt_pk_f16_f32 v93, v202, -v203
    ds_write2st64_b32 v185, v85, v93 offset0:1 offset1:9
    v_pk_mul_f32 v[204:205], v[202:203], v[240:241] op_sel:[0,0] op_sel_hi:[0,1]
    v_pk_fma_f32 v[204:205], v[202:203], v[240:241], v[204:205] op_sel:[1,1,0] op_sel_hi:[1,0,1] neg_lo:[0,1,0]
    v_cvt_pk_f16_f32 v94, v204, -v205
    ds_write2st64_b32 v186, v86, v94 offset0:2 offset1:10
    v_pk_mul_f32 v[202:203], v[204:205], v[240:241] op_sel:[0,0] op_sel_hi:[0,1]
    v_pk_fma_f32 v[202:203], v[204:205], v[240:241], v[202:203] op_sel:[1,1,0] op_sel_hi:[1,0,1] neg_lo:[0,1,0]
    v_cvt_pk_f16_f32 v95, v202, -v203
    ds_write2st64_b32 v187, v87, v95 offset0:3 offset1:11
    v_pk_mul_f32 v[204:205], v[202:203], v[240:241] op_sel:[0,0] op_sel_hi:[0,1]
    v_pk_fma_f32 v[204:205], v[202:203], v[240:241], v[204:205] op_sel:[1,1,0] op_sel_hi:[1,0,1] neg_lo:[0,1,0]
    v_cvt_pk_f16_f32 v96, v204, -v205
    ds_write2st64_b32 v188, v88, v96 offset0:4 offset1:12
    v_pk_mul_f32 v[202:203], v[204:205], v[240:241] op_sel:[0,0] op_sel_hi:[0,1]
    v_pk_fma_f32 v[202:203], v[204:205], v[240:241], v[202:203] op_sel:[1,1,0] op_sel_hi:[1,0,1] neg_lo:[0,1,0]
    v_cvt_pk_f16_f32 v97, v202, -v203
    ds_write2st64_b32 v189, v89, v97 offset0:5 offset1:13
    v_pk_mul_f32 v[204:205], v[202:203], v[240:241] op_sel:[0,0] op_sel_hi:[0,1]
    v_pk_fma_f32 v[204:205], v[202:203], v[240:241], v[204:205] op_sel:[1,1,0] op_sel_hi:[1,0,1] neg_lo:[0,1,0]
    v_cvt_pk_f16_f32 v98, v204, -v205
    ds_write2st64_b32 v190, v90, v98 offset0:6 offset1:14
    v_pk_mul_f32 v[202:203], v[204:205], v[240:241] op_sel:[0,0] op_sel_hi:[0,1]
    v_pk_fma_f32 v[202:203], v[204:205], v[240:241], v[202:203] op_sel:[1,1,0] op_sel_hi:[1,0,1] neg_lo:[0,1,0]
    v_cvt_pk_f16_f32 v99, v202, -v203
    ds_write2st64_b32 v191, v91, v99 offset0:7 offset1:15
    ds_read_b128 a[224:227], v220
    ds_read_b128 a[228:231], v221
    ds_read_b128 a[232:235], v222
    ds_read_b128 a[236:239], v223
    v_mul_f32 v202, 1182793728, v200
    v_mul_f32 v203, 1182793728, v201
    v_mov_b32 v84, 0x7400
    v_mov_b32 v72, 1182793728
    v_cvt_pk_f16_f32 v92, v202, v203
    ds_write2st64_b32 v184, v84, v92 offset0:0 offset1:8
    v_pk_mul_f32 v[80:81], v[242:243], v[72:73] op_sel_hi:[1,0]
    v_pk_mul_f32 v[82:83], v[202:203], v[242:243] op_sel:[0,0] op_sel_hi:[0,1]
    v_pk_fma_f32 v[82:83], v[202:203], v[242:243], v[82:83] op_sel:[1,1,0] op_sel_hi:[1,0,1] neg_lo:[0,1,0]
    v_cvt_pk_f16_f32 v85, v80, v81
    v_cvt_pk_f16_f32 v93, v82, v83
    ds_write2st64_b32 v185, v85, v93 offset0:1 offset1:9
    v_pk_mul_f32 v[80:81], v[244:245], v[72:73] op_sel_hi:[1,0]
    v_pk_mul_f32 v[82:83], v[202:203], v[244:245] op_sel:[0,0] op_sel_hi:[0,1]
    v_pk_fma_f32 v[82:83], v[202:203], v[244:245], v[82:83] op_sel:[1,1,0] op_sel_hi:[1,0,1] neg_lo:[0,1,0]
    v_cvt_pk_f16_f32 v86, v80, v81
    v_cvt_pk_f16_f32 v94, v82, v83
    ds_write2st64_b32 v186, v86, v94 offset0:2 offset1:10
    v_pk_mul_f32 v[80:81], v[246:247], v[72:73] op_sel_hi:[1,0]
    v_pk_mul_f32 v[82:83], v[202:203], v[246:247] op_sel:[0,0] op_sel_hi:[0,1]
    v_pk_fma_f32 v[82:83], v[202:203], v[246:247], v[82:83] op_sel:[1,1,0] op_sel_hi:[1,0,1] neg_lo:[0,1,0]
    v_cvt_pk_f16_f32 v87, v80, v81
    v_cvt_pk_f16_f32 v95, v82, v83
    ds_write2st64_b32 v187, v87, v95 offset0:3 offset1:11
    v_pk_mul_f32 v[80:81], v[248:249], v[72:73] op_sel_hi:[1,0]
    v_pk_mul_f32 v[82:83], v[202:203], v[248:249] op_sel:[0,0] op_sel_hi:[0,1]
    v_pk_fma_f32 v[82:83], v[202:203], v[248:249], v[82:83] op_sel:[1,1,0] op_sel_hi:[1,0,1] neg_lo:[0,1,0]
    v_cvt_pk_f16_f32 v88, v80, v81
    v_cvt_pk_f16_f32 v96, v82, v83
    ds_write2st64_b32 v188, v88, v96 offset0:4 offset1:12
    v_pk_mul_f32 v[80:81], v[250:251], v[72:73] op_sel_hi:[1,0]
    v_pk_mul_f32 v[82:83], v[202:203], v[250:251] op_sel:[0,0] op_sel_hi:[0,1]
    v_pk_fma_f32 v[82:83], v[202:203], v[250:251], v[82:83] op_sel:[1,1,0] op_sel_hi:[1,0,1] neg_lo:[0,1,0]
    v_cvt_pk_f16_f32 v89, v80, v81
    v_cvt_pk_f16_f32 v97, v82, v83
    ds_write2st64_b32 v189, v89, v97 offset0:5 offset1:13
    v_pk_mul_f32 v[80:81], v[252:253], v[72:73] op_sel_hi:[1,0]
    v_pk_mul_f32 v[82:83], v[202:203], v[252:253] op_sel:[0,0] op_sel_hi:[0,1]
    v_pk_fma_f32 v[82:83], v[202:203], v[252:253], v[82:83] op_sel:[1,1,0] op_sel_hi:[1,0,1] neg_lo:[0,1,0]
    v_cvt_pk_f16_f32 v90, v80, v81
    v_cvt_pk_f16_f32 v98, v82, v83
    ds_write2st64_b32 v190, v90, v98 offset0:6 offset1:14
    v_pk_mul_f32 v[80:81], v[254:255], v[72:73] op_sel_hi:[1,0]
    v_pk_mul_f32 v[82:83], v[202:203], v[254:255] op_sel:[0,0] op_sel_hi:[0,1]
    v_pk_fma_f32 v[82:83], v[202:203], v[254:255], v[82:83] op_sel:[1,1,0] op_sel_hi:[1,0,1] neg_lo:[0,1,0]
    v_cvt_pk_f16_f32 v91, v80, v81
    v_cvt_pk_f16_f32 v99, v82, v83
    ds_write2st64_b32 v191, v91, v99 offset0:7 offset1:15
    ds_read_b128 a[240:243], v220
    ds_read_b128 a[244:247], v221
    ds_read_b128 a[248:251], v222
    ds_read_b128 a[252:255], v223
    v_pk_mul_f32 v[204:205], v[202:203], v[200:201] op_sel:[0,0] op_sel_hi:[0,1]
    v_pk_fma_f32 v[204:205], v[202:203], v[200:201], v[204:205] op_sel:[1,1,0] op_sel_hi:[1,0,1] neg_lo:[0,1,0]
    v_cvt_pk_f16_f32 v84, v204, v205
    v_pk_mul_f32 v[80:81], v[204:205], v[244:245] op_sel:[0,0] op_sel_hi:[0,1]
    v_pk_fma_f32 v[80:81], v[204:205], v[244:245], v[80:81] op_sel:[1,1,0] op_sel_hi:[1,0,1] neg_lo:[0,1,0]
    v_cvt_pk_f16_f32 v85, v80, v81
    v_pk_mul_f32 v[80:81], v[204:205], v[248:249] op_sel:[0,0] op_sel_hi:[0,1]
    v_pk_fma_f32 v[80:81], v[204:205], v[248:249], v[80:81] op_sel:[1,1,0] op_sel_hi:[1,0,1] neg_lo:[0,1,0]
    v_cvt_pk_f16_f32 v86, v80, v81
    v_pk_mul_f32 v[80:81], v[204:205], v[252:253] op_sel:[0,0] op_sel_hi:[0,1]
    v_pk_fma_f32 v[80:81], v[204:205], v[252:253], v[80:81] op_sel:[1,1,0] op_sel_hi:[1,0,1] neg_lo:[0,1,0]
    v_cvt_pk_f16_f32 v87, v80, v81
    v_pk_mul_f32 v[202:203], v[204:205], v[200:201] op_sel:[0,0] op_sel_hi:[0,1]
    v_pk_fma_f32 v[202:203], v[204:205], v[200:201], v[202:203] op_sel:[1,1,0] op_sel_hi:[1,0,1] neg_lo:[0,1,0]
    v_cvt_pk_f16_f32 v88, v202, v203
    v_pk_mul_f32 v[80:81], v[202:203], v[244:245] op_sel:[0,0] op_sel_hi:[0,1]
    v_pk_fma_f32 v[80:81], v[202:203], v[244:245], v[80:81] op_sel:[1,1,0] op_sel_hi:[1,0,1] neg_lo:[0,1,0]
    v_cvt_pk_f16_f32 v89, v80, v81
    v_pk_mul_f32 v[80:81], v[202:203], v[248:249] op_sel:[0,0] op_sel_hi:[0,1]
    v_pk_fma_f32 v[80:81], v[202:203], v[248:249], v[80:81] op_sel:[1,1,0] op_sel_hi:[1,0,1] neg_lo:[0,1,0]
    v_cvt_pk_f16_f32 v90, v80, v81
    v_pk_mul_f32 v[80:81], v[202:203], v[252:253] op_sel:[0,0] op_sel_hi:[0,1]
    v_pk_fma_f32 v[80:81], v[202:203], v[252:253], v[80:81] op_sel:[1,1,0] op_sel_hi:[1,0,1] neg_lo:[0,1,0]
    v_cvt_pk_f16_f32 v91, v80, v81
    s_waitcnt lgkmcnt(0)
    v_mfma_f32_16x16x32_f16 a[208:211], a[240:243], a[224:227], 0
    v_mfma_f32_16x16x32_f16 a[208:211], a[244:247], a[228:231], a[208:211]
    v_mfma_f32_16x16x32_f16 a[208:211], a[248:251], a[232:235], a[208:211]
    v_mfma_f32_16x16x32_f16 a[208:211], a[252:255], a[236:239], a[208:211]
    v_pk_mul_f32 v[204:205], v[202:203], v[200:201] op_sel:[0,0] op_sel_hi:[0,1]
    v_pk_fma_f32 v[204:205], v[202:203], v[200:201], v[204:205] op_sel:[1,1,0] op_sel_hi:[1,0,1] neg_lo:[0,1,0]
    v_cvt_pk_f16_f32 v92, v204, v205
    ds_write2st64_b32 v184, v84, v92 offset0:0 offset1:8
    v_pk_mul_f32 v[80:81], v[204:205], v[248:249] op_sel:[0,0] op_sel_hi:[0,1]
    v_pk_fma_f32 v[80:81], v[204:205], v[248:249], v[80:81] op_sel:[1,1,0] op_sel_hi:[1,0,1] neg_lo:[0,1,0]
    v_cvt_pk_f16_f32 v93, v80, v81
    ds_write2st64_b32 v185, v85, v93 offset0:1 offset1:9
    v_pk_mul_f32 v[202:203], v[204:205], v[200:201] op_sel:[0,0] op_sel_hi:[0,1]
    v_pk_fma_f32 v[202:203], v[204:205], v[200:201], v[202:203] op_sel:[1,1,0] op_sel_hi:[1,0,1] neg_lo:[0,1,0]
    v_cvt_pk_f16_f32 v94, v202, v203
    ds_write2st64_b32 v186, v86, v94 offset0:2 offset1:10
    v_pk_mul_f32 v[80:81], v[202:203], v[248:249] op_sel:[0,0] op_sel_hi:[0,1]
    v_pk_fma_f32 v[80:81], v[202:203], v[248:249], v[80:81] op_sel:[1,1,0] op_sel_hi:[1,0,1] neg_lo:[0,1,0]
    v_cvt_pk_f16_f32 v95, v80, v81
    ds_write2st64_b32 v187, v87, v95 offset0:3 offset1:11
    v_pk_mul_f32 v[204:205], v[202:203], v[200:201] op_sel:[0,0] op_sel_hi:[0,1]
    v_pk_fma_f32 v[204:205], v[202:203], v[200:201], v[204:205] op_sel:[1,1,0] op_sel_hi:[1,0,1] neg_lo:[0,1,0]
    v_cvt_pk_f16_f32 v96, v204, v205
    ds_write2st64_b32 v188, v88, v96 offset0:4 offset1:12
    v_pk_mul_f32 v[80:81], v[204:205], v[248:249] op_sel:[0,0] op_sel_hi:[0,1]
    v_pk_fma_f32 v[80:81], v[204:205], v[248:249], v[80:81] op_sel:[1,1,0] op_sel_hi:[1,0,1] neg_lo:[0,1,0]
    v_cvt_pk_f16_f32 v97, v80, v81
    ds_write2st64_b32 v189, v89, v97 offset0:5 offset1:13
    v_pk_mul_f32 v[202:203], v[204:205], v[200:201] op_sel:[0,0] op_sel_hi:[0,1]
    v_pk_fma_f32 v[202:203], v[204:205], v[200:201], v[202:203] op_sel:[1,1,0] op_sel_hi:[1,0,1] neg_lo:[0,1,0]
    v_cvt_pk_f16_f32 v98, v202, v203
    ds_write2st64_b32 v190, v90, v98 offset0:6 offset1:14
    v_pk_mul_f32 v[80:81], v[202:203], v[248:249] op_sel:[0,0] op_sel_hi:[0,1]
    v_pk_fma_f32 v[80:81], v[202:203], v[248:249], v[80:81] op_sel:[1,1,0] op_sel_hi:[1,0,1] neg_lo:[0,1,0]
    v_cvt_pk_f16_f32 v99, v80, v81
    ds_write2st64_b32 v191, v91, v99 offset0:7 offset1:15
    ds_read_b128 a[240:243], v220
    ds_read_b128 a[244:247], v221
    ds_read_b128 a[248:251], v222
    ds_read_b128 a[252:255], v223
    v_pk_mul_f32 v[204:205], v[202:203], v[200:201] op_sel:[0,0] op_sel_hi:[0,1]
    v_pk_fma_f32 v[204:205], v[202:203], v[200:201], v[204:205] op_sel:[1,1,0] op_sel_hi:[1,0,1] neg_lo:[0,1,0]
    v_cvt_pk_f16_f32 v84, v204, v205
    ds_write_b32 v184, v84 offset:0
    v_pk_mul_f32 v[202:203], v[204:205], v[200:201] op_sel:[0,0] op_sel_hi:[0,1]
    v_pk_fma_f32 v[202:203], v[204:205], v[200:201], v[202:203] op_sel:[1,1,0] op_sel_hi:[1,0,1] neg_lo:[0,1,0]
    v_cvt_pk_f16_f32 v85, v202, v203
    ds_write_b32 v185, v85 offset:256
    v_pk_mul_f32 v[204:205], v[202:203], v[200:201] op_sel:[0,0] op_sel_hi:[0,1]
    v_pk_fma_f32 v[204:205], v[202:203], v[200:201], v[204:205] op_sel:[1,1,0] op_sel_hi:[1,0,1] neg_lo:[0,1,0]
    v_cvt_pk_f16_f32 v86, v204, v205
    ds_write_b32 v186, v86 offset:512
    v_pk_mul_f32 v[202:203], v[204:205], v[200:201] op_sel:[0,0] op_sel_hi:[0,1]
    v_pk_fma_f32 v[202:203], v[204:205], v[200:201], v[202:203] op_sel:[1,1,0] op_sel_hi:[1,0,1] neg_lo:[0,1,0]
    v_cvt_pk_f16_f32 v87, v202, v203
    ds_write_b32 v187, v87 offset:768
    v_pk_mul_f32 v[204:205], v[202:203], v[200:201] op_sel:[0,0] op_sel_hi:[0,1]
    v_pk_fma_f32 v[204:205], v[202:203], v[200:201], v[204:205] op_sel:[1,1,0] op_sel_hi:[1,0,1] neg_lo:[0,1,0]
    v_cvt_pk_f16_f32 v88, v204, v205
    ds_write_b32 v188, v88 offset:1024
    v_pk_mul_f32 v[202:203], v[204:205], v[200:201] op_sel:[0,0] op_sel_hi:[0,1]
    v_pk_fma_f32 v[202:203], v[204:205], v[200:201], v[202:203] op_sel:[1,1,0] op_sel_hi:[1,0,1] neg_lo:[0,1,0]
    v_cvt_pk_f16_f32 v89, v202, v203
    ds_write_b32 v189, v89 offset:1280
    s_waitcnt lgkmcnt(6)
    v_mfma_f32_16x16x32_f16 a[212:215], a[240:243], a[224:227], 0
    v_mfma_f32_16x16x32_f16 a[212:215], a[244:247], a[228:231], a[212:215]
    v_mfma_f32_16x16x32_f16 a[212:215], a[248:251], a[232:235], a[212:215]
    v_mfma_f32_16x16x32_f16 a[212:215], a[252:255], a[236:239], a[212:215]
    v_pk_mul_f32 v[204:205], v[202:203], v[200:201] op_sel:[0,0] op_sel_hi:[0,1]
    v_pk_fma_f32 v[204:205], v[202:203], v[200:201], v[204:205] op_sel:[1,1,0] op_sel_hi:[1,0,1] neg_lo:[0,1,0]
    v_cvt_pk_f16_f32 v90, v204, v205
    ds_write_b32 v190, v90 offset:1536
    v_pk_mul_f32 v[202:203], v[204:205], v[200:201] op_sel:[0,0] op_sel_hi:[0,1]
    v_pk_fma_f32 v[202:203], v[204:205], v[200:201], v[202:203] op_sel:[1,1,0] op_sel_hi:[1,0,1] neg_lo:[0,1,0]
    v_cvt_pk_f16_f32 v91, v202, v203
    ds_write_b32 v191, v91 offset:1792
    v_pk_mul_f32 v[204:205], v[202:203], v[200:201] op_sel:[0,0] op_sel_hi:[0,1]
    v_pk_fma_f32 v[204:205], v[202:203], v[200:201], v[204:205] op_sel:[1,1,0] op_sel_hi:[1,0,1] neg_lo:[0,1,0]
    v_cvt_pk_f16_f32 v92, v204, v205
    ds_write_b32 v184, v92 offset:2048
    ds_read_b128 a[240:243], v220
    ds_read_b128 a[244:247], v221
    ds_read_b128 a[248:251], v222
    ds_read_b128 a[252:255], v223
    v_mul_f32 v72, 1065353216, v193
    v_mul_f32 v243, 1065353216, v195
    v_exp_f32 v72, v72
    v_fract_f32 v243, v243
    v_cos_f32 v242, v243
    v_sin_f32 v243, v243
    v_mul_f32 v242, v72, v242
    v_mul_f32 v243, v72, v243
    v_mul_f32 v73, 1090519040, v193
    v_mul_f32 v241, 1090519040, v195
    v_exp_f32 v73, v73
    v_fract_f32 v241, v241
    v_cos_f32 v240, v241
    v_sin_f32 v241, v241
    v_mul_f32 v240, v73, v240
    v_mul_f32 v241, v73, v241
    s_waitcnt lgkmcnt(0)
    v_mfma_f32_16x16x32_f16 a[216:219], a[240:243], a[224:227], 0
    v_mfma_f32_16x16x32_f16 a[216:219], a[244:247], a[228:231], a[216:219]
    v_mfma_f32_16x16x32_f16 a[216:219], a[248:251], a[232:235], a[216:219]
    v_mfma_f32_16x16x32_f16 a[216:219], a[252:255], a[236:239], a[216:219]
    v_mul_f32 v74, 1124073472, v193
    v_mul_f32 v201, 1124073472, v195
    v_exp_f32 v74, v74
    v_fract_f32 v201, v201
    v_cos_f32 v200, v201
    v_sin_f32 v201, v201
    v_mul_f32 v200, v74, v200
    s_add_u32 m0, s44, 4096
    v_mul_f32 v201, v74, v201
    buffer_load_dwordx4 v2, s[8:11], s52 offen  lds
    buffer_load_dwordx4 v3, s[8:11], s52 offen offset:1024  lds
    s_add_u32 s52, s52, 128
    s_cmp_eq_u32 s52, s96
    s_cselect_b32 s52, s53, s52
    v_pk_mul_f32 v[244:245], v[242:243], v[242:243] op_sel:[0,0] op_sel_hi:[0,1]
    v_pk_fma_f32 v[244:245], v[242:243], v[242:243], v[244:245] op_sel:[1,1,0] op_sel_hi:[1,0,1] neg_lo:[0,1,0]
    v_pk_mul_f32 v[246:247], v[244:245], v[242:243] op_sel:[0,0] op_sel_hi:[0,1]
    v_pk_fma_f32 v[246:247], v[244:245], v[242:243], v[246:247] op_sel:[1,1,0] op_sel_hi:[1,0,1] neg_lo:[0,1,0]
    v_pk_mul_f32 v[248:249], v[244:245], v[244:245] op_sel:[0,0] op_sel_hi:[0,1]
    v_pk_fma_f32 v[248:249], v[244:245], v[244:245], v[248:249] op_sel:[1,1,0] op_sel_hi:[1,0,1] neg_lo:[0,1,0]
    v_pk_mul_f32 v[250:251], v[248:249], v[242:243] op_sel:[0,0] op_sel_hi:[0,1]
    v_pk_fma_f32 v[250:251], v[248:249], v[242:243], v[250:251] op_sel:[1,1,0] op_sel_hi:[1,0,1] neg_lo:[0,1,0]
    v_pk_mul_f32 v[252:253], v[248:249], v[244:245] op_sel:[0,0] op_sel_hi:[0,1]
    v_pk_fma_f32 v[252:253], v[248:249], v[244:245], v[252:253] op_sel:[1,1,0] op_sel_hi:[1,0,1] neg_lo:[0,1,0]
    v_pk_mul_f32 v[254:255], v[248:249], v[246:247] op_sel:[0,0] op_sel_hi:[0,1]
    v_pk_fma_f32 v[254:255], v[248:249], v[246:247], v[254:255] op_sel:[1,1,0] op_sel_hi:[1,0,1] neg_lo:[0,1,0]
    v_cvt_pk_f16_f32 v84, v198, -v199
    v_pk_mul_f32 v[202:203], v[198:199], v[240:241] op_sel:[0,0] op_sel_hi:[0,1]
    v_pk_fma_f32 v[202:203], v[198:199], v[240:241], v[202:203] op_sel:[1,1,0] op_sel_hi:[1,0,1] neg_lo:[0,1,0]
    v_cvt_pk_f16_f32 v85, v202, -v203
    v_pk_mul_f32 v[204:205], v[202:203], v[240:241] op_sel:[0,0] op_sel_hi:[0,1]
    v_pk_fma_f32 v[204:205], v[202:203], v[240:241], v[204:205] op_sel:[1,1,0] op_sel_hi:[1,0,1] neg_lo:[0,1,0]
    s_add_u32 m0, s44, 6144
    v_cvt_pk_f16_f32 v86, v204, -v205
    buffer_load_dwordx4 v2, s[8:11], s52 offen  lds
    buffer_load_dwordx4 v3, s[8:11], s52 offen offset:1024  lds
    s_add_u32 s52, s52, 128
    s_cmp_eq_u32 s52, s96
    s_cselect_b32 s52, s53, s52
    v_pk_mul_f32 v[202:203], v[204:205], v[240:241] op_sel:[0,0] op_sel_hi:[0,1]
    v_pk_fma_f32 v[202:203], v[204:205], v[240:241], v[202:203] op_sel:[1,1,0] op_sel_hi:[1,0,1] neg_lo:[0,1,0]
    v_cvt_pk_f16_f32 v87, v202, -v203
    v_pk_mul_f32 v[204:205], v[202:203], v[240:241] op_sel:[0,0] op_sel_hi:[0,1]
    v_pk_fma_f32 v[204:205], v[202:203], v[240:241], v[204:205] op_sel:[1,1,0] op_sel_hi:[1,0,1] neg_lo:[0,1,0]
    v_cvt_pk_f16_f32 v88, v204, -v205
    v_pk_mul_f32 v[202:203], v[204:205], v[240:241] op_sel:[0,0] op_sel_hi:[0,1]
    v_pk_fma_f32 v[202:203], v[204:205], v[240:241], v[202:203] op_sel:[1,1,0] op_sel_hi:[1,0,1] neg_lo:[0,1,0]
    v_cvt_pk_f16_f32 v89, v202, -v203
    v_pk_mul_f32 v[204:205], v[202:203], v[240:241] op_sel:[0,0] op_sel_hi:[0,1]
    v_pk_fma_f32 v[204:205], v[202:203], v[240:241], v[204:205] op_sel:[1,1,0] op_sel_hi:[1,0,1] neg_lo:[0,1,0]
    v_cvt_pk_f16_f32 v90, v204, -v205
    v_pk_mul_f32 v[202:203], v[204:205], v[240:241] op_sel:[0,0] op_sel_hi:[0,1]
    v_pk_fma_f32 v[202:203], v[204:205], v[240:241], v[202:203] op_sel:[1,1,0] op_sel_hi:[1,0,1] neg_lo:[0,1,0]
    v_cvt_pk_f16_f32 v91, v202, -v203
    v_pk_mul_f32 v[204:205], v[202:203], v[240:241] op_sel:[0,0] op_sel_hi:[0,1]
    v_pk_fma_f32 v[204:205], v[202:203], v[240:241], v[204:205] op_sel:[1,1,0] op_sel_hi:[1,0,1] neg_lo:[0,1,0]
    v_cvt_pk_f16_f32 v92, v204, -v205
    s_add_u32 m0, s44, 8192
    ds_write2st64_b32 v184, v84, v92 offset0:0 offset1:8
    buffer_load_dwordx4 v2, s[8:11], s52 offen  lds
    buffer_load_dwordx4 v3, s[8:11], s52 offen offset:1024  lds
    s_add_u32 s52, s52, 128
    s_cmp_eq_u32 s52, s96
    s_cselect_b32 s52, s53, s52
    v_pk_mul_f32 v[202:203], v[204:205], v[240:241] op_sel:[0,0] op_sel_hi:[0,1]
    v_pk_fma_f32 v[202:203], v[204:205], v[240:241], v[202:203] op_sel:[1,1,0] op_sel_hi:[1,0,1] neg_lo:[0,1,0]
    v_cvt_pk_f16_f32 v93, v202, -v203
    ds_write2st64_b32 v185, v85, v93 offset0:1 offset1:9
    v_pk_mul_f32 v[204:205], v[202:203], v[240:241] op_sel:[0,0] op_sel_hi:[0,1]
    v_pk_fma_f32 v[204:205], v[202:203], v[240:241], v[204:205] op_sel:[1,1,0] op_sel_hi:[1,0,1] neg_lo:[0,1,0]
    v_cvt_pk_f16_f32 v94, v204, -v205
    ds_write2st64_b32 v186, v86, v94 offset0:2 offset1:10
    v_pk_mul_f32 v[202:203], v[204:205], v[240:241] op_sel:[0,0] op_sel_hi:[0,1]
    v_pk_fma_f32 v[202:203], v[204:205], v[240:241], v[202:203] op_sel:[1,1,0] op_sel_hi:[1,0,1] neg_lo:[0,1,0]
    v_cvt_pk_f16_f32 v95, v202, -v203
    s_add_u32 m0, s44, 10240
    ds_write2st64_b32 v187, v87, v95 offset0:3 offset1:11
    buffer_load_dwordx4 v2, s[8:11], s52 offen  lds
    buffer_load_dwordx4 v3, s[8:11], s52 offen offset:1024  lds
    s_add_u32 s52, s52, 128
    s_cmp_eq_u32 s52, s96
    s_cselect_b32 s52, s53, s52
    v_pk_mul_f32 v[204:205], v[202:203], v[240:241] op_sel:[0,0] op_sel_hi:[0,1]
    v_pk_fma_f32 v[204:205], v[202:203], v[240:241], v[204:205] op_sel:[1,1,0] op_sel_hi:[1,0,1] neg_lo:[0,1,0]
    v_cvt_pk_f16_f32 v96, v204, -v205
    ds_write2st64_b32 v188, v88, v96 offset0:4 offset1:12
    v_pk_mul_f32 v[202:203], v[204:205], v[240:241] op_sel:[0,0] op_sel_hi:[0,1]
    v_pk_fma_f32 v[202:203], v[204:205], v[240:241], v[202:203] op_sel:[1,1,0] op_sel_hi:[1,0,1] neg_lo:[0,1,0]
    v_cvt_pk_f16_f32 v97, v202, -v203
    ds_write2st64_b32 v189, v89, v97 offset0:5 offset1:13
    v_pk_mul_f32 v[204:205], v[202:203], v[240:241] op_sel:[0,0] op_sel_hi:[0,1]
    v_pk_fma_f32 v[204:205], v[202:203], v[240:241], v[204:205] op_sel:[1,1,0] op_sel_hi:[1,0,1] neg_lo:[0,1,0]
    v_cvt_pk_f16_f32 v98, v204, -v205
    s_add_u32 m0, s44, 12288
    ds_write2st64_b32 v190, v90, v98 offset0:6 offset1:14
    buffer_load_dwordx4 v2, s[8:11], s52 offen  lds
    buffer_load_dwordx4 v3, s[8:11], s52 offen offset:1024  lds
    v_pk_mul_f32 v[202:203], v[204:205], v[240:241] op_sel:[0,0] op_sel_hi:[0,1]
    v_pk_fma_f32 v[202:203], v[204:205], v[240:241], v[202:203] op_sel:[1,1,0] op_sel_hi:[1,0,1] neg_lo:[0,1,0]
    v_cvt_pk_f16_f32 v99, v202, -v203
    ds_write2st64_b32 v191, v91, v99 offset0:7 offset1:15
    ds_read_b128 a[224:227], v220
    ds_read_b128 a[228:231], v221
    ds_read_b128 a[232:235], v222
    ds_read_b128 a[236:239], v223
    v_mul_f32 v202, 1182793728, v200
    v_mul_f32 v203, 1182793728, v201
    v_mov_b32 v84, 0x7400
    v_mov_b32 v72, 1182793728
    v_cvt_pk_f16_f32 v92, v202, v203
    ds_write2st64_b32 v184, v84, v92 offset0:0 offset1:8
    s_add_u32 m0, s45, 0
    v_pk_mul_f32 v[80:81], v[242:243], v[72:73] op_sel_hi:[1,0]
    buffer_load_dwordx4 v6, s[12:15], s36 offen offset:0  lds
    buffer_load_dwordx4 v7, s[12:15], s36 offen offset:1024  lds
    v_pk_mul_f32 v[82:83], v[202:203], v[242:243] op_sel:[0,0] op_sel_hi:[0,1]
    v_pk_fma_f32 v[82:83], v[202:203], v[242:243], v[82:83] op_sel:[1,1,0] op_sel_hi:[1,0,1] neg_lo:[0,1,0]
    v_cvt_pk_f16_f32 v85, v80, v81
    v_cvt_pk_f16_f32 v93, v82, v83
    ds_write2st64_b32 v185, v85, v93 offset0:1 offset1:9
    v_pk_mul_f32 v[80:81], v[244:245], v[72:73] op_sel_hi:[1,0]
    v_pk_mul_f32 v[82:83], v[202:203], v[244:245] op_sel:[0,0] op_sel_hi:[0,1]
    v_pk_fma_f32 v[82:83], v[202:203], v[244:245], v[82:83] op_sel:[1,1,0] op_sel_hi:[1,0,1] neg_lo:[0,1,0]
    v_cvt_pk_f16_f32 v86, v80, v81
    v_cvt_pk_f16_f32 v94, v82, v83
    ds_write2st64_b32 v186, v86, v94 offset0:2 offset1:10
    v_pk_mul_f32 v[80:81], v[246:247], v[72:73] op_sel_hi:[1,0]
    v_pk_mul_f32 v[82:83], v[202:203], v[246:247] op_sel:[0,0] op_sel_hi:[0,1]
    v_pk_fma_f32 v[82:83], v[202:203], v[246:247], v[82:83] op_sel:[1,1,0] op_sel_hi:[1,0,1] neg_lo:[0,1,0]
    v_cvt_pk_f16_f32 v87, v80, v81
    v_cvt_pk_f16_f32 v95, v82, v83
    ds_write2st64_b32 v187, v87, v95 offset0:3 offset1:11
    v_pk_mul_f32 v[80:81], v[248:249], v[72:73] op_sel_hi:[1,0]
    v_pk_mul_f32 v[82:83], v[202:203], v[248:249] op_sel:[0,0] op_sel_hi:[0,1]
    v_pk_fma_f32 v[82:83], v[202:203], v[248:249], v[82:83] op_sel:[1,1,0] op_sel_hi:[1,0,1] neg_lo:[0,1,0]
    v_cvt_pk_f16_f32 v88, v80, v81
    v_cvt_pk_f16_f32 v96, v82, v83
    ds_write2st64_b32 v188, v88, v96 offset0:4 offset1:12
    v_pk_mul_f32 v[80:81], v[250:251], v[72:73] op_sel_hi:[1,0]
    v_pk_mul_f32 v[82:83], v[202:203], v[250:251] op_sel:[0,0] op_sel_hi:[0,1]
    s_add_u32 m0, s45, 0
    v_pk_fma_f32 v[82:83], v[202:203], v[250:251], v[82:83] op_sel:[1,1,0] op_sel_hi:[1,0,1] neg_lo:[0,1,0]
    buffer_load_dwordx4 v8, s[12:15], s36 offen offset:2048  lds
    buffer_load_dwordx4 v9, s[12:15], s36 offen offset:3072  lds
    v_cvt_pk_f16_f32 v89, v80, v81
    v_cvt_pk_f16_f32 v97, v82, v83
    ds_write2st64_b32 v189, v89, v97 offset0:5 offset1:13
    v_pk_mul_f32 v[80:81], v[252:253], v[72:73] op_sel_hi:[1,0]
    v_pk_mul_f32 v[82:83], v[202:203], v[252:253] op_sel:[0,0] op_sel_hi:[0,1]
    v_pk_fma_f32 v[82:83], v[202:203], v[252:253], v[82:83] op_sel:[1,1,0] op_sel_hi:[1,0,1] neg_lo:[0,1,0]
    v_cvt_pk_f16_f32 v90, v80, v81
    v_cvt_pk_f16_f32 v98, v82, v83
    ds_write2st64_b32 v190, v90, v98 offset0:6 offset1:14
    v_pk_mul_f32 v[80:81], v[254:255], v[72:73] op_sel_hi:[1,0]
    v_pk_mul_f32 v[82:83], v[202:203], v[254:255] op_sel:[0,0] op_sel_hi:[0,1]
    v_pk_fma_f32 v[82:83], v[202:203], v[254:255], v[82:83] op_sel:[1,1,0] op_sel_hi:[1,0,1] neg_lo:[0,1,0]
    v_cvt_pk_f16_f32 v91, v80, v81
    v_cvt_pk_f16_f32 v99, v82, v83
    ds_write2st64_b32 v191, v91, v99 offset0:7 offset1:15
    ds_read_b128 a[240:243], v220
    ds_read_b128 a[244:247], v221
    ds_read_b128 a[248:251], v222
    ds_read_b128 a[252:255], v223
    v_pk_mul_f32 v[204:205], v[202:203], v[200:201] op_sel:[0,0] op_sel_hi:[0,1]
    v_pk_fma_f32 v[204:205], v[202:203], v[200:201], v[204:205] op_sel:[1,1,0] op_sel_hi:[1,0,1] neg_lo:[0,1,0]
    v_cvt_pk_f16_f32 v84, v204, v205
    v_pk_mul_f32 v[80:81], v[204:205], v[244:245] op_sel:[0,0] op_sel_hi:[0,1]
    v_pk_fma_f32 v[80:81], v[204:205], v[244:245], v[80:81] op_sel:[1,1,0] op_sel_hi:[1,0,1] neg_lo:[0,1,0]
    v_cvt_pk_f16_f32 v85, v80, v81
    v_pk_mul_f32 v[80:81], v[204:205], v[248:249] op_sel:[0,0] op_sel_hi:[0,1]
    s_add_u32 m0, s45, 4096
    v_pk_fma_f32 v[80:81], v[204:205], v[248:249], v[80:81] op_sel:[1,1,0] op_sel_hi:[1,0,1] neg_lo:[0,1,0]
    buffer_load_dwordx4 v10, s[12:15], s36 offen offset:0  lds
    buffer_load_dwordx4 v11, s[12:15], s36 offen offset:1024  lds
    v_cvt_pk_f16_f32 v86, v80, v81
    v_pk_mul_f32 v[80:81], v[204:205], v[252:253] op_sel:[0,0] op_sel_hi:[0,1]
    v_pk_fma_f32 v[80:81], v[204:205], v[252:253], v[80:81] op_sel:[1,1,0] op_sel_hi:[1,0,1] neg_lo:[0,1,0]
    v_cvt_pk_f16_f32 v87, v80, v81
    v_pk_mul_f32 v[202:203], v[204:205], v[200:201] op_sel:[0,0] op_sel_hi:[0,1]
    v_pk_fma_f32 v[202:203], v[204:205], v[200:201], v[202:203] op_sel:[1,1,0] op_sel_hi:[1,0,1] neg_lo:[0,1,0]
    v_cvt_pk_f16_f32 v88, v202, v203
    v_pk_mul_f32 v[80:81], v[202:203], v[244:245] op_sel:[0,0] op_sel_hi:[0,1]
    v_pk_fma_f32 v[80:81], v[202:203], v[244:245], v[80:81] op_sel:[1,1,0] op_sel_hi:[1,0,1] neg_lo:[0,1,0]
    v_cvt_pk_f16_f32 v89, v80, v81
    v_pk_mul_f32 v[80:81], v[202:203], v[248:249] op_sel:[0,0] op_sel_hi:[0,1]
    v_pk_fma_f32 v[80:81], v[202:203], v[248:249], v[80:81] op_sel:[1,1,0] op_sel_hi:[1,0,1] neg_lo:[0,1,0]
    v_cvt_pk_f16_f32 v90, v80, v81
    v_pk_mul_f32 v[80:81], v[202:203], v[252:253] op_sel:[0,0] op_sel_hi:[0,1]
    v_pk_fma_f32 v[80:81], v[202:203], v[252:253], v[80:81] op_sel:[1,1,0] op_sel_hi:[1,0,1] neg_lo:[0,1,0]
    v_cvt_pk_f16_f32 v91, v80, v81
    s_waitcnt lgkmcnt(0)
    v_mfma_f32_16x16x32_f16 a[208:211], a[240:243], a[224:227], a[208:211]
    v_mfma_f32_16x16x32_f16 a[208:211], a[244:247], a[228:231], a[208:211]
    v_mfma_f32_16x16x32_f16 a[208:211], a[248:251], a[232:235], a[208:211]
    v_mfma_f32_16x16x32_f16 a[208:211], a[252:255], a[236:239], a[208:211]
    v_pk_mul_f32 v[204:205], v[202:203], v[200:201] op_sel:[0,0] op_sel_hi:[0,1]
    v_pk_fma_f32 v[204:205], v[202:203], v[200:201], v[204:205] op_sel:[1,1,0] op_sel_hi:[1,0,1] neg_lo:[0,1,0]
    v_cvt_pk_f16_f32 v92, v204, v205
    ds_write2st64_b32 v184, v84, v92 offset0:0 offset1:8
    v_pk_mul_f32 v[80:81], v[204:205], v[248:249] op_sel:[0,0] op_sel_hi:[0,1]
    s_add_u32 m0, s45, 4096
    v_pk_fma_f32 v[80:81], v[204:205], v[248:249], v[80:81] op_sel:[1,1,0] op_sel_hi:[1,0,1] neg_lo:[0,1,0]
    buffer_load_dwordx4 v12, s[12:15], s36 offen offset:2048  lds
    v_cvt_pk_f16_f32 v93, v80, v81
    ds_write2st64_b32 v185, v85, v93 offset0:1 offset1:9
    v_pk_mul_f32 v[202:203], v[204:205], v[200:201] op_sel:[0,0] op_sel_hi:[0,1]
    v_pk_fma_f32 v[202:203], v[204:205], v[200:201], v[202:203] op_sel:[1,1,0] op_sel_hi:[1,0,1] neg_lo:[0,1,0]
    v_cvt_pk_f16_f32 v94, v202, v203
    ds_write2st64_b32 v186, v86, v94 offset0:2 offset1:10
    v_pk_mul_f32 v[80:81], v[202:203], v[248:249] op_sel:[0,0] op_sel_hi:[0,1]
    v_pk_fma_f32 v[80:81], v[202:203], v[248:249], v[80:81] op_sel:[1,1,0] op_sel_hi:[1,0,1] neg_lo:[0,1,0]
    v_cvt_pk_f16_f32 v95, v80, v81
    ds_write2st64_b32 v187, v87, v95 offset0:3 offset1:11
    v_pk_mul_f32 v[204:205], v[202:203], v[200:201] op_sel:[0,0] op_sel_hi:[0,1]
    s_add_u32 m0, s45, 28672
    v_pk_fma_f32 v[204:205], v[202:203], v[200:201], v[204:205] op_sel:[1,1,0] op_sel_hi:[1,0,1] neg_lo:[0,1,0]
    buffer_load_dwordx4 v6, s[12:15], s37 offen offset:0  lds
    buffer_load_dwordx4 v7, s[12:15], s37 offen offset:1024  lds
    v_cvt_pk_f16_f32 v96, v204, v205
    ds_write2st64_b32 v188, v88, v96 offset0:4 offset1:12
    v_pk_mul_f32 v[80:81], v[204:205], v[248:249] op_sel:[0,0] op_sel_hi:[0,1]
    v_pk_fma_f32 v[80:81], v[204:205], v[248:249], v[80:81] op_sel:[1,1,0] op_sel_hi:[1,0,1] neg_lo:[0,1,0]
    v_cvt_pk_f16_f32 v97, v80, v81
    ds_write2st64_b32 v189, v89, v97 offset0:5 offset1:13
    v_pk_mul_f32 v[202:203], v[204:205], v[200:201] op_sel:[0,0] op_sel_hi:[0,1]
    v_pk_fma_f32 v[202:203], v[204:205], v[200:201], v[202:203] op_sel:[1,1,0] op_sel_hi:[1,0,1] neg_lo:[0,1,0]
    v_cvt_pk_f16_f32 v98, v202, v203
    ds_write2st64_b32 v190, v90, v98 offset0:6 offset1:14
    v_pk_mul_f32 v[80:81], v[202:203], v[248:249] op_sel:[0,0] op_sel_hi:[0,1]
    v_pk_fma_f32 v[80:81], v[202:203], v[248:249], v[80:81] op_sel:[1,1,0] op_sel_hi:[1,0,1] neg_lo:[0,1,0]
    v_cvt_pk_f16_f32 v99, v80, v81
    ds_write2st64_b32 v191, v91, v99 offset0:7 offset1:15
    ds_read_b128 a[240:243], v220
    ds_read_b128 a[244:247], v221
    ds_read_b128 a[248:251], v222
    ds_read_b128 a[252:255], v223
    v_pk_mul_f32 v[204:205], v[202:203], v[200:201] op_sel:[0,0] op_sel_hi:[0,1]
    v_pk_fma_f32 v[204:205], v[202:203], v[200:201], v[204:205] op_sel:[1,1,0] op_sel_hi:[1,0,1] neg_lo:[0,1,0]
    v_cvt_pk_f16_f32 v84, v204, v205
    ds_write_b32 v184, v84 offset:0
    v_pk_mul_f32 v[202:203], v[204:205], v[200:201] op_sel:[0,0] op_sel_hi:[0,1]
    s_add_u32 m0, s45, 28672
    v_pk_fma_f32 v[202:203], v[204:205], v[200:201], v[202:203] op_sel:[1,1,0] op_sel_hi:[1,0,1] neg_lo:[0,1,0]
    buffer_load_dwordx4 v8, s[12:15], s37 offen offset:2048  lds
    buffer_load_dwordx4 v9, s[12:15], s37 offen offset:3072  lds
    v_cvt_pk_f16_f32 v85, v202, v203
    ds_write_b32 v185, v85 offset:256
    v_pk_mul_f32 v[204:205], v[202:203], v[200:201] op_sel:[0,0] op_sel_hi:[0,1]
    v_pk_fma_f32 v[204:205], v[202:203], v[200:201], v[204:205] op_sel:[1,1,0] op_sel_hi:[1,0,1] neg_lo:[0,1,0]
    v_cvt_pk_f16_f32 v86, v204, v205
    ds_write_b32 v186, v86 offset:512
    v_pk_mul_f32 v[202:203], v[204:205], v[200:201] op_sel:[0,0] op_sel_hi:[0,1]
    v_pk_fma_f32 v[202:203], v[204:205], v[200:201], v[202:203] op_sel:[1,1,0] op_sel_hi:[1,0,1] neg_lo:[0,1,0]
    v_cvt_pk_f16_f32 v87, v202, v203
    ds_write_b32 v187, v87 offset:768
    v_pk_mul_f32 v[204:205], v[202:203], v[200:201] op_sel:[0,0] op_sel_hi:[0,1]
    v_pk_fma_f32 v[204:205], v[202:203], v[200:201], v[204:205] op_sel:[1,1,0] op_sel_hi:[1,0,1] neg_lo:[0,1,0]
    v_cvt_pk_f16_f32 v88, v204, v205
    ds_write_b32 v188, v88 offset:1024
    v_pk_mul_f32 v[202:203], v[204:205], v[200:201] op_sel:[0,0] op_sel_hi:[0,1]
    v_pk_fma_f32 v[202:203], v[204:205], v[200:201], v[202:203] op_sel:[1,1,0] op_sel_hi:[1,0,1] neg_lo:[0,1,0]
    v_cvt_pk_f16_f32 v89, v202, v203
    ds_write_b32 v189, v89 offset:1280
    s_waitcnt lgkmcnt(6)
    v_mfma_f32_16x16x32_f16 a[212:215], a[240:243], a[224:227], a[212:215]
    v_mfma_f32_16x16x32_f16 a[212:215], a[244:247], a[228:231], a[212:215]
    s_add_u32 m0, s45, 32768
    v_mfma_f32_16x16x32_f16 a[212:215], a[248:251], a[232:235], a[212:215]
    buffer_load_dwordx4 v10, s[12:15], s37 offen offset:0  lds
    buffer_load_dwordx4 v11, s[12:15], s37 offen offset:1024  lds
    v_mfma_f32_16x16x32_f16 a[212:215], a[252:255], a[236:239], a[212:215]
    v_pk_mul_f32 v[204:205], v[202:203], v[200:201] op_sel:[0,0] op_sel_hi:[0,1]
    v_pk_fma_f32 v[204:205], v[202:203], v[200:201], v[204:205] op_sel:[1,1,0] op_sel_hi:[1,0,1] neg_lo:[0,1,0]
    v_cvt_pk_f16_f32 v90, v204, v205
    ds_write_b32 v190, v90 offset:1536
    v_pk_mul_f32 v[202:203], v[204:205], v[200:201] op_sel:[0,0] op_sel_hi:[0,1]
    v_pk_fma_f32 v[202:203], v[204:205], v[200:201], v[202:203] op_sel:[1,1,0] op_sel_hi:[1,0,1] neg_lo:[0,1,0]
    v_cvt_pk_f16_f32 v91, v202, v203
    ds_write_b32 v191, v91 offset:1792
    v_pk_mul_f32 v[204:205], v[202:203], v[200:201] op_sel:[0,0] op_sel_hi:[0,1]
    v_pk_fma_f32 v[204:205], v[202:203], v[200:201], v[204:205] op_sel:[1,1,0] op_sel_hi:[1,0,1] neg_lo:[0,1,0]
    v_cvt_pk_f16_f32 v92, v204, v205
    ds_write_b32 v184, v92 offset:2048
    ds_read_b128 a[240:243], v220
    ds_read_b128 a[244:247], v221
    s_lshl2_add_u32 s90, s4, s3
    s_mul_i32 s90, s90, 28
    s_lshr_b32 s91, s5, 1
    s_mul_i32 s91, s91, 7
    s_add_u32 s90, s90, s91
    s_lshl_b32 s90, s90, 10
    s_add_u32 s90, s90, 12582912
    s_and_b32 s92, s5, 1
    s_lshl_b32 s91, s92, 12
    s_add_u32 s72, s91, s90
    s_lshl_b32 s92, s92, 9
    s_add_u32 s73, s92, s90
    v_mov_b32 v180, -1
    v_mov_b32 v181, -1
    v_mov_b32 v182, -1
    v_mov_b32 v183, -1
    v_and_b32 v226, 0x1f0, v233
    buffer_store_dwordx4 v[180:183], v233, s[24:27], s72 offen sc1
    buffer_store_dwordx4 v[180:183], v233, s[24:27], s72 offen offset:1024 sc1
    buffer_store_dwordx4 v[180:183], v233, s[24:27], s72 offen offset:2048 sc1
    buffer_store_dwordx4 v[180:183], v226, s[24:27], s73 offen offset:3072 sc1
    s_mul_i32 s90, s48, 57344
    s_lshl2_add_u32 s91, s49, s3
    s_lshl_b32 s91, s91, 11
    s_add_u32 s90, s90, s91
    s_cmp_eq_u32 s49, 7
    s_mov_b32 s91, 8388608
    s_cselect_b32 s91, 25165824, s91
    s_add_u32 s90, s90, s91
    buffer_store_dwordx4 v[180:183], v233, s[24:27], s90 offen sc1
    buffer_store_dwordx4 v[180:183], v233, s[24:27], s90 offen offset:1024 sc1
    buffer_load_dword v207, v206, s[32:35], 0 offen sc1
    ds_read_b128 a[248:251], v222
    ds_read_b128 a[252:255], v223
    s_lshr_b32 s56, s3, 1
    s_mul_i32 s57, s56, 3072
    s_add_u32 s57, s57, 157696
    v_add_u32 v196, s57, v233
    s_add_u32 m0, s45, 32768
    s_waitcnt lgkmcnt(0)
    buffer_load_dwordx4 v12, s[12:15], s37 offen offset:2048  lds
    v_mfma_f32_16x16x32_f16 a[216:219], a[240:243], a[224:227], a[216:219]
    v_mfma_f32_16x16x32_f16 a[216:219], a[244:247], a[228:231], a[216:219]
    v_mfma_f32_16x16x32_f16 a[216:219], a[248:251], a[232:235], a[216:219]
    v_mfma_f32_16x16x32_f16 a[216:219], a[252:255], a[236:239], a[216:219]
    s_waitcnt vmcnt(36)
    ds_read_b128 v[16:19], v4 offset:0
    ds_read_b128 v[20:23], v5 offset:0
    s_waitcnt vmcnt(34)
    ds_read_b128 v[24:27], v4 offset:2048
    ds_read_b128 v[28:31], v5 offset:2048
    s_bitcmp1_b32 s3, 0
    s_cbranch_scc1 L_kg_odd
    ds_write_b128 v196, a[208:211] offset:0
    ds_write_b128 v196, a[212:215] offset:1024
    ds_write_b128 v196, a[216:219] offset:2048
    s_waitcnt lgkmcnt(0)
    s_branch L_kg_j
L_kg_odd:
    v_accvgpr_read_b32 v184, a208
    v_accvgpr_read_b32 v185, a209
    v_accvgpr_read_b32 v186, a210
    v_accvgpr_read_b32 v187, a211
    v_accvgpr_read_b32 v188, a212
    v_accvgpr_read_b32 v189, a213
    v_accvgpr_read_b32 v190, a214
    v_accvgpr_read_b32 v191, a215
    v_accvgpr_read_b32 v192, a216
    v_accvgpr_read_b32 v193, a217
    v_accvgpr_read_b32 v194, a218
    v_accvgpr_read_b32 v195, a219
L_kg_j:
    s_waitcnt vmcnt(29)
    ds_read_b128 v[32:35], v4 offset:4096
    ds_read_b128 v[36:39], v5 offset:4096
    s_waitcnt lgkmcnt(5)
    s_cmp_ge_u32 s3, 2
    s_cbranch_scc1 L_hc_2
    s_add_u32 m0, s45, 57344
    s_nop 0
    buffer_load_dwordx4 v6, s[12:15], s38 offen offset:0  lds
    buffer_load_dwordx4 v7, s[12:15], s38 offen offset:1024  lds
    buffer_load_dwordx4 v8, s[12:15], s38 offen offset:2048  lds
    buffer_load_dwordx4 v9, s[12:15], s38 offen offset:3072  lds
L_hc_2:
    v_mfma_f32_16x16x32_bf16 v[116:119], v[112:115], v[16:19], 0
    s_min_u32 s56, s49, 6
    s_lshl_b32 s57, s56, 7
    v_mfma_f32_16x16x32_bf16 v[120:123], v[16:19], v[16:19], 0
    s_lshl2_add_u32 s61, s48, s3
    s_waitcnt lgkmcnt(4)
    v_mfma_f32_16x16x32_bf16 v[116:119], v[112:115], v[20:23], v[116:119]
    s_mul_i32 s76, s61, 14336
    s_add_u32 s76, s76, s57
    v_mfma_f32_16x16x32_bf16 v[120:123], v[20:23], v[20:23], v[120:123]
    s_and_b32 s58, s3, 1
    s_waitcnt vmcnt(27)
    ds_read_b128 v[40:43], v4 offset:6144
    ds_read_b128 v[44:47], v5 offset:6144
    s_waitcnt lgkmcnt(5)
    v_mfma_f32_16x16x32_bf16 v[116:119], v[112:115], v[24:27], v[116:119]
    s_lshl_b32 s77, s58, 7
    s_lshr_b32 s62, s46, 5
    v_mfma_f32_16x16x32_bf16 v[120:123], v[24:27], v[24:27], v[120:123]
    s_add_u32 s77, s77, s62
    s_waitcnt lgkmcnt(4)
    v_mfma_f32_16x16x32_bf16 v[116:119], v[112:115], v[28:31], v[116:119]
    s_lshl_b32 s77, s77, 5
    s_bfe_u32 s62, s46, 0x20003
    v_mfma_f32_16x16x32_bf16 v[120:123], v[28:31], v[28:31], v[120:123]
    s_add_u32 s77, s77, s62
    s_waitcnt vmcnt(25)
    ds_read_b128 v[48:51], v4 offset:8192
    ds_read_b128 v[52:55], v5 offset:8192
    s_waitcnt lgkmcnt(5)
    v_mfma_f32_16x16x32_bf16 v[116:119], v[112:115], v[32:35], v[116:119]
    s_lshl_b32 s77, s77, 2
    s_add_u32 s77, s77, 98304
    s_cmp_ge_u32 s3, 2
    s_cbranch_scc1 L_hc_3
    s_add_u32 m0, s45, 61440
    s_nop 0
    buffer_load_dwordx4 v10, s[12:15], s38 offen offset:0  lds
    buffer_load_dwordx4 v11, s[12:15], s38 offen offset:1024  lds
    buffer_load_dwordx4 v12, s[12:15], s38 offen offset:2048  lds
L_hc_3:
    v_mfma_f32_16x16x32_bf16 v[120:123], v[32:35], v[32:35], v[120:123]
    s_lshl_b32 s78, s56, 8
    s_waitcnt lgkmcnt(4)
    v_mfma_f32_16x16x32_bf16 v[116:119], v[112:115], v[36:39], v[116:119]
    s_add_u32 s78, s78, s3
    s_lshl_b32 s78, s78, 5
    v_mfma_f32_16x16x32_bf16 v[120:123], v[36:39], v[36:39], v[120:123]
    s_mul_i32 s62, s48, 57344
    s_waitcnt vmcnt(23)
    ds_read_b128 v[56:59], v4 offset:10240
    ds_read_b128 v[60:63], v5 offset:10240
    s_waitcnt lgkmcnt(5)
    v_mfma_f32_16x16x32_bf16 v[116:119], v[112:115], v[40:43], v[116:119]
    s_add_u32 s78, s78, s62
    s_add_u32 s78, s78, 8388608
    v_mfma_f32_16x16x32_bf16 v[120:123], v[40:43], v[40:43], v[120:123]
    s_add_u32 s89, s78, 4096
    s_waitcnt lgkmcnt(4)
    v_mfma_f32_16x16x32_bf16 v[116:119], v[112:115], v[44:47], v[116:119]
    s_mul_i32 s62, s61, 28672
    s_add_u32 s79, s62, 12582908
    v_mfma_f32_16x16x32_bf16 v[120:123], v[44:47], v[44:47], v[120:123]
    s_add_u32 s80, s62, 12582912
    s_waitcnt vmcnt(21)
    ds_read_b128 v[64:67], v4 offset:12288
    ds_read_b128 v[68:71], v5 offset:12288
    s_add_u32 m0, s45, 71680
    s_waitcnt lgkmcnt(5)
    buffer_load_dwordx4 v6, s[12:15], s39 offen offset:0  lds
    buffer_load_dwordx4 v7, s[12:15], s39 offen offset:1024  lds
    v_mfma_f32_16x16x32_bf16 v[116:119], v[112:115], v[48:51], v[116:119]
    s_add_u32 s81, s62, 12587008
    s_add_u32 s82, s62, 12591104
    v_mfma_f32_16x16x32_bf16 v[120:123], v[48:51], v[48:51], v[120:123]
    s_add_u32 s83, s62, 12595200
    s_waitcnt lgkmcnt(4)
    v_mfma_f32_16x16x32_bf16 v[116:119], v[112:115], v[52:55], v[116:119]
    s_add_u32 s84, s62, 12599296
    s_add_u32 s85, s62, 12603392
    v_mfma_f32_16x16x32_bf16 v[120:123], v[52:55], v[52:55], v[120:123]
    s_add_u32 s86, s62, 12607488
    s_waitcnt lgkmcnt(3)
    v_mfma_f32_16x16x32_bf16 v[116:119], v[112:115], v[56:59], v[116:119]
    s_lshl_b32 s62, s48, 8
    s_add_u32 s62, s62, s3
    v_mfma_f32_16x16x32_bf16 v[120:123], v[56:59], v[56:59], v[120:123]
    s_lshl_b32 s62, s62, 2
    s_waitcnt lgkmcnt(2)
    v_mfma_f32_16x16x32_bf16 v[116:119], v[112:115], v[60:63], v[116:119]
    s_add_u32 s93, s62, 32768
    v_mfma_f32_16x16x32_bf16 v[120:123], v[60:63], v[60:63], v[120:123]
    s_waitcnt lgkmcnt(1)
    v_mfma_f32_16x16x32_bf16 v[116:119], v[112:115], v[64:67], v[116:119]
    v_mfma_f32_16x16x32_bf16 v[120:123], v[64:67], v[64:67], v[120:123]
    s_waitcnt lgkmcnt(0)
    v_mfma_f32_16x16x32_bf16 v[116:119], v[112:115], v[68:71], v[116:119]
    v_mfma_f32_16x16x32_bf16 v[120:123], v[68:71], v[68:71], v[120:123]
    s_mov_b32 s58, 0x00100001
    s_mov_b32 s59, 0x10000100
    v_mov_b32 v101, 0
    v_lshrrev_b32 v103, 4, v1
    v_lshlrev_b32 v103, 4, v103
    s_nop 1
    v_mul_f32 v100, 991054117, v116
    v_cvt_pk_bf16_f32 v124, -v100, -v100
    v_and_b32 v124, s54, v124
    v_mov_b32 v125, v124
    v_mov_b32 v126, v124
    v_mov_b32 v127, v124
    s_nop 1
    v_mfma_f32_16x16x32_bf16 v[128:131], v[172:175], v[16:19], v[124:127]
    v_cndmask_b32 v101, v101, v120, s[58:59]
    v_mfma_f32_16x16x32_bf16 v[132:135], v[176:179], v[16:19], v[124:127]
    s_lshl_b64 s[58:59], s[58:59], 1
    v_mfma_f32_16x16x32_bf16 v[136:139], v[172:175], v[20:23], v[124:127]
    v_cndmask_b32 v101, v101, v121, s[58:59]
    v_mfma_f32_16x16x32_bf16 v[140:143], v[176:179], v[20:23], v[124:127]
    s_lshl_b64 s[58:59], s[58:59], 1
    s_nop 0
    v_cvt_pk_bf16_f32 v16, v128, v129
    v_cvt_pk_bf16_f32 v17, v130, v131
    v_cvt_pk_bf16_f32 v18, v132, v133
    v_cvt_pk_bf16_f32 v19, v134, v135
    v_mfma_f32_16x16x32_bf16 v[144:147], v[172:175], v[24:27], v[124:127]
    v_cndmask_b32 v101, v101, v122, s[58:59]
    v_mfma_f32_16x16x32_bf16 v[148:151], v[176:179], v[24:27], v[124:127]
    s_lshl_b64 s[58:59], s[58:59], 1
    v_cvt_pk_bf16_f32 v20, v136, v137
    v_cvt_pk_bf16_f32 v21, v138, v139
    v_cvt_pk_bf16_f32 v22, v140, v141
    v_cvt_pk_bf16_f32 v23, v142, v143
    v_mfma_f32_16x16x32_bf16 v[128:131], v[172:175], v[28:31], v[124:127]
    v_cndmask_b32 v101, v101, v123, s[58:59]
    v_mfma_f32_16x16x32_bf16 v[132:135], v[176:179], v[28:31], v[124:127]
    v_mov_b32 v102, v101
    v_cvt_pk_bf16_f32 v24, v144, v145
    v_cvt_pk_bf16_f32 v25, v146, v147
    v_cvt_pk_bf16_f32 v26, v148, v149
    v_cvt_pk_bf16_f32 v27, v150, v151
    v_mfma_f32_16x16x32_bf16 v[136:139], v[172:175], v[32:35], v[124:127]
    v_permlane16_swap_b32 v101, v102
    v_mfma_f32_16x16x32_bf16 v[140:143], v[176:179], v[32:35], v[124:127]
    v_add_f32 v101, v101, v102
    v_cvt_pk_bf16_f32 v28, v128, v129
    v_cvt_pk_bf16_f32 v29, v130, v131
    v_cvt_pk_bf16_f32 v30, v132, v133
    v_cvt_pk_bf16_f32 v31, v134, v135
    v_mfma_f32_16x16x32_bf16 v[144:147], v[172:175], v[36:39], v[124:127]
    v_mov_b32 v102, v101
    v_mfma_f32_16x16x32_bf16 v[148:151], v[176:179], v[36:39], v[124:127]
    s_nop 0
    v_permlane32_swap_b32 v101, v102
    v_cvt_pk_bf16_f32 v32, v136, v137
    v_cvt_pk_bf16_f32 v33, v138, v139
    v_cvt_pk_bf16_f32 v34, v140, v141
    v_cvt_pk_bf16_f32 v35, v142, v143
    v_mfma_f32_16x16x32_bf16 v[128:131], v[172:175], v[40:43], v[124:127]
    v_add_f32 v101, v101, v102
    v_mfma_f32_16x16x32_bf16 v[132:135], v[176:179], v[40:43], v[124:127]
    v_mul_f32 v101, 991054117, v101
    v_cvt_pk_bf16_f32 v36, v144, v145
    v_cvt_pk_bf16_f32 v37, v146, v147
    v_cvt_pk_bf16_f32 v38, v148, v149
    v_cvt_pk_bf16_f32 v39, v150, v151
    v_mfma_f32_16x16x32_bf16 v[136:139], v[172:175], v[44:47], v[124:127]
    v_fma_f32 v101, -v100, v100, v101
    v_mfma_f32_16x16x32_bf16 v[140:143], v[176:179], v[44:47], v[124:127]
    v_max_f32 v101, 0, v101
    v_cvt_pk_bf16_f32 v40, v128, v129
    v_cvt_pk_bf16_f32 v41, v130, v131
    v_cvt_pk_bf16_f32 v42, v132, v133
    v_cvt_pk_bf16_f32 v43, v134, v135
    v_mfma_f32_16x16x32_bf16 v[144:147], v[172:175], v[48:51], v[124:127]
    v_cvt_pk_bf16_f32 v101, v101, v101
    v_mfma_f32_16x16x32_bf16 v[148:151], v[176:179], v[48:51], v[124:127]
    v_and_b32 v101, s54, v101
    v_cvt_pk_bf16_f32 v44, v136, v137
    v_cvt_pk_bf16_f32 v45, v138, v139
    v_cvt_pk_bf16_f32 v46, v140, v141
    v_cvt_pk_bf16_f32 v47, v142, v143
    v_mfma_f32_16x16x32_bf16 v[128:131], v[172:175], v[52:55], v[124:127]
    v_add_f32 v101, 925353388, v101
    v_mfma_f32_16x16x32_bf16 v[132:135], v[176:179], v[52:55], v[124:127]
    v_cvt_pk_bf16_f32 v101, v101, v101
    v_cvt_pk_bf16_f32 v48, v144, v145
    v_cvt_pk_bf16_f32 v49, v146, v147
    v_cvt_pk_bf16_f32 v50, v148, v149
    v_cvt_pk_bf16_f32 v51, v150, v151
    v_mfma_f32_16x16x32_bf16 v[136:139], v[172:175], v[56:59], v[124:127]
    v_and_b32 v101, s54, v101
    v_mfma_f32_16x16x32_bf16 v[140:143], v[176:179], v[56:59], v[124:127]
    v_sqrt_f32 v101, v101
    v_cvt_pk_bf16_f32 v52, v128, v129
    v_cvt_pk_bf16_f32 v53, v130, v131
    v_cvt_pk_bf16_f32 v54, v132, v133
    v_cvt_pk_bf16_f32 v55, v134, v135
    v_mfma_f32_16x16x32_bf16 v[144:147], v[172:175], v[60:63], v[124:127]
    v_cvt_pk_bf16_f32 v101, v101, v101
    v_mfma_f32_16x16x32_bf16 v[148:151], v[176:179], v[60:63], v[124:127]
    v_and_b32 v101, s54, v101
    v_cvt_pk_bf16_f32 v56, v136, v137
    v_cvt_pk_bf16_f32 v57, v138, v139
    v_cvt_pk_bf16_f32 v58, v140, v141
    v_cvt_pk_bf16_f32 v59, v142, v143
    v_mfma_f32_16x16x32_bf16 v[128:131], v[172:175], v[64:67], v[124:127]
    v_rcp_f32 v2, v101
    v_mfma_f32_16x16x32_bf16 v[132:135], v[176:179], v[64:67], v[124:127]
    v_fma_f32 v101, -v101, v2, 1.0
    v_cvt_pk_bf16_f32 v60, v144, v145
    v_cvt_pk_bf16_f32 v61, v146, v147
    v_cvt_pk_bf16_f32 v62, v148, v149
    v_cvt_pk_bf16_f32 v63, v150, v151
    v_mfma_f32_16x16x32_bf16 v[136:139], v[172:175], v[68:71], v[124:127]
    v_fma_f32 v2, v101, v2, v2
    v_mfma_f32_16x16x32_bf16 v[140:143], v[176:179], v[68:71], v[124:127]
    ds_bpermute_b32 v234, v103, v2 offset:0
    v_cvt_pk_bf16_f32 v64, v128, v129
    v_cvt_pk_bf16_f32 v65, v130, v131
    v_cvt_pk_bf16_f32 v66, v132, v133
    v_cvt_pk_bf16_f32 v67, v134, v135
    ds_bpermute_b32 v235, v103, v2 offset:4
    ds_bpermute_b32 v236, v103, v2 offset:8
    ds_bpermute_b32 v237, v103, v2 offset:12
    v_cvt_pk_bf16_f32 v68, v136, v137
    v_cvt_pk_bf16_f32 v69, v138, v139
    v_cvt_pk_bf16_f32 v70, v140, v141
    s_add_u32 m0, s45, 71680
    v_cvt_pk_bf16_f32 v71, v142, v143
    buffer_load_dwordx4 v8, s[12:15], s39 offen offset:2048  lds
    buffer_load_dwordx4 v9, s[12:15], s39 offen offset:3072  lds
    v_mfma_f32_16x16x32_bf16 v[128:131], v[16:19], v[168:171], 0
    v_mfma_f32_16x16x32_bf16 v[132:135], v[16:19], v[166:169], 0
    v_mfma_f32_16x16x32_bf16 v[136:139], v[20:23], v[168:171], 0
    v_mfma_f32_16x16x32_bf16 v[140:143], v[20:23], v[166:169], 0
    v_lshrrev_b32 v164, 5, v1
    v_mul_u32_u24 v164, 7168, v164
    v_and_b32 v165, 31, v1
    v_lshl_add_u32 v164, v165, 4, v164
    s_lshl2_add_u32 s56, s4, s3
    s_mul_i32 s56, s56, 14336
    s_add_u32 s56, s56, 1048576
    s_lshl_b32 s57, s6, 10
    s_add_u32 s57, s57, s56
    s_waitcnt lgkmcnt(0)
    v_pk_mul_f32 v[128:129], v[128:129], v[234:235]
    v_cvt_pk_bf16_f32 v129, v128, v129
    v_lshlrev_b32 v128, 16, v129
    v_and_b32 v129, s54, v129
    v_cvt_pk_f16_f32 v156, v128, v129
    v_pk_mul_f32 v[130:131], v[130:131], v[236:237]
    v_cvt_pk_bf16_f32 v131, v130, v131
    v_lshlrev_b32 v130, 16, v131
    v_and_b32 v131, s54, v131
    v_cvt_pk_f16_f32 v157, v130, v131
    v_pk_mul_f32 v[132:133], v[132:133], v[234:235]
    v_cvt_pk_bf16_f32 v133, v132, v133
    v_lshlrev_b32 v132, 16, v133
    v_and_b32 v133, s54, v133
    v_cvt_pk_f16_f32 v158, v132, v133
    v_pk_mul_f32 v[134:135], v[134:135], v[236:237]
    v_cvt_pk_bf16_f32 v135, v134, v135
    v_lshlrev_b32 v134, 16, v135
    v_and_b32 v135, s54, v135
    s_add_u32 m0, s45, 75776
    v_cvt_pk_f16_f32 v159, v134, v135
    buffer_load_dwordx4 v10, s[12:15], s39 offen offset:0  lds
    buffer_load_dwordx4 v11, s[12:15], s39 offen offset:1024  lds
    v_pk_mul_f32 v[136:137], v[136:137], v[234:235]
    v_cvt_pk_bf16_f32 v137, v136, v137
    v_lshlrev_b32 v136, 16, v137
    v_and_b32 v137, s54, v137
    v_cvt_pk_f16_f32 v160, v136, v137
    v_pk_mul_f32 v[138:139], v[138:139], v[236:237]
    v_cvt_pk_bf16_f32 v139, v138, v139
    v_lshlrev_b32 v138, 16, v139
    v_and_b32 v139, s54, v139
    v_cvt_pk_f16_f32 v161, v138, v139
    v_pk_mul_f32 v[140:141], v[140:141], v[234:235]
    v_cvt_pk_bf16_f32 v141, v140, v141
    v_lshlrev_b32 v140, 16, v141
    v_and_b32 v141, s54, v141
    v_cvt_pk_f16_f32 v162, v140, v141
    v_pk_mul_f32 v[142:143], v[142:143], v[236:237]
    v_cvt_pk_bf16_f32 v143, v142, v143
    v_lshlrev_b32 v142, 16, v143
    v_and_b32 v143, s54, v143
    v_cvt_pk_f16_f32 v163, v142, v143
    v_permlane16_swap_b32 v156, v158
    v_permlane16_swap_b32 v157, v159
    v_permlane16_swap_b32 v160, v162
    v_permlane16_swap_b32 v161, v163
    buffer_store_dwordx4 v[156:159], v164, s[24:27], s57 offen offset:0 sc1
    buffer_store_dwordx4 v[160:163], v164, s[24:27], s57 offen offset:512 sc1
    s_waitcnt vmcnt(22)
    s_barrier
    ds_read_b64_tr_b16 v[72:73], v13 offset:0
    ds_read_b64_tr_b16 v[74:75], v13 offset:1792
    ds_read_b64_tr_b16 v[76:77], v13 offset:32
    ds_read_b64_tr_b16 v[78:79], v13 offset:1824
    ds_read_b64_tr_b16 v[80:81], v13 offset:64
    ds_read_b64_tr_b16 v[82:83], v13 offset:1856
    ds_read_b64_tr_b16 v[84:85], v13 offset:96
    ds_read_b64_tr_b16 v[86:87], v13 offset:1888
    ds_read_b64_tr_b16 v[88:89], v13 offset:128
    s_add_u32 m0, s45, 75776
    ds_read_b64_tr_b16 v[90:91], v13 offset:1920
    buffer_load_dwordx4 v12, s[12:15], s39 offen offset:2048  lds
    ds_read_b64_tr_b16 v[92:93], v13 offset:160
    ds_read_b64_tr_b16 v[94:95], v13 offset:1952
    ds_read_b64_tr_b16 v[96:97], v13 offset:192
    ds_read_b64_tr_b16 v[98:99], v13 offset:1984
    s_waitcnt lgkmcnt(6)
    v_mfma_f32_16x16x32_bf16 v[128:131], v[16:19], v[72:75], 0
    ds_read_b64_tr_b16 v[100:101], v13 offset:7168
    ds_read_b64_tr_b16 v[102:103], v13 offset:8960
    v_mfma_f32_16x16x32_bf16 v[132:135], v[16:19], v[76:79], 0
    ds_read_b64_tr_b16 v[104:105], v13 offset:7200
    ds_read_b64_tr_b16 v[106:107], v13 offset:8992
    s_xor_b32 s95, s7, 0
    s_lshl_b32 s95, s95, 6
    s_add_u32 m0, s44, 6144
    s_add_u32 s95, s95, s94
    buffer_load_dwordx4 v224, s[16:19], s95 offen offset:0  lds
    buffer_load_dwordx4 v225, s[16:19], s95 offen offset:1024  lds
    v_mfma_f32_16x16x32_bf16 v[136:139], v[16:19], v[80:83], 0
    ds_read_b64_tr_b16 v[108:109], v13 offset:7232
    ds_read_b64_tr_b16 v[110:111], v13 offset:9024
    v_mfma_f32_16x16x32_bf16 v[140:143], v[16:19], v[84:87], 0
    ds_read_b64_tr_b16 v[112:113], v13 offset:7264
    ds_read_b64_tr_b16 v[114:115], v13 offset:9056
    s_waitcnt lgkmcnt(8)
    v_mfma_f32_16x16x32_bf16 v[144:147], v[16:19], v[88:91], 0
    ds_read_b64_tr_b16 v[116:117], v13 offset:7296
    ds_read_b64_tr_b16 v[118:119], v13 offset:9088
    v_mfma_f32_16x16x32_bf16 v[148:151], v[16:19], v[92:95], 0
    ds_read_b64_tr_b16 v[120:121], v13 offset:7328
    ds_read_b64_tr_b16 v[122:123], v13 offset:9120
    s_add_u32 m0, s44, 8192
    s_xor_b32 s95, s95, 65536
    buffer_load_dwordx4 v224, s[16:19], s95 offen offset:0  lds
    buffer_load_dwordx4 v225, s[16:19], s95 offen offset:1024  lds
    v_mfma_f32_16x16x32_bf16 v[152:155], v[16:19], v[96:99], 0
    ds_read_b64_tr_b16 v[124:125], v13 offset:7360
    ds_read_b64_tr_b16 v[126:127], v13 offset:9152
    s_waitcnt lgkmcnt(6)
    v_mfma_f32_16x16x32_bf16 v[128:131], v[20:23], v[100:103], v[128:131]
    ds_read_b64_tr_b16 v[72:73], v13 offset:14336
    ds_read_b64_tr_b16 v[74:75], v13 offset:16128
    v_mfma_f32_16x16x32_bf16 v[132:135], v[20:23], v[104:107], v[132:135]
    ds_read_b64_tr_b16 v[76:77], v13 offset:14368
    ds_read_b64_tr_b16 v[78:79], v13 offset:16160
    v_mfma_f32_16x16x32_bf16 v[136:139], v[20:23], v[108:111], v[136:139]
    ds_read_b64_tr_b16 v[80:81], v13 offset:14400
    ds_read_b64_tr_b16 v[82:83], v13 offset:16192
    s_add_u32 m0, s44, 10240
    s_xor_b32 s95, s95, 196608
    buffer_load_dwordx4 v224, s[16:19], s95 offen offset:0  lds
    buffer_load_dwordx4 v225, s[16:19], s95 offen offset:1024  lds
    v_mfma_f32_16x16x32_bf16 v[140:143], v[20:23], v[112:115], v[140:143]
    ds_read_b64_tr_b16 v[84:85], v13 offset:14432
    ds_read_b64_tr_b16 v[86:87], v13 offset:16224
    s_waitcnt lgkmcnt(8)
    v_mfma_f32_16x16x32_bf16 v[144:147], v[20:23], v[116:119], v[144:147]
    ds_read_b64_tr_b16 v[88:89], v13 offset:14464
    ds_read_b64_tr_b16 v[90:91], v13 offset:16256
    v_mfma_f32_16x16x32_bf16 v[148:151], v[20:23], v[120:123], v[148:151]
    ds_read_b64_tr_b16 v[92:93], v13 offset:14496
    ds_read_b64_tr_b16 v[94:95], v13 offset:16288
    v_mfma_f32_16x16x32_bf16 v[152:155], v[20:23], v[124:127], v[152:155]
    ds_read_b64_tr_b16 v[96:97], v13 offset:14528
    ds_read_b64_tr_b16 v[98:99], v13 offset:16320
    s_add_u32 m0, s44, 12288
    s_xor_b32 s95, s95, 65536
    buffer_load_dwordx4 v224, s[16:19], s95 offen offset:0  lds
    buffer_load_dwordx4 v225, s[16:19], s95 offen offset:1024  lds
    v_lshlrev_b32 v208, 2, v1
    s_lshl2_add_u32 s56, s4, s3
    s_lshl_b32 s56, s56, 11
    s_add_u32 s64, s56, 262144
    s_lshl_b32 s57, s5, 8
    s_add_u32 s65, s64, s57
    v_bfe_u32 v209, v1, 1, 3
    v_lshlrev_b32 v209, 8, v209
    v_lshrrev_b32 v210, 4, v1
    v_lshl_add_u32 v209, v210, 6, v209
    v_and_b32 v210, 1, v1
    v_lshl_add_u32 v209, v210, 5, v209
    s_waitcnt lgkmcnt(6)
    v_mfma_f32_16x16x32_bf16 v[128:131], v[24:27], v[72:75], v[128:131]
    ds_read_b64_tr_b16 v[100:101], v13 offset:21504
    ds_read_b64_tr_b16 v[102:103], v13 offset:23296
    s_xor_b32 s95, s7, 2
    s_lshl_b32 s95, s95, 6
    s_add_u32 m0, s44, 4096
    s_add_u32 s95, s95, s94
    buffer_load_dwordx4 v224, s[16:19], s95 offen offset:0  lds
    buffer_load_dwordx4 v225, s[16:19], s95 offen offset:1024  lds
    v_mfma_f32_16x16x32_bf16 v[132:135], v[24:27], v[76:79], v[132:135]
    ds_read_b64_tr_b16 v[104:105], v13 offset:21536
    ds_read_b64_tr_b16 v[106:107], v13 offset:23328
    v_mfma_f32_16x16x32_bf16 v[136:139], v[24:27], v[80:83], v[136:139]
    ds_read_b64_tr_b16 v[108:109], v13 offset:21568
    ds_read_b64_tr_b16 v[110:111], v13 offset:23360
    v_mfma_f32_16x16x32_bf16 v[140:143], v[24:27], v[84:87], v[140:143]
    ds_read_b64_tr_b16 v[112:113], v13 offset:21600
    ds_read_b64_tr_b16 v[114:115], v13 offset:23392
    s_waitcnt lgkmcnt(8)
    v_mfma_f32_16x16x32_bf16 v[144:147], v[24:27], v[88:91], v[144:147]
    ds_read_b64_tr_b16 v[116:117], v13 offset:21632
    ds_read_b64_tr_b16 v[118:119], v13 offset:23424
    v_mfma_f32_16x16x32_bf16 v[148:151], v[24:27], v[92:95], v[148:151]
    ds_read_b64_tr_b16 v[120:121], v13 offset:21664
    ds_read_b64_tr_b16 v[122:123], v13 offset:23456
    v_mfma_f32_16x16x32_bf16 v[152:155], v[24:27], v[96:99], v[152:155]
    ds_read_b64_tr_b16 v[124:125], v13 offset:21696
    ds_read_b64_tr_b16 v[126:127], v13 offset:23488
    s_waitcnt vmcnt(19)
    s_barrier
    s_waitcnt lgkmcnt(6)
    v_mfma_f32_16x16x32_bf16 v[128:131], v[28:31], v[100:103], v[128:131]
    ds_read_b64_tr_b16 v[72:73], v13 offset:28672
    ds_read_b64_tr_b16 v[74:75], v13 offset:30464
    s_waitcnt vmcnt(8)
    ds_read_b128 a[0:3], v4 offset:6144
    ds_read_b128 a[64:67], v5 offset:6144
    v_mfma_f32_16x16x32_bf16 v[132:135], v[28:31], v[104:107], v[132:135]
    ds_read_b64_tr_b16 v[76:77], v13 offset:28704
    ds_read_b64_tr_b16 v[78:79], v13 offset:30496
    v_mfma_f32_16x16x32_bf16 v[136:139], v[28:31], v[108:111], v[136:139]
    ds_read_b64_tr_b16 v[80:81], v13 offset:28736
    ds_read_b64_tr_b16 v[82:83], v13 offset:30528
    v_mfma_f32_16x16x32_bf16 v[140:143], v[28:31], v[112:115], v[140:143]
    ds_read_b64_tr_b16 v[84:85], v13 offset:28768
    ds_read_b64_tr_b16 v[86:87], v13 offset:30560
    s_waitcnt lgkmcnt(10)
    v_mfma_f32_16x16x32_bf16 v[144:147], v[28:31], v[116:119], v[144:147]
    ds_read_b64_tr_b16 v[88:89], v13 offset:28800
    ds_read_b64_tr_b16 v[90:91], v13 offset:30592
    s_waitcnt vmcnt(6)
    ds_read_b128 a[4:7], v4 offset:8192
    ds_read_b128 a[68:71], v5 offset:8192
    v_mfma_f32_16x16x32_bf16 v[148:151], v[28:31], v[120:123], v[148:151]
    ds_read_b64_tr_b16 v[92:93], v13 offset:28832
    ds_read_b64_tr_b16 v[94:95], v13 offset:30624
    s_waitcnt lgkmcnt(12)
    s_add_u32 m0, s44, 6144
    s_xor_b32 s95, s95, 65536
    buffer_load_dwordx4 v224, s[16:19], s95 offen offset:0  lds
    buffer_load_dwordx4 v225, s[16:19], s95 offen offset:1024  lds
    v_mfma_f32_16x16x32_bf16 v[152:155], v[28:31], v[124:127], v[152:155]
    ds_read_b64_tr_b16 v[96:97], v13 offset:28864
    ds_read_b64_tr_b16 v[98:99], v13 offset:30656
    s_barrier
    s_waitcnt lgkmcnt(8)
    v_mfma_f32_16x16x32_bf16 v[128:131], v[32:35], v[72:75], v[128:131]
    ds_read_b64_tr_b16 v[100:101], v13 offset:35840
    ds_read_b64_tr_b16 v[102:103], v13 offset:37632
    v_mfma_f32_16x16x32_bf16 v[132:135], v[32:35], v[76:79], v[132:135]
    ds_read_b64_tr_b16 v[104:105], v13 offset:35872
    ds_read_b64_tr_b16 v[106:107], v13 offset:37664
    v_mfma_f32_16x16x32_bf16 v[136:139], v[32:35], v[80:83], v[136:139]
    ds_read_b64_tr_b16 v[108:109], v13 offset:35904
    s_add_u32 m0, s45, 0
    ds_read_b64_tr_b16 v[110:111], v13 offset:37696
    buffer_load_dwordx4 v6, s[12:15], s40 offen offset:0  lds
    buffer_load_dwordx4 v7, s[12:15], s40 offen offset:1024  lds
    v_mfma_f32_16x16x32_bf16 v[140:143], v[32:35], v[84:87], v[140:143]
    ds_read_b64_tr_b16 v[112:113], v13 offset:35936
    ds_read_b64_tr_b16 v[114:115], v13 offset:37728
    s_waitcnt lgkmcnt(8)
    v_mfma_f32_16x16x32_bf16 v[144:147], v[32:35], v[88:91], v[144:147]
    ds_read_b64_tr_b16 v[116:117], v13 offset:35968
    ds_read_b64_tr_b16 v[118:119], v13 offset:37760
    v_mfma_f32_16x16x32_bf16 v[148:151], v[32:35], v[92:95], v[148:151]
    ds_read_b64_tr_b16 v[120:121], v13 offset:36000
    ds_read_b64_tr_b16 v[122:123], v13 offset:37792
    v_mfma_f32_16x16x32_bf16 v[152:155], v[32:35], v[96:99], v[152:155]
    ds_read_b64_tr_b16 v[124:125], v13 offset:36032
    ds_read_b64_tr_b16 v[126:127], v13 offset:37824
    s_waitcnt lgkmcnt(6)
    v_mfma_f32_16x16x32_bf16 v[128:131], v[36:39], v[100:103], v[128:131]
    ds_read_b64_tr_b16 v[72:73], v13 offset:43008
    ds_read_b64_tr_b16 v[74:75], v13 offset:44800
    v_mfma_f32_16x16x32_bf16 v[132:135], v[36:39], v[104:107], v[132:135]
    ds_read_b64_tr_b16 v[76:77], v13 offset:43040
    s_add_u32 m0, s45, 0
    ds_read_b64_tr_b16 v[78:79], v13 offset:44832
    buffer_load_dwordx4 v8, s[12:15], s40 offen offset:2048  lds
    buffer_load_dwordx4 v9, s[12:15], s40 offen offset:3072  lds
    v_mfma_f32_16x16x32_bf16 v[136:139], v[36:39], v[108:111], v[136:139]
    ds_read_b64_tr_b16 v[80:81], v13 offset:43072
    ds_read_b64_tr_b16 v[82:83], v13 offset:44864
    v_mfma_f32_16x16x32_bf16 v[140:143], v[36:39], v[112:115], v[140:143]
    ds_read_b64_tr_b16 v[84:85], v13 offset:43104
    ds_read_b64_tr_b16 v[86:87], v13 offset:44896
    s_waitcnt lgkmcnt(8)
    v_mfma_f32_16x16x32_bf16 v[144:147], v[36:39], v[116:119], v[144:147]
    ds_read_b64_tr_b16 v[88:89], v13 offset:43136
    ds_read_b64_tr_b16 v[90:91], v13 offset:44928
    v_mfma_f32_16x16x32_bf16 v[148:151], v[36:39], v[120:123], v[148:151]
    ds_read_b64_tr_b16 v[92:93], v13 offset:43168
    ds_read_b64_tr_b16 v[94:95], v13 offset:44960
    v_mfma_f32_16x16x32_bf16 v[152:155], v[36:39], v[124:127], v[152:155]
    ds_read_b64_tr_b16 v[96:97], v13 offset:43200
    ds_read_b64_tr_b16 v[98:99], v13 offset:44992
    s_waitcnt lgkmcnt(6)
    v_mfma_f32_16x16x32_bf16 v[128:131], v[40:43], v[72:75], v[128:131]
    ds_read_b64_tr_b16 v[100:101], v13 offset:50176
    s_add_u32 m0, s45, 4096
    ds_read_b64_tr_b16 v[102:103], v13 offset:51968
    buffer_load_dwordx4 v10, s[12:15], s40 offen offset:0  lds
    buffer_load_dwordx4 v11, s[12:15], s40 offen offset:1024  lds
    v_mfma_f32_16x16x32_bf16 v[132:135], v[40:43], v[76:79], v[132:135]
    ds_read_b64_tr_b16 v[104:105], v13 offset:50208
    ds_read_b64_tr_b16 v[106:107], v13 offset:52000
    v_mfma_f32_16x16x32_bf16 v[136:139], v[40:43], v[80:83], v[136:139]
    ds_read_b64_tr_b16 v[108:109], v13 offset:50240
    ds_read_b64_tr_b16 v[110:111], v13 offset:52032
    v_mfma_f32_16x16x32_bf16 v[140:143], v[40:43], v[84:87], v[140:143]
    ds_read_b64_tr_b16 v[112:113], v13 offset:50272
    ds_read_b64_tr_b16 v[114:115], v13 offset:52064
    s_waitcnt lgkmcnt(8)
    v_mfma_f32_16x16x32_bf16 v[144:147], v[40:43], v[88:91], v[144:147]
    ds_read_b64_tr_b16 v[116:117], v13 offset:50304
    ds_read_b64_tr_b16 v[118:119], v13 offset:52096
    v_mfma_f32_16x16x32_bf16 v[148:151], v[40:43], v[92:95], v[148:151]
    ds_read_b64_tr_b16 v[120:121], v13 offset:50336
    ds_read_b64_tr_b16 v[122:123], v13 offset:52128
    v_mfma_f32_16x16x32_bf16 v[152:155], v[40:43], v[96:99], v[152:155]
    ds_read_b64_tr_b16 v[124:125], v13 offset:50368
    ds_read_b64_tr_b16 v[126:127], v13 offset:52160
    s_barrier
    s_add_u32 m0, s45, 4096
    s_waitcnt lgkmcnt(6)
    buffer_load_dwordx4 v12, s[12:15], s40 offen offset:2048  lds
    v_mfma_f32_16x16x32_bf16 v[128:131], v[44:47], v[100:103], v[128:131]
    ds_read_b64_tr_b16 v[72:73], v13 offset:57344
    ds_read_b64_tr_b16 v[74:75], v13 offset:59136
    v_mfma_f32_16x16x32_bf16 v[132:135], v[44:47], v[104:107], v[132:135]
    ds_read_b64_tr_b16 v[76:77], v13 offset:57376
    ds_read_b64_tr_b16 v[78:79], v13 offset:59168
    v_mfma_f32_16x16x32_bf16 v[136:139], v[44:47], v[108:111], v[136:139]
    ds_read_b64_tr_b16 v[80:81], v13 offset:57408
    ds_read_b64_tr_b16 v[82:83], v13 offset:59200
    s_waitcnt vmcnt(13)
    ds_read_b128 a[8:11], v4 offset:10240
    ds_read_b128 a[72:75], v5 offset:10240
    v_mfma_f32_16x16x32_bf16 v[140:143], v[44:47], v[112:115], v[140:143]
    ds_read_b64_tr_b16 v[84:85], v13 offset:57440
    ds_read_b64_tr_b16 v[86:87], v13 offset:59232
    s_waitcnt lgkmcnt(10)
    s_waitcnt vmcnt(11)
    ds_read_b128 a[12:15], v4 offset:12288
    ds_read_b128 a[76:79], v5 offset:12288
    v_mfma_f32_16x16x32_bf16 v[144:147], v[44:47], v[116:119], v[144:147]
    ds_read_b64_tr_b16 v[88:89], v13 offset:57472
    ds_read_b64_tr_b16 v[90:91], v13 offset:59264
    s_waitcnt vmcnt(9)
    ds_read_b128 a[16:19], v4 offset:4096
    ds_read_b128 a[80:83], v5 offset:4096
    v_mfma_f32_16x16x32_bf16 v[148:151], v[44:47], v[120:123], v[148:151]
    ds_read_b64_tr_b16 v[92:93], v13 offset:57504
    ds_read_b64_tr_b16 v[94:95], v13 offset:59296
    s_waitcnt vmcnt(7)
    ds_read_b128 a[20:23], v4 offset:6144
    ds_read_b128 a[84:87], v5 offset:6144
    v_mfma_f32_16x16x32_bf16 v[152:155], v[44:47], v[124:127], v[152:155]
    ds_read_b64_tr_b16 v[96:97], v13 offset:57536
    ds_read_b64_tr_b16 v[98:99], v13 offset:59328
    s_waitcnt lgkmcnt(12)
    s_add_u32 m0, s44, 8192
    s_xor_b32 s95, s95, 196608
    buffer_load_dwordx4 v224, s[16:19], s95 offen offset:0  lds
    buffer_load_dwordx4 v225, s[16:19], s95 offen offset:1024  lds
    v_mfma_f32_16x16x32_bf16 v[128:131], v[48:51], v[72:75], v[128:131]
    ds_read_b64_tr_b16 v[100:101], v13 offset:64512
    ds_read_b64_tr_b16 v[102:103], v14 offset:768
    v_mfma_f32_16x16x32_bf16 v[132:135], v[48:51], v[76:79], v[132:135]
    ds_read_b64_tr_b16 v[104:105], v13 offset:64544
    ds_read_b64_tr_b16 v[106:107], v14 offset:800
    v_mfma_f32_16x16x32_bf16 v[136:139], v[48:51], v[80:83], v[136:139]
    ds_read_b64_tr_b16 v[108:109], v13 offset:64576
    ds_read_b64_tr_b16 v[110:111], v14 offset:832
    v_mfma_f32_16x16x32_bf16 v[140:143], v[48:51], v[84:87], v[140:143]
    ds_read_b64_tr_b16 v[112:113], v13 offset:64608
    ds_read_b64_tr_b16 v[114:115], v14 offset:864
    s_waitcnt lgkmcnt(8)
    s_add_u32 m0, s44, 10240
    s_xor_b32 s95, s95, 65536
    buffer_load_dwordx4 v224, s[16:19], s95 offen offset:0  lds
    buffer_load_dwordx4 v225, s[16:19], s95 offen offset:1024  lds
    v_mfma_f32_16x16x32_bf16 v[144:147], v[48:51], v[88:91], v[144:147]
    ds_read_b64_tr_b16 v[116:117], v13 offset:64640
    ds_read_b64_tr_b16 v[118:119], v14 offset:896
    v_mfma_f32_16x16x32_bf16 v[148:151], v[48:51], v[92:95], v[148:151]
    ds_read_b64_tr_b16 v[120:121], v13 offset:64672
    ds_read_b64_tr_b16 v[122:123], v14 offset:928
    v_mfma_f32_16x16x32_bf16 v[152:155], v[48:51], v[96:99], v[152:155]
    ds_read_b64_tr_b16 v[124:125], v13 offset:64704
    ds_read_b64_tr_b16 v[126:127], v14 offset:960
    s_barrier
    s_waitcnt lgkmcnt(6)
    v_mfma_f32_16x16x32_bf16 v[128:131], v[52:55], v[100:103], v[128:131]
    ds_read_b64_tr_b16 v[72:73], v14 offset:6144
    s_add_u32 m0, s45, 28672
    ds_read_b64_tr_b16 v[74:75], v14 offset:7936
    buffer_load_dwordx4 v6, s[12:15], s41 offen offset:0  lds
    buffer_load_dwordx4 v7, s[12:15], s41 offen offset:1024  lds
    v_mfma_f32_16x16x32_bf16 v[132:135], v[52:55], v[104:107], v[132:135]
    ds_read_b64_tr_b16 v[76:77], v14 offset:6176
    ds_read_b64_tr_b16 v[78:79], v14 offset:7968
    v_mfma_f32_16x16x32_bf16 v[136:139], v[52:55], v[108:111], v[136:139]
    ds_read_b64_tr_b16 v[80:81], v14 offset:6208
    ds_read_b64_tr_b16 v[82:83], v14 offset:8000
    v_mfma_f32_16x16x32_bf16 v[140:143], v[52:55], v[112:115], v[140:143]
    ds_read_b64_tr_b16 v[84:85], v14 offset:6240
    ds_read_b64_tr_b16 v[86:87], v14 offset:8032
    s_waitcnt lgkmcnt(8)
    v_mfma_f32_16x16x32_bf16 v[144:147], v[52:55], v[116:119], v[144:147]
    ds_read_b64_tr_b16 v[88:89], v14 offset:6272
    ds_read_b64_tr_b16 v[90:91], v14 offset:8064
    v_mfma_f32_16x16x32_bf16 v[148:151], v[52:55], v[120:123], v[148:151]
    ds_read_b64_tr_b16 v[92:93], v14 offset:6304
    ds_read_b64_tr_b16 v[94:95], v14 offset:8096
    v_mfma_f32_16x16x32_bf16 v[152:155], v[52:55], v[124:127], v[152:155]
    ds_read_b64_tr_b16 v[96:97], v14 offset:6336
    ds_read_b64_tr_b16 v[98:99], v14 offset:8128
    s_add_u32 m0, s45, 28672
    s_waitcnt lgkmcnt(6)
    buffer_load_dwordx4 v8, s[12:15], s41 offen offset:2048  lds
    buffer_load_dwordx4 v9, s[12:15], s41 offen offset:3072  lds
    v_mfma_f32_16x16x32_bf16 v[128:131], v[56:59], v[72:75], v[128:131]
    ds_read_b64_tr_b16 v[100:101], v14 offset:13312
    ds_read_b64_tr_b16 v[102:103], v14 offset:15104
    v_mfma_f32_16x16x32_bf16 v[132:135], v[56:59], v[76:79], v[132:135]
    ds_read_b64_tr_b16 v[104:105], v14 offset:13344
    ds_read_b64_tr_b16 v[106:107], v14 offset:15136
    v_mfma_f32_16x16x32_bf16 v[136:139], v[56:59], v[80:83], v[136:139]
    ds_read_b64_tr_b16 v[108:109], v14 offset:13376
    ds_read_b64_tr_b16 v[110:111], v14 offset:15168
    v_mfma_f32_16x16x32_bf16 v[140:143], v[56:59], v[84:87], v[140:143]
    ds_read_b64_tr_b16 v[112:113], v14 offset:13408
    ds_read_b64_tr_b16 v[114:115], v14 offset:15200
    s_waitcnt lgkmcnt(8)
    v_mfma_f32_16x16x32_bf16 v[144:147], v[56:59], v[88:91], v[144:147]
    ds_read_b64_tr_b16 v[116:117], v14 offset:13440
    ds_read_b64_tr_b16 v[118:119], v14 offset:15232
    v_mfma_f32_16x16x32_bf16 v[148:151], v[56:59], v[92:95], v[148:151]
    ds_read_b64_tr_b16 v[120:121], v14 offset:13472
    s_add_u32 m0, s45, 32768
    ds_read_b64_tr_b16 v[122:123], v14 offset:15264
    buffer_load_dwordx4 v10, s[12:15], s41 offen offset:0  lds
    buffer_load_dwordx4 v11, s[12:15], s41 offen offset:1024  lds
    v_mfma_f32_16x16x32_bf16 v[152:155], v[56:59], v[96:99], v[152:155]
    ds_read_b64_tr_b16 v[124:125], v14 offset:13504
    ds_read_b64_tr_b16 v[126:127], v14 offset:15296
    s_waitcnt lgkmcnt(6)
    v_mfma_f32_16x16x32_bf16 v[128:131], v[60:63], v[100:103], v[128:131]
    ds_read_b64_tr_b16 v[72:73], v14 offset:20480
    ds_read_b64_tr_b16 v[74:75], v14 offset:22272
    v_mfma_f32_16x16x32_bf16 v[132:135], v[60:63], v[104:107], v[132:135]
    ds_read_b64_tr_b16 v[76:77], v14 offset:20512
    ds_read_b64_tr_b16 v[78:79], v14 offset:22304
    v_mfma_f32_16x16x32_bf16 v[136:139], v[60:63], v[108:111], v[136:139]
    ds_read_b64_tr_b16 v[80:81], v14 offset:20544
    ds_read_b64_tr_b16 v[82:83], v14 offset:22336
    v_mfma_f32_16x16x32_bf16 v[140:143], v[60:63], v[112:115], v[140:143]
    ds_read_b64_tr_b16 v[84:85], v14 offset:20576
    ds_read_b64_tr_b16 v[86:87], v14 offset:22368
    s_waitcnt lgkmcnt(8)
    v_mfma_f32_16x16x32_bf16 v[144:147], v[60:63], v[116:119], v[144:147]
    ds_read_b64_tr_b16 v[88:89], v14 offset:20608
    s_add_u32 m0, s45, 32768
    ds_read_b64_tr_b16 v[90:91], v14 offset:22400
    buffer_load_dwordx4 v12, s[12:15], s41 offen offset:2048  lds
    v_mfma_f32_16x16x32_bf16 v[148:151], v[60:63], v[120:123], v[148:151]
    ds_read_b64_tr_b16 v[92:93], v14 offset:20640
    ds_read_b64_tr_b16 v[94:95], v14 offset:22432
    v_mfma_f32_16x16x32_bf16 v[152:155], v[60:63], v[124:127], v[152:155]
    ds_read_b64_tr_b16 v[96:97], v14 offset:20672
    ds_read_b64_tr_b16 v[98:99], v14 offset:22464
    s_barrier
    s_waitcnt lgkmcnt(6)
    v_mfma_f32_16x16x32_bf16 v[128:131], v[64:67], v[72:75], v[128:131]
    ds_read_b64_tr_b16 v[100:101], v14 offset:27648
    s_add_u32 m0, s45, 57344
    ds_read_b64_tr_b16 v[102:103], v14 offset:29440
    buffer_load_dwordx4 v6, s[12:15], s42 offen offset:0  lds
    buffer_load_dwordx4 v7, s[12:15], s42 offen offset:1024  lds
    v_mfma_f32_16x16x32_bf16 v[132:135], v[64:67], v[76:79], v[132:135]
    ds_read_b64_tr_b16 v[104:105], v14 offset:27680
    ds_read_b64_tr_b16 v[106:107], v14 offset:29472
    v_mfma_f32_16x16x32_bf16 v[136:139], v[64:67], v[80:83], v[136:139]
    ds_read_b64_tr_b16 v[108:109], v14 offset:27712
    ds_read_b64_tr_b16 v[110:111], v14 offset:29504
    v_mfma_f32_16x16x32_bf16 v[140:143], v[64:67], v[84:87], v[140:143]
    ds_read_b64_tr_b16 v[112:113], v14 offset:27744
    ds_read_b64_tr_b16 v[114:115], v14 offset:29536
    s_waitcnt lgkmcnt(8)
    v_mfma_f32_16x16x32_bf16 v[144:147], v[64:67], v[88:91], v[144:147]
    ds_read_b64_tr_b16 v[116:117], v14 offset:27776
    ds_read_b64_tr_b16 v[118:119], v14 offset:29568
    v_mfma_f32_16x16x32_bf16 v[148:151], v[64:67], v[92:95], v[148:151]
    ds_read_b64_tr_b16 v[120:121], v14 offset:27808
    ds_read_b64_tr_b16 v[122:123], v14 offset:29600
    s_lshl2_add_u32 s90, s2, s3
    s_mul_i32 s90, s90, 896
    v_min_u32 v15, 6, v1
    v_lshlrev_b32 v15, 7, v15
    s_add_u32 m0, s45, 57344
    buffer_load_dword v229, v15, s[20:23], s90 offen
    buffer_load_dwordx4 v8, s[12:15], s42 offen offset:2048  lds
    buffer_load_dwordx4 v9, s[12:15], s42 offen offset:3072  lds
    v_mfma_f32_16x16x32_bf16 v[152:155], v[64:67], v[96:99], v[152:155]
    ds_read_b64_tr_b16 v[124:125], v14 offset:27840
    ds_read_b64_tr_b16 v[126:127], v14 offset:29632
    v_cmp_eq_u32 vcc, 0, v207
    s_cbranch_vccnz L_poll_4_s
L_poll_4_ok:
    v_readlane_b32 s100, v207, 0
    v_readlane_b32 s101, v207, 1
    v_mov_b32 v218, 0
    v_mov_b32 v219, s100
    s_mov_b64 exec, 1
    buffer_store_dword v219, v218, s[24:27], s97 offen sc1
    s_mov_b64 exec, -1
    s_waitcnt lgkmcnt(6)
    v_mfma_f32_16x16x32_bf16 v[128:131], v[68:71], v[100:103], v[128:131]
    v_mfma_f32_16x16x32_bf16 v[132:135], v[68:71], v[104:107], v[132:135]
    v_mfma_f32_16x16x32_bf16 v[136:139], v[68:71], v[108:111], v[136:139]
    v_mfma_f32_16x16x32_bf16 v[140:143], v[68:71], v[112:115], v[140:143]
    s_add_u32 m0, s45, 61440
    s_waitcnt lgkmcnt(0)
    buffer_load_dwordx4 v10, s[12:15], s42 offen offset:0  lds
    buffer_load_dwordx4 v11, s[12:15], s42 offen offset:1024  lds
    v_mfma_f32_16x16x32_bf16 v[144:147], v[68:71], v[116:119], v[144:147]
    v_mfma_f32_16x16x32_bf16 v[148:151], v[68:71], v[120:123], v[148:151]
    v_mfma_f32_16x16x32_bf16 v[152:155], v[68:71], v[124:127], v[152:155]
    s_barrier
    v_mov_b32 v120, 3222493025
    v_mov_b32 v122, 3184710632
    v_pk_mul_f32 v[88:89], v[128:129], v[234:235]
    v_pk_mul_f32 v[90:91], v[88:89], v[88:89]
    v_pk_fma_f32 v[90:91], v[90:91], v[122:123], v[120:121] op_sel_hi:[1,0,0]
    v_pk_mul_f32 v[90:91], v[90:91], v[88:89]
    v_exp_f32 v90, v90
    v_exp_f32 v91, v91
    v_pk_mul_f32 v[92:93], v[130:131], v[236:237]
    v_pk_mul_f32 v[94:95], v[92:93], v[92:93]
    v_pk_fma_f32 v[94:95], v[94:95], v[122:123], v[120:121] op_sel_hi:[1,0,0]
    v_pk_mul_f32 v[94:95], v[94:95], v[92:93]
    v_exp_f32 v94, v94
    s_add_u32 m0, s45, 61440
    v_exp_f32 v95, v95
    buffer_load_dwordx4 v12, s[12:15], s42 offen offset:2048  lds
    v_pk_add_f32 v[90:91], v[90:91], 1.0 op_sel_hi:[1,0]
    v_rcp_f32 v90, v90
    v_rcp_f32 v91, v91
    v_pk_add_f32 v[94:95], v[94:95], 1.0 op_sel_hi:[1,0]
    v_rcp_f32 v94, v94
    v_rcp_f32 v95, v95
    v_pk_mul_f32 v[156:157], v[88:89], v[90:91]
    v_pk_mul_f32 v[158:159], v[92:93], v[94:95]
    v_pk_mul_f32 v[116:117], v[156:157], v[156:157]
    v_pk_mul_f32 v[118:119], v[158:159], v[158:159]
    s_cmp_ge_u32 s3, 2
    s_cbranch_scc1 L_hc_5
    s_add_u32 m0, s45, 86016
    s_nop 0
    buffer_load_dwordx4 v6, s[12:15], s43 offen offset:0  lds
    buffer_load_dwordx4 v7, s[12:15], s43 offen offset:1024  lds
    buffer_load_dwordx4 v8, s[12:15], s43 offen offset:2048  lds
    buffer_load_dwordx4 v9, s[12:15], s43 offen offset:3072  lds
L_hc_5:
    v_pk_mul_f32 v[88:89], v[132:133], v[234:235]
    v_pk_mul_f32 v[90:91], v[88:89], v[88:89]
    v_pk_fma_f32 v[90:91], v[90:91], v[122:123], v[120:121] op_sel_hi:[1,0,0]
    v_pk_mul_f32 v[90:91], v[90:91], v[88:89]
    v_exp_f32 v90, v90
    v_exp_f32 v91, v91
    v_pk_mul_f32 v[92:93], v[134:135], v[236:237]
    v_pk_mul_f32 v[94:95], v[92:93], v[92:93]
    v_pk_fma_f32 v[94:95], v[94:95], v[122:123], v[120:121] op_sel_hi:[1,0,0]
    v_pk_mul_f32 v[94:95], v[94:95], v[92:93]
    v_exp_f32 v94, v94
    v_exp_f32 v95, v95
    v_pk_add_f32 v[90:91], v[90:91], 1.0 op_sel_hi:[1,0]
    v_rcp_f32 v90, v90
    v_rcp_f32 v91, v91
    v_pk_add_f32 v[94:95], v[94:95], 1.0 op_sel_hi:[1,0]
    v_rcp_f32 v94, v94
    v_rcp_f32 v95, v95
    v_pk_mul_f32 v[160:161], v[88:89], v[90:91]
    s_cmp_ge_u32 s3, 2
    s_cbranch_scc1 L_hc_6
    s_add_u32 m0, s45, 90112
    s_nop 0
    buffer_load_dwordx4 v10, s[12:15], s43 offen offset:0  lds
    buffer_load_dwordx4 v11, s[12:15], s43 offen offset:1024  lds
    buffer_load_dwordx4 v12, s[12:15], s43 offen offset:2048  lds
L_hc_6:
    v_pk_mul_f32 v[162:163], v[92:93], v[94:95]
    v_pk_fma_f32 v[116:117], v[160:161], v[160:161], v[116:117]
    v_pk_add_f32 v[112:113], v[156:157], v[160:161]
    v_pk_fma_f32 v[118:119], v[162:163], v[162:163], v[118:119]
    v_pk_add_f32 v[114:115], v[158:159], v[162:163]
    v_pk_mul_f32 v[88:89], v[136:137], v[234:235]
    v_pk_mul_f32 v[90:91], v[88:89], v[88:89]
    v_pk_fma_f32 v[90:91], v[90:91], v[122:123], v[120:121] op_sel_hi:[1,0,0]
    v_pk_mul_f32 v[90:91], v[90:91], v[88:89]
    v_exp_f32 v90, v90
    v_exp_f32 v91, v91
    v_pk_mul_f32 v[92:93], v[138:139], v[236:237]
    v_pk_mul_f32 v[94:95], v[92:93], v[92:93]
    v_pk_fma_f32 v[94:95], v[94:95], v[122:123], v[120:121] op_sel_hi:[1,0,0]
    v_pk_mul_f32 v[94:95], v[94:95], v[92:93]
    v_exp_f32 v94, v94
    v_exp_f32 v95, v95
    s_waitcnt vmcnt(18)
    ds_read_b128 a[24:27], v4 offset:8192
    ds_read_b128 a[88:91], v5 offset:8192
    v_pk_add_f32 v[90:91], v[90:91], 1.0 op_sel_hi:[1,0]
    v_rcp_f32 v90, v90
    v_rcp_f32 v91, v91
    s_waitcnt vmcnt(16)
    ds_read_b128 a[28:31], v4 offset:10240
    ds_read_b128 a[92:95], v5 offset:10240
    v_pk_add_f32 v[94:95], v[94:95], 1.0 op_sel_hi:[1,0]
    v_rcp_f32 v94, v94
    v_rcp_f32 v95, v95
    s_xor_b32 s95, s7, 4
    s_lshl_b32 s95, s95, 6
    s_add_u32 m0, s44, 12288
    s_add_u32 s95, s95, s94
    buffer_load_dwordx4 v224, s[16:19], s95 offen offset:0  lds
    buffer_load_dwordx4 v225, s[16:19], s95 offen offset:1024  lds
    v_pk_mul_f32 v[164:165], v[88:89], v[90:91]
    v_pk_mul_f32 v[166:167], v[92:93], v[94:95]
    v_pk_fma_f32 v[116:117], v[164:165], v[164:165], v[116:117]
    v_pk_add_f32 v[112:113], v[112:113], v[164:165]
    v_pk_fma_f32 v[118:119], v[166:167], v[166:167], v[118:119]
    v_pk_add_f32 v[114:115], v[114:115], v[166:167]
    v_pk_mul_f32 v[88:89], v[140:141], v[234:235]
    v_pk_mul_f32 v[90:91], v[88:89], v[88:89]
    v_pk_fma_f32 v[90:91], v[90:91], v[122:123], v[120:121] op_sel_hi:[1,0,0]
    v_pk_mul_f32 v[90:91], v[90:91], v[88:89]
    v_exp_f32 v90, v90
    v_exp_f32 v91, v91
    v_pk_mul_f32 v[92:93], v[142:143], v[236:237]
    v_pk_mul_f32 v[94:95], v[92:93], v[92:93]
    v_pk_fma_f32 v[94:95], v[94:95], v[122:123], v[120:121] op_sel_hi:[1,0,0]
    v_pk_mul_f32 v[94:95], v[94:95], v[92:93]
    v_exp_f32 v94, v94
    v_exp_f32 v95, v95
    s_add_u32 m0, s44, 4096
    s_xor_b32 s95, s95, 65536
    buffer_load_dwordx4 v224, s[16:19], s95 offen offset:0  lds
    buffer_load_dwordx4 v225, s[16:19], s95 offen offset:1024  lds
    v_pk_add_f32 v[90:91], v[90:91], 1.0 op_sel_hi:[1,0]
    v_rcp_f32 v90, v90
    v_rcp_f32 v91, v91
    v_pk_add_f32 v[94:95], v[94:95], 1.0 op_sel_hi:[1,0]
    v_rcp_f32 v94, v94
    v_rcp_f32 v95, v95
    v_pk_mul_f32 v[168:169], v[88:89], v[90:91]
    v_pk_mul_f32 v[170:171], v[92:93], v[94:95]
    v_pk_fma_f32 v[116:117], v[168:169], v[168:169], v[116:117]
    v_pk_add_f32 v[112:113], v[112:113], v[168:169]
    v_pk_fma_f32 v[118:119], v[170:171], v[170:171], v[118:119]
    v_pk_add_f32 v[114:115], v[114:115], v[170:171]
    v_pk_mul_f32 v[88:89], v[144:145], v[234:235]
    v_pk_mul_f32 v[90:91], v[88:89], v[88:89]
    v_pk_fma_f32 v[90:91], v[90:91], v[122:123], v[120:121] op_sel_hi:[1,0,0]
    v_pk_mul_f32 v[90:91], v[90:91], v[88:89]
    v_exp_f32 v90, v90
    v_exp_f32 v91, v91
    s_add_u32 m0, s44, 6144
    s_xor_b32 s95, s95, 196608
    buffer_load_dwordx4 v224, s[16:19], s95 offen offset:0  lds
    buffer_load_dwordx4 v225, s[16:19], s95 offen offset:1024  lds
    v_pk_mul_f32 v[92:93], v[146:147], v[236:237]
    v_pk_mul_f32 v[94:95], v[92:93], v[92:93]
    v_pk_fma_f32 v[94:95], v[94:95], v[122:123], v[120:121] op_sel_hi:[1,0,0]
    v_pk_mul_f32 v[94:95], v[94:95], v[92:93]
    v_exp_f32 v94, v94
    v_exp_f32 v95, v95
    v_pk_add_f32 v[90:91], v[90:91], 1.0 op_sel_hi:[1,0]
    v_rcp_f32 v90, v90
    v_rcp_f32 v91, v91
    v_pk_add_f32 v[94:95], v[94:95], 1.0 op_sel_hi:[1,0]
    v_rcp_f32 v94, v94
    v_rcp_f32 v95, v95
    s_waitcnt lgkmcnt(2)
    s_add_u32 m0, s44, 8192
    s_xor_b32 s95, s95, 65536
    buffer_load_dwordx4 v224, s[16:19], s95 offen offset:0  lds
    buffer_load_dwordx4 v225, s[16:19], s95 offen offset:1024  lds
    v_pk_mul_f32 v[172:173], v[88:89], v[90:91]
    v_pk_mul_f32 v[174:175], v[92:93], v[94:95]
    v_pk_fma_f32 v[116:117], v[172:173], v[172:173], v[116:117]
    v_pk_add_f32 v[112:113], v[112:113], v[172:173]
    v_pk_fma_f32 v[118:119], v[174:175], v[174:175], v[118:119]
    v_pk_add_f32 v[114:115], v[114:115], v[174:175]
    v_pk_mul_f32 v[88:89], v[148:149], v[234:235]
    v_pk_mul_f32 v[90:91], v[88:89], v[88:89]
    v_pk_fma_f32 v[90:91], v[90:91], v[122:123], v[120:121] op_sel_hi:[1,0,0]
    v_pk_mul_f32 v[90:91], v[90:91], v[88:89]
    v_exp_f32 v90, v90
    v_exp_f32 v91, v91
    v_pk_mul_f32 v[92:93], v[150:151], v[236:237]
    v_pk_mul_f32 v[94:95], v[92:93], v[92:93]
    v_pk_fma_f32 v[94:95], v[94:95], v[122:123], v[120:121] op_sel_hi:[1,0,0]
    v_pk_mul_f32 v[94:95], v[94:95], v[92:93]
    v_exp_f32 v94, v94
    v_exp_f32 v95, v95
    s_waitcnt lgkmcnt(0)
    s_xor_b32 s95, s7, 6
    s_lshl_b32 s95, s95, 6
    s_add_u32 m0, s44, 10240
    s_add_u32 s95, s95, s94
    buffer_load_dwordx4 v224, s[16:19], s95 offen offset:0  lds
    buffer_load_dwordx4 v225, s[16:19], s95 offen offset:1024  lds
    v_pk_add_f32 v[90:91], v[90:91], 1.0 op_sel_hi:[1,0]
    v_rcp_f32 v90, v90
    v_rcp_f32 v91, v91
    v_pk_add_f32 v[94:95], v[94:95], 1.0 op_sel_hi:[1,0]
    v_rcp_f32 v94, v94
    v_rcp_f32 v95, v95
    v_pk_mul_f32 v[176:177], v[88:89], v[90:91]
    v_pk_mul_f32 v[178:179], v[92:93], v[94:95]
    v_pk_fma_f32 v[116:117], v[176:177], v[176:177], v[116:117]
    v_pk_add_f32 v[112:113], v[112:113], v[176:177]
    v_pk_fma_f32 v[118:119], v[178:179], v[178:179], v[118:119]
    v_pk_add_f32 v[114:115], v[114:115], v[178:179]
    v_pk_mul_f32 v[88:89], v[152:153], v[234:235]
    v_pk_mul_f32 v[90:91], v[88:89], v[88:89]
    v_pk_fma_f32 v[90:91], v[90:91], v[122:123], v[120:121] op_sel_hi:[1,0,0]
    v_pk_mul_f32 v[90:91], v[90:91], v[88:89]
    v_exp_f32 v90, v90
    v_exp_f32 v91, v91
    s_waitcnt vmcnt(8)
    ds_read_b128 a[32:35], v4 offset:12288
    ds_read_b128 a[96:99], v5 offset:12288
    v_pk_mul_f32 v[92:93], v[154:155], v[236:237]
    v_pk_mul_f32 v[94:95], v[92:93], v[92:93]
    v_pk_fma_f32 v[94:95], v[94:95], v[122:123], v[120:121] op_sel_hi:[1,0,0]
    v_pk_mul_f32 v[94:95], v[94:95], v[92:93]
    v_exp_f32 v94, v94
    v_exp_f32 v95, v95
    v_pk_add_f32 v[90:91], v[90:91], 1.0 op_sel_hi:[1,0]
    v_rcp_f32 v90, v90
    v_rcp_f32 v91, v91
    v_pk_add_f32 v[94:95], v[94:95], 1.0 op_sel_hi:[1,0]
    v_rcp_f32 v94, v94
    v_rcp_f32 v95, v95
    v_pk_mul_f32 v[180:181], v[88:89], v[90:91]
    s_waitcnt vmcnt(6)
    ds_read_b128 a[36:39], v4 offset:4096
    ds_read_b128 a[100:103], v5 offset:4096
    v_pk_mul_f32 v[182:183], v[92:93], v[94:95]
    s_waitcnt lgkmcnt(2)
    s_add_u32 m0, s44, 12288
    s_xor_b32 s95, s95, 65536
    buffer_load_dwordx4 v224, s[16:19], s95 offen offset:0  lds
    buffer_load_dwordx4 v225, s[16:19], s95 offen offset:1024  lds
    v_pk_fma_f32 v[116:117], v[180:181], v[180:181], v[116:117]
    v_pk_add_f32 v[112:113], v[112:113], v[180:181]
    v_pk_fma_f32 v[118:119], v[182:183], v[182:183], v[118:119]
    v_pk_add_f32 v[114:115], v[114:115], v[182:183]
    v_add_f32_dpp v112, v112, v112 row_ror:8 row_mask:0xf bank_mask:0x3
    v_add_f32_dpp v113, v113, v113 row_ror:8 row_mask:0xf bank_mask:0x3
    v_add_f32_dpp v116, v116, v116 row_ror:8 row_mask:0xf bank_mask:0x3
    v_add_f32_dpp v117, v117, v117 row_ror:8 row_mask:0xf bank_mask:0x3
    v_add_f32_dpp v112, v114, v114 row_ror:8 row_mask:0xf bank_mask:0xc
    v_add_f32_dpp v113, v115, v115 row_ror:8 row_mask:0xf bank_mask:0xc
    v_add_f32_dpp v116, v118, v118 row_ror:8 row_mask:0xf bank_mask:0xc
    v_add_f32_dpp v117, v119, v119 row_ror:8 row_mask:0xf bank_mask:0xc
    v_add_f32_dpp v100, v112, v112 row_shl:4 row_mask:0xf bank_mask:0x5
    v_add_f32_dpp v101, v116, v116 row_shl:4 row_mask:0xf bank_mask:0x5
    s_nop 0
    v_add_f32_dpp v100, v113, v113 row_shr:4 row_mask:0xf bank_mask:0xa
    v_add_f32_dpp v101, v117, v117 row_shr:4 row_mask:0xf bank_mask:0xa
    s_mov_b32 s58, 0x11111111
    s_mov_b32 s59, 0x11111111
    v_add_f32_dpp v100, v100, v100 quad_perm:[1,0,3,2] row_mask:0xf bank_mask:0xf
    v_add_f32_dpp v101, v101, v101 quad_perm:[1,0,3,2] row_mask:0xf bank_mask:0xf
    s_nop 0
    v_add_f32_dpp v100, v100, v100 quad_perm:[2,3,0,1] row_mask:0xf bank_mask:0xf
    v_add_f32_dpp v101, v101, v101 quad_perm:[2,3,0,1] row_mask:0xf bank_mask:0xf
    v_mov_b32 v103, s100
    v_xor_b32 v102, s101, v100
    v_xor_b32 v102, v102, v101
    s_mov_b64 exec, s[58:59]
    buffer_store_dwordx4 v[100:103], v208, s[24:27], s65 offen sc1
    s_mov_b64 exec, -1
    s_waitcnt vmcnt(7)
    ds_read_b128 a[40:43], v4 offset:6144
    ds_read_b128 a[104:107], v5 offset:6144
    v_bfe_u32 v206, v1, 4, 1
    v_lshlrev_b32 v206, 10, v206
    v_lshrrev_b32 v207, 5, v1
    v_lshlrev_b32 v207, 8, v207
    v_and_b32 v208, 15, v1
    v_lshl_add_u32 v207, v208, 4, v207
    v_add_u32 v206, v206, v207
    s_xor_b32 s56, s5, 1
    s_lshl_b32 s56, s56, 6
    s_lshl1_add_u32 s56, s4, s56
    s_lshr_b32 s57, s3, 1
    s_add_u32 s56, s56, s57
    s_mul_i32 s56, s56, 7168
    s_and_b32 s57, s3, 1
    s_lshl_b32 s57, s57, 9
    s_add_u32 s56, s56, s57
    s_add_u32 s66, s56, 4194304
    s_add_u32 s67, s66, 4096
    v_min_u32 v211, 27, v1
    v_lshrrev_b32 v208, 2, v211
    v_and_b32 v211, 3, v211
    v_lshlrev_b32 v211, 7, v211
    v_lshl_add_u32 v211, v208, 10, v211
    s_bitcmp0_b32 s3, 0
    s_cbranch_scc1 L_kw_j
    ds_read_b128 v[240:243], v196 offset:0
    ds_read_b128 v[244:247], v196 offset:1024
    ds_read_b128 v[248:251], v196 offset:2048
    s_lshr_b32 s56, s3, 1
    s_mul_i32 s57, s56, 3072
    s_add_u32 s57, s57, 157696
    v_mov_b32 v212, 947912704
    v_and_b32 v214, 15, v1
    v_lshrrev_b32 v215, 4, v1
    v_lshrrev_b32 v216, 5, v1
    v_lshlrev_b32 v216, 8, v216
    v_lshl_add_u32 v216, v214, 4, v216
    v_and_b32 v217, 1, v215
    v_lshl_add_u32 v216, v217, 3, v216
    v_add_u32 v216, s44, v216
    v_cmp_gt_u32 vcc, 32, v1
    v_lshlrev_b32 v217, 2, v214
    v_lshlrev_b32 v218, 3, v214
    v_cndmask_b32 v217, v217, v218, vcc
    v_lshl_add_u32 v217, v215, 7, v217
    v_add_u32 v217, s57, v217
    v_mov_b32 v218, 64
    v_cndmask_b32 v218, v218, 4, vcc
    v_add_u32 v218, v218, v217
    v_lshlrev_b32 v219, 1, v214
    v_lshl_add_u32 v219, v215, 7, v219
    v_add_u32 v219, s57, v219
    s_waitcnt lgkmcnt(0)
    v_pk_add_f32 v[184:185], v[184:185], v[240:241]
    v_pk_add_f32 v[186:187], v[186:187], v[242:243]
    v_pk_add_f32 v[188:189], v[188:189], v[244:245]
    v_pk_add_f32 v[190:191], v[190:191], v[246:247]
    v_pk_add_f32 v[192:193], v[192:193], v[248:249]
    v_pk_add_f32 v[194:195], v[194:195], v[250:251]
    v_pk_mul_f32 v[184:185], v[184:185], v[212:213] op_sel_hi:[1,0]
    v_pk_mul_f32 v[186:187], v[186:187], v[212:213] op_sel_hi:[1,0]
    v_pk_mul_f32 v[188:189], v[188:189], v[212:213] op_sel_hi:[1,0]
    v_pk_mul_f32 v[190:191], v[190:191], v[212:213] op_sel_hi:[1,0]
    v_pk_mul_f32 v[192:193], v[192:193], v[212:213] op_sel_hi:[1,0]
    v_pk_mul_f32 v[194:195], v[194:195], v[212:213] op_sel_hi:[1,0]
    v_add_f32 v184, v184, v231
    v_cvt_pk_f16_f32 v200, v184, v185
    v_cvt_pk_f16_f32 v201, v186, v187
    v_cvt_pk_f16_f32 v202, v188, v189
    v_cvt_pk_f16_f32 v203, v190, v191
    v_cvt_pk_f16_f32 v204, v192, v193
    v_cvt_pk_f16_f32 v205, v194, v195
    ds_write_b64 v216, v[200:201] offset:0
    ds_write_b32 v217, v202
    ds_write_b32 v218, v203
    ds_write_b16 v219, v204 offset:512
    ds_write_b16_d16_hi v219, v204 offset:544
    ds_write_b16 v219, v205 offset:576
    ds_write_b16_d16_hi v219, v205 offset:608
    s_waitcnt lgkmcnt(0)
L_kw_j:
    s_barrier
    s_waitcnt vmcnt(5)
    ds_read_b128 a[44:47], v4 offset:8192
    ds_read_b128 a[108:111], v5 offset:8192
    ds_read_b64_tr_b16 v[72:73], v13 offset:0
    ds_read_b64_tr_b16 v[74:75], v13 offset:1792
    s_waitcnt vmcnt(3)
    ds_read_b128 a[48:51], v4 offset:10240
    ds_read_b128 a[112:115], v5 offset:10240
    ds_read_b64_tr_b16 v[76:77], v13 offset:32
    ds_read_b64_tr_b16 v[78:79], v13 offset:1824
    s_waitcnt vmcnt(1)
    ds_read_b128 a[52:55], v4 offset:12288
    ds_read_b128 a[116:119], v5 offset:12288
    ds_read_b64_tr_b16 v[80:81], v13 offset:64
    ds_read_b64_tr_b16 v[82:83], v13 offset:1856
    s_waitcnt lgkmcnt(14)
    s_add_u32 m0, s44, 4096
    s_xor_b32 s95, s95, 196608
    buffer_load_dwordx4 v224, s[16:19], s95 offen offset:0  lds
    buffer_load_dwordx4 v225, s[16:19], s95 offen offset:1024  lds
    ds_read_b64_tr_b16 v[84:85], v13 offset:96
    ds_read_b64_tr_b16 v[86:87], v13 offset:1888
    ds_read_b64_tr_b16 v[88:89], v13 offset:128
    ds_read_b64_tr_b16 v[90:91], v13 offset:1920
    ds_read_b64_tr_b16 v[92:93], v13 offset:160
    ds_read_b64_tr_b16 v[94:95], v13 offset:1952
    ds_read_b64_tr_b16 v[96:97], v13 offset:192
    ds_read_b64_tr_b16 v[98:99], v13 offset:1984
    s_waitcnt lgkmcnt(6)
    v_mfma_f32_16x16x32_bf16 v[128:131], v[72:75], v[16:19], 0
    ds_read_b64_tr_b16 v[100:101], v13 offset:7168
    ds_read_b64_tr_b16 v[102:103], v13 offset:8960
    v_mfma_f32_16x16x32_bf16 v[132:135], v[76:79], v[16:19], 0
    ds_read_b64_tr_b16 v[104:105], v13 offset:7200
    ds_read_b64_tr_b16 v[106:107], v13 offset:8992
    s_add_u32 m0, s44, 6144
    s_xor_b32 s95, s95, 65536
    buffer_load_dwordx4 v224, s[16:19], s95 offen offset:0  lds
    buffer_load_dwordx4 v225, s[16:19], s95 offen offset:1024  lds
    v_mfma_f32_16x16x32_bf16 v[136:139], v[80:83], v[16:19], 0
    ds_read_b64_tr_b16 v[108:109], v13 offset:7232
    ds_read_b64_tr_b16 v[110:111], v13 offset:9024
    v_mfma_f32_16x16x32_bf16 v[140:143], v[84:87], v[16:19], 0
    ds_read_b64_tr_b16 v[112:113], v13 offset:7264
    ds_read_b64_tr_b16 v[114:115], v13 offset:9056
    s_waitcnt lgkmcnt(8)
    v_mfma_f32_16x16x32_bf16 v[144:147], v[88:91], v[16:19], 0
    ds_read_b64_tr_b16 v[116:117], v13 offset:7296
    ds_read_b64_tr_b16 v[118:119], v13 offset:9088
    v_mfma_f32_16x16x32_bf16 v[148:151], v[92:95], v[16:19], 0
    ds_read_b64_tr_b16 v[120:121], v13 offset:7328
    ds_read_b64_tr_b16 v[122:123], v13 offset:9120
    s_xor_b32 s95, s7, 8
    s_lshl_b32 s95, s95, 6
    s_add_u32 m0, s44, 8192
    s_add_u32 s95, s95, s94
    buffer_load_dwordx4 v224, s[16:19], s95 offen offset:0  lds
    buffer_load_dwordx4 v225, s[16:19], s95 offen offset:1024  lds
    v_mfma_f32_16x16x32_bf16 v[152:155], v[96:99], v[16:19], 0
    ds_read_b64_tr_b16 v[124:125], v13 offset:7360
    ds_read_b64_tr_b16 v[126:127], v13 offset:9152
    s_waitcnt lgkmcnt(6)
    v_mfma_f32_16x16x32_bf16 v[128:131], v[100:103], v[20:23], v[128:131]
    ds_read_b64_tr_b16 v[72:73], v13 offset:14336
    ds_read_b64_tr_b16 v[74:75], v13 offset:16128
    v_mfma_f32_16x16x32_bf16 v[132:135], v[104:107], v[20:23], v[132:135]
    ds_read_b64_tr_b16 v[76:77], v13 offset:14368
    ds_read_b64_tr_b16 v[78:79], v13 offset:16160
    v_mfma_f32_16x16x32_bf16 v[136:139], v[108:111], v[20:23], v[136:139]
    ds_read_b64_tr_b16 v[80:81], v13 offset:14400
    ds_read_b64_tr_b16 v[82:83], v13 offset:16192
    s_add_u32 m0, s44, 10240
    s_xor_b32 s95, s95, 65536
    buffer_load_dwordx4 v224, s[16:19], s95 offen offset:0  lds
    buffer_load_dwordx4 v225, s[16:19], s95 offen offset:1024  lds
    v_mfma_f32_16x16x32_bf16 v[140:143], v[112:115], v[20:23], v[140:143]
    ds_read_b64_tr_b16 v[84:85], v13 offset:14432
    ds_read_b64_tr_b16 v[86:87], v13 offset:16224
    s_waitcnt lgkmcnt(8)
    v_mfma_f32_16x16x32_bf16 v[144:147], v[116:119], v[20:23], v[144:147]
    ds_read_b64_tr_b16 v[88:89], v13 offset:14464
    ds_read_b64_tr_b16 v[90:91], v13 offset:16256
    v_mfma_f32_16x16x32_bf16 v[148:151], v[120:123], v[20:23], v[148:151]
    ds_read_b64_tr_b16 v[92:93], v13 offset:14496
    ds_read_b64_tr_b16 v[94:95], v13 offset:16288
    v_mfma_f32_16x16x32_bf16 v[152:155], v[124:127], v[20:23], v[152:155]
    ds_read_b64_tr_b16 v[96:97], v13 offset:14528
    ds_read_b64_tr_b16 v[98:99], v13 offset:16320
    s_waitcnt lgkmcnt(6)
    s_add_u32 m0, s44, 12288
    s_xor_b32 s95, s95, 196608
    buffer_load_dwordx4 v224, s[16:19], s95 offen offset:0  lds
    buffer_load_dwordx4 v225, s[16:19], s95 offen offset:1024  lds
    v_mfma_f32_16x16x32_bf16 v[128:131], v[72:75], v[24:27], v[128:131]
    ds_read_b64_tr_b16 v[100:101], v13 offset:21504
    ds_read_b64_tr_b16 v[102:103], v13 offset:23296
    v_mfma_f32_16x16x32_bf16 v[132:135], v[76:79], v[24:27], v[132:135]
    ds_read_b64_tr_b16 v[104:105], v13 offset:21536
    ds_read_b64_tr_b16 v[106:107], v13 offset:23328
    v_mfma_f32_16x16x32_bf16 v[136:139], v[80:83], v[24:27], v[136:139]
    ds_read_b64_tr_b16 v[108:109], v13 offset:21568
    ds_read_b64_tr_b16 v[110:111], v13 offset:23360
    v_mfma_f32_16x16x32_bf16 v[140:143], v[84:87], v[24:27], v[140:143]
    ds_read_b64_tr_b16 v[112:113], v13 offset:21600
    ds_read_b64_tr_b16 v[114:115], v13 offset:23392
    s_waitcnt lgkmcnt(8)
    v_mfma_f32_16x16x32_bf16 v[144:147], v[88:91], v[24:27], v[144:147]
    ds_read_b64_tr_b16 v[116:117], v13 offset:21632
    ds_read_b64_tr_b16 v[118:119], v13 offset:23424
    v_mfma_f32_16x16x32_bf16 v[148:151], v[92:95], v[24:27], v[148:151]
    ds_read_b64_tr_b16 v[120:121], v13 offset:21664
    ds_read_b64_tr_b16 v[122:123], v13 offset:23456
    v_mfma_f32_16x16x32_bf16 v[152:155], v[96:99], v[24:27], v[152:155]
    ds_read_b64_tr_b16 v[124:125], v13 offset:21696
    ds_read_b64_tr_b16 v[126:127], v13 offset:23488
    s_barrier
    s_waitcnt lgkmcnt(6)
    s_waitcnt vmcnt(8)
    ds_read_b128 a[56:59], v4 offset:4096
    ds_read_b128 a[120:123], v5 offset:4096
    v_mfma_f32_16x16x32_bf16 v[128:131], v[100:103], v[28:31], v[128:131]
    ds_read_b64_tr_b16 v[72:73], v13 offset:28672
    ds_read_b64_tr_b16 v[74:75], v13 offset:30464
    v_mfma_f32_16x16x32_bf16 v[132:135], v[104:107], v[28:31], v[132:135]
    ds_read_b64_tr_b16 v[76:77], v13 offset:28704
    ds_read_b64_tr_b16 v[78:79], v13 offset:30496
    v_mfma_f32_16x16x32_bf16 v[136:139], v[108:111], v[28:31], v[136:139]
    ds_read_b64_tr_b16 v[80:81], v13 offset:28736
    ds_read_b64_tr_b16 v[82:83], v13 offset:30528
    v_mfma_f32_16x16x32_bf16 v[140:143], v[112:115], v[28:31], v[140:143]
    ds_read_b64_tr_b16 v[84:85], v13 offset:28768
    ds_read_b64_tr_b16 v[86:87], v13 offset:30560
    s_waitcnt lgkmcnt(10)
    s_waitcnt vmcnt(6)
    ds_read_b128 a[60:63], v4 offset:6144
    ds_read_b128 a[124:127], v5 offset:6144
    v_mfma_f32_16x16x32_bf16 v[144:147], v[116:119], v[28:31], v[144:147]
    ds_read_b64_tr_b16 v[88:89], v13 offset:28800
    ds_read_b64_tr_b16 v[90:91], v13 offset:30592
    s_waitcnt lgkmcnt(12)
    s_add_u32 m0, s44, 4096
    s_xor_b32 s95, s95, 65536
    buffer_load_dwordx4 v224, s[16:19], s95 offen offset:0  lds
    buffer_load_dwordx4 v225, s[16:19], s95 offen offset:1024  lds
    v_mfma_f32_16x16x32_bf16 v[148:151], v[120:123], v[28:31], v[148:151]
    ds_read_b64_tr_b16 v[92:93], v13 offset:28832
    ds_read_b64_tr_b16 v[94:95], v13 offset:30624
    v_mfma_f32_16x16x32_bf16 v[152:155], v[124:127], v[28:31], v[152:155]
    ds_read_b64_tr_b16 v[96:97], v13 offset:28864
    ds_read_b64_tr_b16 v[98:99], v13 offset:30656
    s_waitcnt lgkmcnt(8)
    v_mfma_f32_16x16x32_bf16 v[128:131], v[72:75], v[32:35], v[128:131]
    ds_read_b64_tr_b16 v[100:101], v13 offset:35840
    ds_read_b64_tr_b16 v[102:103], v13 offset:37632
    v_mfma_f32_16x16x32_bf16 v[132:135], v[76:79], v[32:35], v[132:135]
    ds_read_b64_tr_b16 v[104:105], v13 offset:35872
    ds_read_b64_tr_b16 v[106:107], v13 offset:37664
    s_waitcnt vmcnt(6)
    ds_read_b128 a[128:131], v4 offset:8192
    ds_read_b128 a[192:195], v5 offset:8192
    v_mfma_f32_16x16x32_bf16 v[136:139], v[80:83], v[32:35], v[136:139]
    ds_read_b64_tr_b16 v[108:109], v13 offset:35904
    ds_read_b64_tr_b16 v[110:111], v13 offset:37696
    s_waitcnt lgkmcnt(14)
    s_xor_b32 s95, s7, 10
    s_lshl_b32 s95, s95, 6
    s_add_u32 m0, s44, 6144
    s_add_u32 s95, s95, s94
    buffer_load_dwordx4 v224, s[16:19], s95 offen offset:0  lds
    buffer_load_dwordx4 v225, s[16:19], s95 offen offset:1024  lds
    v_mfma_f32_16x16x32_bf16 v[140:143], v[84:87], v[32:35], v[140:143]
    ds_read_b64_tr_b16 v[112:113], v13 offset:35936
    ds_read_b64_tr_b16 v[114:115], v13 offset:37728
    s_waitcnt lgkmcnt(10)
    v_mfma_f32_16x16x32_bf16 v[144:147], v[88:91], v[32:35], v[144:147]
    ds_read_b64_tr_b16 v[116:117], v13 offset:35968
    ds_read_b64_tr_b16 v[118:119], v13 offset:37760
    v_mfma_f32_16x16x32_bf16 v[148:151], v[92:95], v[32:35], v[148:151]
    ds_read_b64_tr_b16 v[120:121], v13 offset:36000
    ds_read_b64_tr_b16 v[122:123], v13 offset:37792
    v_mfma_f32_16x16x32_bf16 v[152:155], v[96:99], v[32:35], v[152:155]
    ds_read_b64_tr_b16 v[124:125], v13 offset:36032
    ds_read_b64_tr_b16 v[126:127], v13 offset:37824
    s_waitcnt lgkmcnt(6)
    s_waitcnt vmcnt(6)
    ds_read_b128 a[132:135], v4 offset:10240
    ds_read_b128 a[196:199], v5 offset:10240
    v_mfma_f32_16x16x32_bf16 v[128:131], v[100:103], v[36:39], v[128:131]
    ds_read_b64_tr_b16 v[72:73], v13 offset:43008
    ds_read_b64_tr_b16 v[74:75], v13 offset:44800
    s_waitcnt vmcnt(4)
    ds_read_b128 a[136:139], v4 offset:12288
    ds_read_b128 a[200:203], v5 offset:12288
    v_mfma_f32_16x16x32_bf16 v[132:135], v[104:107], v[36:39], v[132:135]
    ds_read_b64_tr_b16 v[76:77], v13 offset:43040
    ds_read_b64_tr_b16 v[78:79], v13 offset:44832
    s_add_u32 m0, s44, 8192
    s_xor_b32 s95, s95, 65536
    buffer_load_dwordx4 v224, s[16:19], s95 offen offset:0  lds
    buffer_load_dwordx4 v225, s[16:19], s95 offen offset:1024  lds
    v_mfma_f32_16x16x32_bf16 v[136:139], v[108:111], v[36:39], v[136:139]
    ds_read_b64_tr_b16 v[80:81], v13 offset:43072
    ds_read_b64_tr_b16 v[82:83], v13 offset:44864
    v_mfma_f32_16x16x32_bf16 v[140:143], v[112:115], v[36:39], v[140:143]
    ds_read_b64_tr_b16 v[84:85], v13 offset:43104
    ds_read_b64_tr_b16 v[86:87], v13 offset:44896
    s_waitcnt lgkmcnt(12)
    v_mfma_f32_16x16x32_bf16 v[144:147], v[116:119], v[36:39], v[144:147]
    ds_read_b64_tr_b16 v[88:89], v13 offset:43136
    ds_read_b64_tr_b16 v[90:91], v13 offset:44928
    v_mfma_f32_16x16x32_bf16 v[148:151], v[120:123], v[36:39], v[148:151]
    ds_read_b64_tr_b16 v[92:93], v13 offset:43168
    ds_read_b64_tr_b16 v[94:95], v13 offset:44960
    s_waitcnt lgkmcnt(14)
    s_add_u32 m0, s44, 10240
    s_xor_b32 s95, s95, 196608
    buffer_load_dwordx4 v224, s[16:19], s95 offen offset:0  lds
    buffer_load_dwordx4 v225, s[16:19], s95 offen offset:1024  lds
    v_mfma_f32_16x16x32_bf16 v[152:155], v[124:127], v[36:39], v[152:155]
    ds_read_b64_tr_b16 v[96:97], v13 offset:43200
    ds_read_b64_tr_b16 v[98:99], v13 offset:44992
    s_waitcnt lgkmcnt(6)
    v_mfma_f32_16x16x32_bf16 v[128:131], v[72:75], v[40:43], v[128:131]
    ds_read_b64_tr_b16 v[100:101], v13 offset:50176
    ds_read_b64_tr_b16 v[102:103], v13 offset:51968
    v_mfma_f32_16x16x32_bf16 v[132:135], v[76:79], v[40:43], v[132:135]
    ds_read_b64_tr_b16 v[104:105], v13 offset:50208
    ds_read_b64_tr_b16 v[106:107], v13 offset:52000
    v_mfma_f32_16x16x32_bf16 v[136:139], v[80:83], v[40:43], v[136:139]
    ds_read_b64_tr_b16 v[108:109], v13 offset:50240
    ds_read_b64_tr_b16 v[110:111], v13 offset:52032
    s_add_u32 m0, s44, 12288
    s_xor_b32 s95, s95, 65536
    buffer_load_dwordx4 v224, s[16:19], s95 offen offset:0  lds
    buffer_load_dwordx4 v225, s[16:19], s95 offen offset:1024  lds
    v_mfma_f32_16x16x32_bf16 v[140:143], v[84:87], v[40:43], v[140:143]
    ds_read_b64_tr_b16 v[112:113], v13 offset:50272
    ds_read_b64_tr_b16 v[114:115], v13 offset:52064
    s_waitcnt lgkmcnt(8)
    v_mfma_f32_16x16x32_bf16 v[144:147], v[88:91], v[40:43], v[144:147]
    ds_read_b64_tr_b16 v[116:117], v13 offset:50304
    ds_read_b64_tr_b16 v[118:119], v13 offset:52096
    v_mfma_f32_16x16x32_bf16 v[148:151], v[92:95], v[40:43], v[148:151]
    ds_read_b64_tr_b16 v[120:121], v13 offset:50336
    ds_read_b64_tr_b16 v[122:123], v13 offset:52128
    v_mfma_f32_16x16x32_bf16 v[152:155], v[96:99], v[40:43], v[152:155]
    ds_read_b64_tr_b16 v[124:125], v13 offset:50368
    ds_read_b64_tr_b16 v[126:127], v13 offset:52160
    s_barrier
    s_waitcnt lgkmcnt(6)
    s_waitcnt vmcnt(8)
    ds_read_b128 a[140:143], v4 offset:4096
    ds_read_b128 a[204:207], v5 offset:4096
    v_mfma_f32_16x16x32_bf16 v[128:131], v[100:103], v[44:47], v[128:131]
    ds_read_b64_tr_b16 v[72:73], v13 offset:57344
    ds_read_b64_tr_b16 v[74:75], v13 offset:59136
    buffer_load_dwordx4 v[234:237], v209, s[24:27], s64 offen sc1
    buffer_load_dwordx4 v[8:11], v209, s[24:27], s64 offen offset:16 sc1
    v_mfma_f32_16x16x32_bf16 v[132:135], v[104:107], v[44:47], v[132:135]
    ds_read_b64_tr_b16 v[76:77], v13 offset:57376
    ds_read_b64_tr_b16 v[78:79], v13 offset:59168
    v_mfma_f32_16x16x32_bf16 v[136:139], v[108:111], v[44:47], v[136:139]
    ds_read_b64_tr_b16 v[80:81], v13 offset:57408
    ds_read_b64_tr_b16 v[82:83], v13 offset:59200
    s_waitcnt vmcnt(8)
    ds_read_b128 a[144:147], v4 offset:6144
    ds_read_b128 a[208:211], v5 offset:6144
    v_mfma_f32_16x16x32_bf16 v[140:143], v[112:115], v[44:47], v[140:143]
    ds_read_b64_tr_b16 v[84:85], v13 offset:57440
    ds_read_b64_tr_b16 v[86:87], v13 offset:59232
    s_waitcnt lgkmcnt(12)
    s_waitcnt lgkmcnt(10)
    s_xor_b32 s95, s7, 12
    s_lshl_b32 s95, s95, 6
    s_add_u32 m0, s44, 4096
    s_add_u32 s95, s95, s94
    buffer_load_dwordx4 v224, s[16:19], s95 offen offset:0  lds
    buffer_load_dwordx4 v225, s[16:19], s95 offen offset:1024  lds
    v_mfma_f32_16x16x32_bf16 v[144:147], v[116:119], v[44:47], v[144:147]
    ds_read_b64_tr_b16 v[88:89], v13 offset:57472
    ds_read_b64_tr_b16 v[90:91], v13 offset:59264
    v_mfma_f32_16x16x32_bf16 v[148:151], v[120:123], v[44:47], v[148:151]
    ds_read_b64_tr_b16 v[92:93], v13 offset:57504
    ds_read_b64_tr_b16 v[94:95], v13 offset:59296
    v_mfma_f32_16x16x32_bf16 v[152:155], v[124:127], v[44:47], v[152:155]
    ds_read_b64_tr_b16 v[96:97], v13 offset:57536
    ds_read_b64_tr_b16 v[98:99], v13 offset:59328
    s_waitcnt lgkmcnt(6)
    v_bfe_u32 v197, v1, 2, 2
    s_lshl_b32 s90, s3, 2
    v_and_or_b32 v197, v1, 16, v197
    v_add_u32 v197, s90, v197
    v_and_b32 v198, 7, v197
    s_lshr_b32 s90, s46, 5
    s_add_u32 s90, s90, 7
    v_sub_u32 v198, s90, v198
    v_subrev_u32 v199, 7, v198
    v_min_u32 v198, v198, v199
    v_lshrrev_b32 v199, 1, v198
    v_and_b32 v198, 1, v198
    v_lshl_add_u32 v198, v198, 2, v199
    v_lshl_add_u32 v197, v197, 3, v198
    v_lshlrev_b32 v197, 7, v197
    v_and_b32 v198, 3, v1
    v_lshl_add_u32 v197, v198, 2, v197
    v_lshrrev_b32 v199, 1, v0
    v_mul_u32_u24 v199, 7168, v199
    v_and_b32 v198, 16, v233
    v_add_u32 v199, v198, v199
    buffer_load_dword v198, v197, s[24:27], 0 offen sc1
    v_mfma_f32_16x16x32_bf16 v[128:131], v[72:75], v[48:51], v[128:131]
    ds_read_b64_tr_b16 v[100:101], v13 offset:64512
    ds_read_b64_tr_b16 v[102:103], v14 offset:768
    v_mfma_f32_16x16x32_bf16 v[132:135], v[76:79], v[48:51], v[132:135]
    ds_read_b64_tr_b16 v[104:105], v13 offset:64544
    ds_read_b64_tr_b16 v[106:107], v14 offset:800
    s_waitcnt vmcnt(9)
    ds_read_b128 a[148:151], v4 offset:8192
    ds_read_b128 a[212:215], v5 offset:8192
    v_mfma_f32_16x16x32_bf16 v[136:139], v[80:83], v[48:51], v[136:139]
    ds_read_b64_tr_b16 v[108:109], v13 offset:64576
    ds_read_b64_tr_b16 v[110:111], v14 offset:832
    s_waitcnt vmcnt(7)
    ds_read_b128 a[152:155], v4 offset:10240
    ds_read_b128 a[216:219], v5 offset:10240
    v_mfma_f32_16x16x32_bf16 v[140:143], v[84:87], v[48:51], v[140:143]
    ds_read_b64_tr_b16 v[112:113], v13 offset:64608
    ds_read_b64_tr_b16 v[114:115], v14 offset:864
    s_waitcnt lgkmcnt(12)
    s_add_u32 m0, s44, 6144
    s_xor_b32 s95, s95, 65536
    buffer_load_dwordx4 v224, s[16:19], s95 offen offset:0  lds
    buffer_load_dwordx4 v225, s[16:19], s95 offen offset:1024  lds
    v_mfma_f32_16x16x32_bf16 v[144:147], v[88:91], v[48:51], v[144:147]
    ds_read_b64_tr_b16 v[116:117], v13 offset:64640
    ds_read_b64_tr_b16 v[118:119], v14 offset:896
    v_mfma_f32_16x16x32_bf16 v[148:151], v[92:95], v[48:51], v[148:151]
    ds_read_b64_tr_b16 v[120:121], v13 offset:64672
    ds_read_b64_tr_b16 v[122:123], v14 offset:928
    v_mfma_f32_16x16x32_bf16 v[152:155], v[96:99], v[48:51], v[152:155]
    ds_read_b64_tr_b16 v[124:125], v13 offset:64704
    ds_read_b64_tr_b16 v[126:127], v14 offset:960
    s_waitcnt lgkmcnt(6)
    v_mfma_f32_16x16x32_bf16 v[128:131], v[100:103], v[52:55], v[128:131]
    ds_read_b64_tr_b16 v[72:73], v14 offset:6144
    ds_read_b64_tr_b16 v[74:75], v14 offset:7936
    s_waitcnt vmcnt(7)
    ds_read_b128 a[156:159], v4 offset:12288
    ds_read_b128 a[220:223], v5 offset:12288
    v_mfma_f32_16x16x32_bf16 v[132:135], v[104:107], v[52:55], v[132:135]
    ds_read_b64_tr_b16 v[76:77], v14 offset:6176
    ds_read_b64_tr_b16 v[78:79], v14 offset:7968
    s_add_u32 m0, s44, 8192
    s_xor_b32 s95, s95, 196608
    buffer_load_dwordx4 v224, s[16:19], s95 offen offset:0  lds
    buffer_load_dwordx4 v225, s[16:19], s95 offen offset:1024  lds
    v_mfma_f32_16x16x32_bf16 v[136:139], v[108:111], v[52:55], v[136:139]
    ds_read_b64_tr_b16 v[80:81], v14 offset:6208
    ds_read_b64_tr_b16 v[82:83], v14 offset:8000
    v_mfma_f32_16x16x32_bf16 v[140:143], v[112:115], v[52:55], v[140:143]
    ds_read_b64_tr_b16 v[84:85], v14 offset:6240
    ds_read_b64_tr_b16 v[86:87], v14 offset:8032
    s_waitcnt lgkmcnt(10)
    v_mfma_f32_16x16x32_bf16 v[144:147], v[116:119], v[52:55], v[144:147]
    ds_read_b64_tr_b16 v[88:89], v14 offset:6272
    ds_read_b64_tr_b16 v[90:91], v14 offset:8064
    v_mfma_f32_16x16x32_bf16 v[148:151], v[120:123], v[52:55], v[148:151]
    ds_read_b64_tr_b16 v[92:93], v14 offset:6304
    ds_read_b64_tr_b16 v[94:95], v14 offset:8096
    s_add_u32 m0, s44, 10240
    s_xor_b32 s95, s95, 65536
    buffer_load_dwordx4 v224, s[16:19], s95 offen offset:0  lds
    buffer_load_dwordx4 v225, s[16:19], s95 offen offset:1024  lds
    v_mfma_f32_16x16x32_bf16 v[152:155], v[124:127], v[52:55], v[152:155]
    ds_read_b64_tr_b16 v[96:97], v14 offset:6336
    ds_read_b64_tr_b16 v[98:99], v14 offset:8128
    s_mov_b32 s40, s101
    s_mov_b32 s41, s100
    s_waitcnt vmcnt(9)
    v_xor_b32 v236, v236, v234
    v_xor_b32 v10, v10, v8
    v_xor_b32 v236, v236, v235
    v_xor_b32 v10, v10, v9
    v_cmp_ne_u64 vcc, s[40:41], v[236:237]
    v_cmp_ne_u64 s[58:59], s[40:41], v[10:11]
    s_nop 0
    s_or_b64 vcc, vcc, s[58:59]
    s_cbranch_scc1 L_st_7_s
L_st_7_ok:
    v_add_f32_dpp v234, v234, v234 row_ror:8 row_mask:0xf bank_mask:0xf
    v_add_f32_dpp v235, v235, v235 row_ror:8 row_mask:0xf bank_mask:0xf
    v_add_f32_dpp v236, v8, v8 row_ror:8 row_mask:0xf bank_mask:0xf
    v_add_f32_dpp v237, v9, v9 row_ror:8 row_mask:0xf bank_mask:0xf
    v_add_f32_dpp v234, v234, v234 row_ror:4 row_mask:0xf bank_mask:0xf
    v_add_f32_dpp v235, v235, v235 row_ror:4 row_mask:0xf bank_mask:0xf
    v_add_f32_dpp v236, v236, v236 row_ror:4 row_mask:0xf bank_mask:0xf
    v_add_f32_dpp v237, v237, v237 row_ror:4 row_mask:0xf bank_mask:0xf
    v_add_f32_dpp v234, v234, v234 row_ror:2 row_mask:0xf bank_mask:0xf
    v_add_f32_dpp v235, v235, v235 row_ror:2 row_mask:0xf bank_mask:0xf
    v_add_f32_dpp v236, v236, v236 row_ror:2 row_mask:0xf bank_mask:0xf
    v_add_f32_dpp v237, v237, v237 row_ror:2 row_mask:0xf bank_mask:0xf
    v_mul_f32 v234, 982665509, v234
    v_mul_f32 v235, 982665509, v235
    v_fma_f32 v235, -v234, v234, v235
    v_max_f32 v235, 0, v235
    v_mul_f32 v236, 982665509, v236
    v_mul_f32 v237, 982665509, v237
    v_fma_f32 v237, -v236, v236, v237
    v_max_f32 v237, 0, v237
    v_cvt_pk_bf16_f32 v226, v234, v236
    v_cvt_pk_bf16_f32 v227, v235, v237
    v_lshlrev_b32 v234, 16, v227
    v_and_b32 v235, s54, v227
    v_add_f32 v234, 925353388, v234
    v_add_f32 v235, 925353388, v235
    v_cvt_pk_bf16_f32 v227, v234, v235
    v_lshlrev_b32 v234, 16, v227
    v_and_b32 v235, s54, v227
    v_sqrt_f32 v234, v234
    v_sqrt_f32 v235, v235
    v_mov_b32_dpp v240, v226 quad_perm:[0,0,2,2] row_mask:0xf bank_mask:0xf
    v_mov_b32_dpp v241, v226 quad_perm:[1,1,3,3] row_mask:0xf bank_mask:0xf
    v_cvt_pk_bf16_f32 v227, v234, v235
    v_lshlrev_b32 v234, 16, v227
    v_and_b32 v235, s54, v227
    v_rcp_f32 v236, v234
    v_rcp_f32 v237, v235
    v_lshlrev_b32 v244, 16, v240
    v_and_b32 v245, s54, v240
    v_lshlrev_b32 v246, 16, v241
    v_and_b32 v247, s54, v241
    v_fma_f32 v234, -v234, v236, 1.0
    v_fma_f32 v235, -v235, v237, 1.0
    v_fma_f32 v236, v234, v236, v236
    v_fma_f32 v237, v235, v237, v237
    v_pk_add_f32 v[156:157], v[156:157], v[244:245] neg_lo:[0,1] neg_hi:[0,1]
    v_pk_add_f32 v[158:159], v[158:159], v[246:247] neg_lo:[0,1] neg_hi:[0,1]
    v_mov_b32_dpp v248, v236 quad_perm:[0,0,2,2] row_mask:0xf bank_mask:0xf
    v_mov_b32_dpp v249, v237 quad_perm:[0,0,2,2] row_mask:0xf bank_mask:0xf
    v_mov_b32_dpp v250, v236 quad_perm:[1,1,3,3] row_mask:0xf bank_mask:0xf
    v_mov_b32_dpp v251, v237 quad_perm:[1,1,3,3] row_mask:0xf bank_mask:0xf
    v_pk_mul_f32 v[156:157], v[156:157], v[248:249]
    v_cvt_pk_bf16_f32 v156, v156, v157
    v_pk_mul_f32 v[158:159], v[158:159], v[250:251]
    v_cvt_pk_bf16_f32 v157, v158, v159
    v_pk_add_f32 v[160:161], v[160:161], v[244:245] neg_lo:[0,1] neg_hi:[0,1]
    v_pk_mul_f32 v[160:161], v[160:161], v[248:249]
    v_cvt_pk_bf16_f32 v158, v160, v161
    v_pk_add_f32 v[162:163], v[162:163], v[246:247] neg_lo:[0,1] neg_hi:[0,1]
    v_pk_mul_f32 v[162:163], v[162:163], v[250:251]
    v_cvt_pk_bf16_f32 v159, v162, v163
    v_pk_add_f32 v[164:165], v[164:165], v[244:245] neg_lo:[0,1] neg_hi:[0,1]
    v_pk_mul_f32 v[164:165], v[164:165], v[248:249]
    v_cvt_pk_bf16_f32 v160, v164, v165
    v_permlane16_swap_b32 v156, v158
    v_permlane16_swap_b32 v157, v159
    buffer_store_dwordx4 v[156:159], v206, s[24:27], s66 offen offset:0 sc1
    v_pk_add_f32 v[166:167], v[166:167], v[246:247] neg_lo:[0,1] neg_hi:[0,1]
    v_pk_mul_f32 v[166:167], v[166:167], v[250:251]
    v_cvt_pk_bf16_f32 v161, v166, v167
    v_pk_add_f32 v[168:169], v[168:169], v[244:245] neg_lo:[0,1] neg_hi:[0,1]
    v_pk_mul_f32 v[168:169], v[168:169], v[248:249]
    v_cvt_pk_bf16_f32 v162, v168, v169
    v_pk_add_f32 v[170:171], v[170:171], v[246:247] neg_lo:[0,1] neg_hi:[0,1]
    v_pk_mul_f32 v[170:171], v[170:171], v[250:251]
    v_cvt_pk_bf16_f32 v163, v170, v171
    v_pk_add_f32 v[172:173], v[172:173], v[244:245] neg_lo:[0,1] neg_hi:[0,1]
    v_pk_mul_f32 v[172:173], v[172:173], v[248:249]
    v_cvt_pk_bf16_f32 v164, v172, v173
    v_permlane16_swap_b32 v160, v162
    v_permlane16_swap_b32 v161, v163
    buffer_store_dwordx4 v[160:163], v206, s[24:27], s66 offen offset:2048 sc1
    v_pk_add_f32 v[174:175], v[174:175], v[246:247] neg_lo:[0,1] neg_hi:[0,1]
    v_pk_mul_f32 v[174:175], v[174:175], v[250:251]
    v_cvt_pk_bf16_f32 v165, v174, v175
    v_pk_add_f32 v[176:177], v[176:177], v[244:245] neg_lo:[0,1] neg_hi:[0,1]
    v_pk_mul_f32 v[176:177], v[176:177], v[248:249]
    v_cvt_pk_bf16_f32 v166, v176, v177
    v_pk_add_f32 v[178:179], v[178:179], v[246:247] neg_lo:[0,1] neg_hi:[0,1]
    v_pk_mul_f32 v[178:179], v[178:179], v[250:251]
    v_cvt_pk_bf16_f32 v167, v178, v179
    v_pk_add_f32 v[180:181], v[180:181], v[244:245] neg_lo:[0,1] neg_hi:[0,1]
    v_pk_mul_f32 v[180:181], v[180:181], v[248:249]
    v_cvt_pk_bf16_f32 v168, v180, v181
    v_cvt_pk_bf16_f32 v170, v180, v181
    v_permlane16_swap_b32 v164, v166
    v_permlane16_swap_b32 v165, v167
    buffer_store_dwordx4 v[164:167], v206, s[24:27], s67 offen offset:0 sc1
    v_pk_add_f32 v[182:183], v[182:183], v[246:247] neg_lo:[0,1] neg_hi:[0,1]
    v_pk_mul_f32 v[182:183], v[182:183], v[250:251]
    v_cvt_pk_bf16_f32 v169, v182, v183
    v_cvt_pk_bf16_f32 v171, v182, v183
    v_permlane16_swap_b32 v168, v170
    s_nop 0
    v_permlane16_swap_b32 v169, v171
    buffer_store_dwordx4 v[168:171], v207, s[24:27], s67 offen offset:2048 sc1
    v_lshrrev_b32 v238, 1, v1
    v_xor_b32 v238, s7, v238
    v_and_b32 v238, 14, v238
    v_lshlrev_b32 v238, 9, v238
    v_and_b32 v227, 3, v1
    v_lshl_add_u32 v238, v227, 2, v238
    s_xor_b32 s57, s5, 1
    s_lshl_b32 s58, s3, 6
    s_add_u32 s57, s57, s58
    s_lshl_b32 s57, s57, 7
    s_add_u32 s68, s57, 32768
    s_lshl2_add_u32 s57, s5, s3
    s_mul_i32 s69, s57, 114688
    s_add_u32 s69, s69, 4194304
    v_min_u32 v228, 55, v1
    v_lshlrev_b32 v210, 7, v228
    s_mul_i32 s70, s7, 7168
    s_add_u32 s70, s70, s69
    s_add_u32 s71, s70, 7168
    v_add_u32 v222, 4096, v233
    s_waitcnt lgkmcnt(6)
    s_waitcnt vmcnt(11)
    ds_read_b128 a[160:163], v4 offset:4096
    ds_read_b128 a[224:227], v5 offset:4096
    v_mfma_f32_16x16x32_bf16 v[128:131], v[72:75], v[56:59], v[128:131]
    ds_read_b64_tr_b16 v[100:101], v14 offset:13312
    ds_read_b64_tr_b16 v[102:103], v14 offset:15104
    s_waitcnt vmcnt(8)
    ds_read_b128 a[164:167], v4 offset:6144
    ds_read_b128 a[228:231], v5 offset:6144
    v_mfma_f32_16x16x32_bf16 v[132:135], v[76:79], v[56:59], v[132:135]
    ds_read_b64_tr_b16 v[104:105], v14 offset:13344
    ds_read_b64_tr_b16 v[106:107], v14 offset:15136
    s_waitcnt vmcnt(6)
    ds_read_b128 a[168:171], v4 offset:8192
    ds_read_b128 a[232:235], v5 offset:8192
    v_mfma_f32_16x16x32_bf16 v[136:139], v[80:83], v[56:59], v[136:139]
    ds_read_b64_tr_b16 v[108:109], v14 offset:13376
    ds_read_b64_tr_b16 v[110:111], v14 offset:15168
    s_waitcnt vmcnt(4)
    ds_read_b128 a[172:175], v4 offset:10240
    ds_read_b128 a[236:239], v5 offset:10240
    v_mfma_f32_16x16x32_bf16 v[140:143], v[84:87], v[56:59], v[140:143]
    ds_read_b64_tr_b16 v[112:113], v14 offset:13408
    ds_read_b64_tr_b16 v[114:115], v14 offset:15200
    s_waitcnt lgkmcnt(15)
    s_xor_b32 s95, s7, 14
    s_lshl_b32 s95, s95, 6
    s_add_u32 m0, s44, 12288
    s_add_u32 s95, s95, s94
    buffer_load_dwordx4 v224, s[16:19], s95 offen offset:0  lds
    buffer_load_dwordx4 v225, s[16:19], s95 offen offset:1024  lds
    v_mfma_f32_16x16x32_bf16 v[144:147], v[88:91], v[56:59], v[144:147]
    ds_read_b64_tr_b16 v[116:117], v14 offset:13440
    ds_read_b64_tr_b16 v[118:119], v14 offset:15232
    v_mfma_f32_16x16x32_bf16 v[148:151], v[92:95], v[56:59], v[148:151]
    ds_read_b64_tr_b16 v[120:121], v14 offset:13472
    ds_read_b64_tr_b16 v[122:123], v14 offset:15264
    v_mfma_f32_16x16x32_bf16 v[152:155], v[96:99], v[56:59], v[152:155]
    ds_read_b64_tr_b16 v[124:125], v14 offset:13504
    ds_read_b64_tr_b16 v[126:127], v14 offset:15296
    s_barrier
    s_waitcnt lgkmcnt(6)
    v_mfma_f32_16x16x32_bf16 v[128:131], v[100:103], v[60:63], v[128:131]
    ds_read_b64_tr_b16 v[72:73], v14 offset:20480
    ds_read_b64_tr_b16 v[74:75], v14 offset:22272
    s_add_u32 m0, s44, 4096
    s_xor_b32 s95, s95, 65536
    buffer_load_dwordx4 v224, s[16:19], s95 offen offset:0  lds
    buffer_load_dwordx4 v225, s[16:19], s95 offen offset:1024  lds
    v_mfma_f32_16x16x32_bf16 v[132:135], v[104:107], v[60:63], v[132:135]
    ds_read_b64_tr_b16 v[76:77], v14 offset:20512
    ds_read_b64_tr_b16 v[78:79], v14 offset:22304
    v_mfma_f32_16x16x32_bf16 v[136:139], v[108:111], v[60:63], v[136:139]
    ds_read_b64_tr_b16 v[80:81], v14 offset:20544
    ds_read_b64_tr_b16 v[82:83], v14 offset:22336
    v_mfma_f32_16x16x32_bf16 v[140:143], v[112:115], v[60:63], v[140:143]
    ds_read_b64_tr_b16 v[84:85], v14 offset:20576
    ds_read_b64_tr_b16 v[86:87], v14 offset:22368
    s_waitcnt lgkmcnt(8)
    v_mfma_f32_16x16x32_bf16 v[144:147], v[116:119], v[60:63], v[144:147]
    ds_read_b64_tr_b16 v[88:89], v14 offset:20608
    ds_read_b64_tr_b16 v[90:91], v14 offset:22400
    s_add_u32 m0, s44, 6144
    s_xor_b32 s95, s95, 196608
    buffer_load_dwordx4 v224, s[16:19], s95 offen offset:0  lds
    buffer_load_dwordx4 v225, s[16:19], s95 offen offset:1024  lds
    v_mfma_f32_16x16x32_bf16 v[148:151], v[120:123], v[60:63], v[148:151]
    ds_read_b64_tr_b16 v[92:93], v14 offset:20640
    ds_read_b64_tr_b16 v[94:95], v14 offset:22432
    v_mfma_f32_16x16x32_bf16 v[152:155], v[124:127], v[60:63], v[152:155]
    ds_read_b64_tr_b16 v[96:97], v14 offset:20672
    ds_read_b64_tr_b16 v[98:99], v14 offset:22464
    s_waitcnt lgkmcnt(6)
    v_mfma_f32_16x16x32_bf16 v[128:131], v[72:75], v[64:67], v[128:131]
    ds_read_b64_tr_b16 v[100:101], v14 offset:27648
    ds_read_b64_tr_b16 v[102:103], v14 offset:29440
    v_mfma_f32_16x16x32_bf16 v[132:135], v[76:79], v[64:67], v[132:135]
    ds_read_b64_tr_b16 v[104:105], v14 offset:27680
    ds_read_b64_tr_b16 v[106:107], v14 offset:29472
    s_add_u32 m0, s44, 8192
    s_xor_b32 s95, s95, 65536
    buffer_load_dwordx4 v224, s[16:19], s95 offen offset:0  lds
    buffer_load_dwordx4 v225, s[16:19], s95 offen offset:1024  lds
    v_mfma_f32_16x16x32_bf16 v[136:139], v[80:83], v[64:67], v[136:139]
    ds_read_b64_tr_b16 v[108:109], v14 offset:27712
    ds_read_b64_tr_b16 v[110:111], v14 offset:29504
    v_mfma_f32_16x16x32_bf16 v[140:143], v[84:87], v[64:67], v[140:143]
    ds_read_b64_tr_b16 v[112:113], v14 offset:27744
    ds_read_b64_tr_b16 v[114:115], v14 offset:29536
    s_waitcnt lgkmcnt(8)
    v_mfma_f32_16x16x32_bf16 v[144:147], v[88:91], v[64:67], v[144:147]
    ds_read_b64_tr_b16 v[116:117], v14 offset:27776
    ds_read_b64_tr_b16 v[118:119], v14 offset:29568
    v_mfma_f32_16x16x32_bf16 v[148:151], v[92:95], v[64:67], v[148:151]
    ds_read_b64_tr_b16 v[120:121], v14 offset:27808
    ds_read_b64_tr_b16 v[122:123], v14 offset:29600
    v_mfma_f32_16x16x32_bf16 v[152:155], v[96:99], v[64:67], v[152:155]
    ds_read_b64_tr_b16 v[124:125], v14 offset:27840
    ds_read_b64_tr_b16 v[126:127], v14 offset:29632
    s_waitcnt lgkmcnt(6)
    v_mfma_f32_16x16x32_bf16 v[128:131], v[100:103], v[68:71], v[128:131]
    v_mfma_f32_16x16x32_bf16 v[132:135], v[104:107], v[68:71], v[132:135]
    v_cmp_ne_u32 vcc, s100, v198
    s_cbranch_vccnz L_poll_8_s
L_poll_8_ok:
    s_lshl_b32 s90, s46, 5
    s_add_u32 s90, s90, 1048576
    s_add_u32 s91, s90, 917504
    buffer_load_dwordx4 a[248:251], v199, s[24:27], s90 offen sc1
    buffer_load_dwordx4 a[252:255], v199, s[24:27], s91 offen sc1
    v_mfma_f32_16x16x32_bf16 v[136:139], v[108:111], v[68:71], v[136:139]
    v_mfma_f32_16x16x32_bf16 v[140:143], v[112:115], v[68:71], v[140:143]
    s_waitcnt lgkmcnt(0)
    v_mfma_f32_16x16x32_bf16 v[144:147], v[116:119], v[68:71], v[144:147]
    v_mfma_f32_16x16x32_bf16 v[148:151], v[120:123], v[68:71], v[148:151]
    v_mfma_f32_16x16x32_bf16 v[152:155], v[124:127], v[68:71], v[152:155]
    v_pk_mul_f32 v[128:129], v[128:129], v[2:3] op_sel_hi:[1,0]
    v_pk_mul_f32 v[130:131], v[130:131], v[2:3] op_sel_hi:[1,0]
    v_pk_mul_f32 v[132:133], v[132:133], v[2:3] op_sel_hi:[1,0]
    v_pk_mul_f32 v[134:135], v[134:135], v[2:3] op_sel_hi:[1,0]
    v_pk_mul_f32 v[136:137], v[136:137], v[2:3] op_sel_hi:[1,0]
    v_pk_mul_f32 v[138:139], v[138:139], v[2:3] op_sel_hi:[1,0]
    v_pk_mul_f32 v[140:141], v[140:141], v[2:3] op_sel_hi:[1,0]
    v_pk_mul_f32 v[142:143], v[142:143], v[2:3] op_sel_hi:[1,0]
    v_pk_mul_f32 v[144:145], v[144:145], v[2:3] op_sel_hi:[1,0]
    v_pk_mul_f32 v[146:147], v[146:147], v[2:3] op_sel_hi:[1,0]
    v_pk_mul_f32 v[148:149], v[148:149], v[2:3] op_sel_hi:[1,0]
    v_pk_mul_f32 v[150:151], v[150:151], v[2:3] op_sel_hi:[1,0]
    v_pk_mul_f32 v[152:153], v[152:153], v[2:3] op_sel_hi:[1,0]
    v_pk_mul_f32 v[154:155], v[154:155], v[2:3] op_sel_hi:[1,0]
    v_cvt_pk_bf16_f32 v240, v128, v129
    s_waitcnt vmcnt(10)
    s_lshl_b32 s90, s47, 7
    s_lshl2_add_u32 s90, s3, s90
    s_add_u32 s90, s90, 98304
    s_add_u32 s91, s97, 32768
    v_mov_b32 v218, s90
    v_mov_b32 v219, s100
    v_writelane_b32 v218, s91, 1
    s_mov_b64 exec, 3
    buffer_store_dword v219, v218, s[24:27], 0 offen sc1
    s_mov_b64 exec, -1
    v_cvt_pk_bf16_f32 v241, v130, v131
    v_cvt_pk_bf16_f32 v242, v132, v133
    v_cvt_pk_bf16_f32 v243, v134, v135
    v_cvt_pk_bf16_f32 v244, v136, v137
    v_cvt_pk_bf16_f32 v245, v138, v139
    v_cvt_pk_bf16_f32 v246, v140, v141
    v_cvt_pk_bf16_f32 v247, v142, v143
    v_cvt_pk_bf16_f32 v248, v144, v145
    v_cvt_pk_bf16_f32 v249, v146, v147
    v_cvt_pk_bf16_f32 v250, v148, v149
    v_cvt_pk_bf16_f32 v251, v150, v151
    v_cvt_pk_bf16_f32 v252, v152, v153
    v_cvt_pk_bf16_f32 v253, v154, v155
    v_lshrrev_b32 v11, 3, v1
    v_and_b32 v12, 7, v1
    v_and_b32 v13, 6, v11
    v_xor_b32 v12, v12, v13
    v_mul_u32_u24 v2, 896, v11
    v_lshl_add_u32 v2, v12, 4, v2
    v_and_b32 v13, 3, v11
    v_and_b32 v11, 4, v11
    v_lshl_add_u32 v11, v11, 1, v13
    v_mul_u32_u24 v3, 896, v11
    v_lshl_add_u32 v3, v12, 4, v3
    s_min_u32 s75, s49, 6
    s_mul_i32 s74, s3, 200704
    s_lshl_b32 s75, s75, 7
    s_add_u32 s74, s74, s75
    s_lshr_b32 s56, s3, 1
    s_and_b32 s58, s3, 1
    s_mul_i32 s57, s56, 3072
    s_add_u32 s57, s57, 157696
    s_or_b32 s59, s3, 1
    s_mul_i32 s59, s59, 14336
    v_and_b32 v184, 127, v0
    v_lshrrev_b32 v185, 1, v184
    v_lshl_add_u32 v185, v185, 2, s57
    ds_read2_b32 v[100:101], v185 offset0:128 offset1:129
    v_lshl_add_u32 v196, v184, 4, s59
    s_cmp_eq_u32 s58, 0
    s_cselect_b32 s60, 63, 31
    s_cselect_b32 s61, 2, 3
    s_cselect_b32 s62, 256, 0
    s_movk_i32 s63, 1024
    s_cselect_b32 s63, s63, 512
    v_and_b32 v188, s60, v1
    v_lshlrev_b32 v189, s61, v188
    s_add_u32 s62, s62, s57
    v_add_u32 v189, s62, v189
    ds_read2_b32 v[108:109], v189 offset0:0 offset1:1
    ds_read_b32 v110, v189 offset:8
    s_add_u32 s63, s63, s59
    v_lshl_add_u32 v190, v188, 4, s63
    s_waitcnt lgkmcnt(0)
    s_mov_b32 vcc_lo, 0xaaaaaaaa
    s_mov_b32 vcc_hi, 0xaaaaaaaa
    v_alignbit_b32 v102, v101, v100, 16
    s_mov_b32 s60, 0x01000100
    s_mov_b32 s61, 0x03020302
    v_cndmask_b32 v100, v100, v102, vcc
    s_mov_b32 s62, 0x05040302
    v_perm_b32 v104, v100, v100, s60
    v_perm_b32 v105, v100, v100, s60
    v_perm_b32 v107, v100, v100, s61
    s_bitcmp0_b32 s3, 0
    v_cndmask_b32 v106, v100, v107, vcc
    s_cselect_b32 s63, 0x03020100, s62
    s_cselect_b32 s61, s61, 0x05040504
    s_cselect_b32 s62, s60, s62
    ds_write_b128 v196, v[104:107] offset:2048
    v_perm_b32 v112, v108, v108, s60
    v_perm_b32 v113, v109, v108, s63
    v_perm_b32 v114, v109, v108, s61
    v_perm_b32 v115, v110, v109, s62
    v_subrev_u32 v196, 8, v196
    ds_write_b128 v190, v[112:115] offset:0
    s_waitcnt lgkmcnt(0)
    s_barrier
    s_add_u32 m0, s44, 102400
    s_add_u32 s75, s74, 89600
    buffer_load_dwordx4 v3, s[20:23], s75 offen lds
    ds_read_b64 v[184:185], v196 offset:0
    ds_read_b128 v[186:189], v196 offset:8
    ds_read_b64 v[190:191], v196 offset:2048
    ds_read_b128 v[192:195], v196 offset:2056
    s_lshr_b32 s56, s3, 1
    s_mul_i32 s57, s56, 16640
    s_add_u32 s57, s57, 57376
    v_and_b32 v16, 127, v0
    v_lshl_add_u32 v16, v16, 4, s57
    s_waitcnt lgkmcnt(0)
    ds_write_b128 v16, v[186:189]
    v_cmp_eq_u32 vcc, s57, v16
    s_mul_i32 s58, s3, 8320
    s_add_u32 s58, s58, 57344
    v_cndmask_b32 v184, v184, 0, vcc
    v_cndmask_b32 v185, v185, 0, vcc
    s_add_u32 m0, s44, 103424
    s_add_u32 s75, s74, 189952
    buffer_load_dwordx4 v3, s[20:23], s75 offen lds
    v_pk_mov_b32 v[24:25], v[184:185], v[186:187] op_sel:[1,0]
    v_pk_mov_b32 v[26:27], v[186:187], v[188:189] op_sel:[1,0]
    ds_write_b128 v16, v[24:27] offset:8320
    s_add_u32 m0, s44, 104448
    s_add_u32 s75, s74, 100352
    buffer_load_dwordx4 v2, s[20:23], s75 offen lds
    v_alignbit_b32 v28, v185, v184, 16
    v_alignbit_b32 v29, v186, v185, 16
    v_alignbit_b32 v30, v187, v186, 16
    v_alignbit_b32 v31, v188, v187, 16
    v_alignbit_b32 v32, v189, v188, 16
    s_add_u32 m0, s44, 105472
    s_add_u32 s75, s74, 107520
    buffer_load_dwordx4 v2, s[20:23], s75 offen lds
    ds_write_b128 v16, v[28:31] offset:12480
    s_add_u32 m0, s44, 106496
    s_add_u32 s75, s74, 114688
    buffer_load_dwordx4 v2, s[20:23], s75 offen lds
    v_pk_mov_b32 v[36:37], v[28:29], v[30:31] op_sel:[1,0]
    v_pk_mov_b32 v[38:39], v[30:31], v[32:33] op_sel:[1,0]
    ds_write_b128 v16, v[36:39] offset:4160
    s_add_u32 m0, s44, 107520
    s_add_u32 s75, s74, 121856
    buffer_load_dwordx4 v2, s[20:23], s75 offen lds
    ds_write_b128 v16, v[192:195] offset:2048
    s_add_u32 m0, s44, 108544
    s_add_u32 s75, s74, 129024
    buffer_load_dwordx4 v2, s[20:23], s75 offen lds
    v_pk_mov_b32 v[40:41], v[190:191], v[192:193] op_sel:[1,0]
    v_pk_mov_b32 v[42:43], v[192:193], v[194:195] op_sel:[1,0]
    ds_write_b128 v16, v[40:43] offset:10368
    s_add_u32 m0, s44, 109568
    s_add_u32 s75, s74, 136192
    buffer_load_dwordx4 v2, s[20:23], s75 offen lds
    v_alignbit_b32 v44, v191, v190, 16
    v_alignbit_b32 v45, v192, v191, 16
    v_alignbit_b32 v46, v193, v192, 16
    v_alignbit_b32 v47, v194, v193, 16
    v_alignbit_b32 v48, v195, v194, 16
    s_add_u32 m0, s44, 110592
    s_add_u32 s75, s74, 143360
    buffer_load_dwordx4 v2, s[20:23], s75 offen lds
    ds_write_b128 v16, v[44:47] offset:14528
    s_add_u32 m0, s44, 111616
    s_add_u32 s75, s74, 150528
    buffer_load_dwordx4 v2, s[20:23], s75 offen lds
    v_pk_mov_b32 v[52:53], v[44:45], v[46:47] op_sel:[1,0]
    v_pk_mov_b32 v[54:55], v[46:47], v[48:49] op_sel:[1,0]
    ds_write_b128 v16, v[52:55] offset:6208
    s_mul_i32 s57, s56, 4096
    s_lshl_b32 s59, s3, 8
    s_add_u32 s57, s57, s59
    s_add_u32 s57, s57, 90624
    v_and_b32 v17, 15, v1
    v_lshl_add_u32 v17, v17, 4, s57
    v_bfe_u32 v18, v1, 1, 1
    v_mul_u32_u24 v18, 4160, v18
    v_and_b32 v19, 16, v233
    v_add3_u32 v18, v18, v19, s58
    v_cmp_gt_u32 vcc, 32, v1
    v_mov_b32 v20, 0
    v_mov_b32 v21, 0
    v_cndmask_b32 v17, v18, v17, vcc
    v_mov_b32 v22, 0
    v_mov_b32 v23, 0
    ds_write_b128 v17, v[20:23]
    v_and_b32 v197, 1, v0
    v_mul_u32_u24 v197, 4608, v197
    v_lshrrev_b32 v198, 1, v0
    v_lshl_add_u32 v197, v198, 4, v197
    v_add_u32 v197, 91136, v197
    s_waitcnt vmcnt(11)
    ds_write_b128 v197, a[248:251]
    ds_write_b128 v197, a[252:255] offset:2048
    s_add_u32 m0, s44, 112640
    s_add_u32 s75, s74, 157696
    buffer_load_dwordx4 v2, s[20:23], s75 offen lds
    s_lshr_b32 s56, s3, 1
    s_and_b32 s58, s3, 1
    s_mul_i32 s57, s56, 16640
    s_lshl_b32 s59, s58, 8
    s_sub_u32 s57, s57, s59
    s_add_u32 s57, s57, 57656
    v_bfe_u32 v18, v1, 2, 2
    v_mul_u32_u24 v18, 4160, v18
    v_and_b32 v19, 3, v1
    v_lshl_add_u32 v18, v19, 3, v18
    v_and_b32 v20, 48, v1
    v_sub_u32 v18, v18, v20
    v_add_u32 v16, s57, v18
    s_mul_i32 s57, s56, 4608
    s_add_u32 s57, s57, s59
    s_add_u32 s57, s57, 90656
    v_and_b32 v18, 15, v1
    v_lshl_add_u32 v18, v18, 5, v20
    v_add_u32 v17, s57, v18
    s_waitcnt lgkmcnt(0)
    s_barrier
    ds_read_b64_tr_b16 v[128:129], v16 offset:200
    ds_read_b64_tr_b16 v[130:131], v16 offset:192
    ds_read_b128 v[160:163], v17 offset:0
    ds_read_b64_tr_b16 v[132:133], v16 offset:712
    ds_read_b64_tr_b16 v[134:135], v16 offset:704
    ds_read_b128 v[164:167], v17 offset:512
    ds_read_b64_tr_b16 v[136:137], v16 offset:1224
    ds_read_b64_tr_b16 v[138:139], v16 offset:1216
    ds_read_b128 v[168:171], v17 offset:1024
    ds_read_b64_tr_b16 v[140:141], v16 offset:1736
    ds_read_b64_tr_b16 v[142:143], v16 offset:1728
    ds_read_b128 v[172:175], v17 offset:1536
    ds_read_b64_tr_b16 v[144:145], v16 offset:2248
    ds_read_b64_tr_b16 v[146:147], v16 offset:2240
    ds_read_b128 v[176:179], v17 offset:2048
    ds_read_b64_tr_b16 v[148:149], v16 offset:2760
    ds_read_b64_tr_b16 v[150:151], v16 offset:2752
    ds_read_b128 v[180:183], v17 offset:2560
    s_waitcnt lgkmcnt(15)
    s_add_u32 m0, s44, 113664
    s_add_u32 s75, s74, 164864
    buffer_load_dwordx4 v2, s[20:23], s75 offen lds
    v_mfma_f32_16x16x32_f16 v[24:27], v[128:131], v[160:163], 0
    ds_read_b64_tr_b16 v[152:153], v16 offset:3272
    s_waitcnt lgkmcnt(13)
    v_mfma_f32_16x16x32_f16 v[28:31], v[128:131], v[164:167], 0
    s_add_u32 m0, s44, 114688
    s_add_u32 s75, s74, 172032
    buffer_load_dwordx4 v2, s[20:23], s75 offen lds
    ds_read_b64_tr_b16 v[154:155], v16 offset:3264
    v_mfma_f32_16x16x32_f16 v[28:31], v[132:135], v[160:163], v[28:31]
    ds_read_b128 v[184:187], v17 offset:3072
    s_waitcnt lgkmcnt(12)
    v_mfma_f32_16x16x32_f16 v[32:35], v[128:131], v[168:171], 0
    s_add_u32 m0, s44, 115712
    s_add_u32 s75, s74, 179200
    buffer_load_dwordx4 v2, s[20:23], s75 offen lds
    ds_read_b64_tr_b16 v[156:157], v16 offset:3784
    v_mfma_f32_16x16x32_f16 v[32:35], v[132:135], v[164:167], v[32:35]
    ds_read_b64_tr_b16 v[158:159], v16 offset:3776
    v_mfma_f32_16x16x32_f16 v[32:35], v[136:139], v[160:163], v[32:35]
    ds_read_b128 a[176:179], v4 offset:12288
    ds_read_b128 a[240:243], v5 offset:12288
    ds_read_b128 v[188:191], v17 offset:3584
    s_waitcnt lgkmcnt(14)
    ds_read_b128 a[180:183], v4 offset:4096
    ds_read_b128 a[244:247], v5 offset:4096
    v_mfma_f32_16x16x32_f16 v[36:39], v[128:131], v[172:175], 0
    ds_read_b128 a[184:187], v4 offset:6144
    ds_read_b128 a[248:251], v5 offset:6144
    ds_read_b64_tr_b16 v[64:65], v16 offset:136
    ds_read_b128 a[188:191], v4 offset:8192
    ds_read_b128 a[252:255], v5 offset:8192
    v_mfma_f32_16x16x32_f16 v[36:39], v[132:135], v[168:171], v[36:39]
    ds_read_b64_tr_b16 v[66:67], v16 offset:128
    v_mfma_f32_16x16x32_f16 v[36:39], v[136:139], v[164:167], v[36:39]
    ds_read_b128 v[96:99], v17 offset:64
    v_mfma_f32_16x16x32_f16 v[36:39], v[140:143], v[160:163], v[36:39]
    ds_read_b64_tr_b16 v[68:69], v16 offset:648
    s_waitcnt lgkmcnt(15)
    v_mfma_f32_16x16x32_f16 v[40:43], v[128:131], v[176:179], 0
    ds_read_b64_tr_b16 v[70:71], v16 offset:640
    v_mfma_f32_16x16x32_f16 v[40:43], v[132:135], v[172:175], v[40:43]
    ds_read_b128 v[100:103], v17 offset:576
    v_mfma_f32_16x16x32_f16 v[40:43], v[136:139], v[168:171], v[40:43]
    ds_read_b64_tr_b16 v[72:73], v16 offset:1160
    v_mfma_f32_16x16x32_f16 v[40:43], v[140:143], v[164:167], v[40:43]
    s_waitcnt lgkmcnt(6)
    s_add_u32 m0, s44, 0
    s_add_u32 s75, s74, 0
    buffer_load_dwordx4 v2, s[20:23], s75 offen lds
    ds_read_b64_tr_b16 v[74:75], v16 offset:1152
    v_mfma_f32_16x16x32_f16 v[40:43], v[144:147], v[160:163], v[40:43]
    ds_read_b128 v[104:107], v17 offset:1088
    v_mfma_f32_16x16x32_f16 v[44:47], v[128:131], v[180:183], 0
    s_add_u32 m0, s44, 1024
    s_add_u32 s75, s74, 7168
    buffer_load_dwordx4 v2, s[20:23], s75 offen lds
    ds_read_b64_tr_b16 v[76:77], v16 offset:1672
    v_mfma_f32_16x16x32_f16 v[44:47], v[132:135], v[176:179], v[44:47]
    ds_read_b64_tr_b16 v[78:79], v16 offset:1664
    v_mfma_f32_16x16x32_f16 v[44:47], v[136:139], v[172:175], v[44:47]
    s_add_u32 m0, s44, 2048
    s_add_u32 s75, s74, 14336
    buffer_load_dwordx4 v2, s[20:23], s75 offen lds
    ds_read_b128 v[108:111], v17 offset:1600
    v_mfma_f32_16x16x32_f16 v[44:47], v[140:143], v[168:171], v[44:47]
    ds_read_b64_tr_b16 v[80:81], v16 offset:2184
    v_mfma_f32_16x16x32_f16 v[44:47], v[144:147], v[164:167], v[44:47]
    s_add_u32 m0, s44, 3072
    s_add_u32 s75, s74, 21504
    buffer_load_dwordx4 v2, s[20:23], s75 offen lds
    ds_read_b64_tr_b16 v[82:83], v16 offset:2176
    v_mfma_f32_16x16x32_f16 v[44:47], v[148:151], v[160:163], v[44:47]
    ds_read_b128 v[112:115], v17 offset:2112
    v_mfma_f32_16x16x32_f16 v[48:51], v[128:131], v[184:187], 0
    s_add_u32 m0, s44, 4096
    s_add_u32 s75, s74, 28672
    buffer_load_dwordx4 v2, s[20:23], s75 offen lds
    ds_read_b64_tr_b16 v[84:85], v16 offset:2696
    v_mfma_f32_16x16x32_f16 v[48:51], v[132:135], v[180:183], v[48:51]
    ds_read_b64_tr_b16 v[86:87], v16 offset:2688
    v_mfma_f32_16x16x32_f16 v[48:51], v[136:139], v[176:179], v[48:51]
    buffer_load_dword v227, v238, s[24:27], s68 offen sc1
    ds_read_b128 v[116:119], v17 offset:2624
    v_mfma_f32_16x16x32_f16 v[48:51], v[140:143], v[172:175], v[48:51]
    ds_read_b64_tr_b16 v[88:89], v16 offset:3208
    v_mfma_f32_16x16x32_f16 v[48:51], v[144:147], v[168:171], v[48:51]
    ds_read_b64_tr_b16 v[90:91], v16 offset:3200
    s_add_u32 m0, s44, 5120
    s_add_u32 s75, s74, 35840
    buffer_load_dwordx4 v2, s[20:23], s75 offen lds
    v_mfma_f32_16x16x32_f16 v[48:51], v[148:151], v[164:167], v[48:51]
    ds_read_b128 v[120:123], v17 offset:3136
    v_mfma_f32_16x16x32_f16 v[48:51], v[152:155], v[160:163], v[48:51]
    ds_read_b64_tr_b16 v[92:93], v16 offset:3720
    s_add_u32 m0, s44, 6144
    s_add_u32 s75, s74, 43008
    buffer_load_dwordx4 v2, s[20:23], s75 offen lds
    v_mfma_f32_16x16x32_f16 v[52:55], v[128:131], v[188:191], 0
    ds_read_b64_tr_b16 v[94:95], v16 offset:3712
    v_mfma_f32_16x16x32_f16 v[52:55], v[132:135], v[184:187], v[52:55]
    ds_read_b128 v[124:127], v17 offset:3648
    s_add_u32 m0, s44, 7168
    s_add_u32 s75, s74, 50176
    buffer_load_dwordx4 v2, s[20:23], s75 offen lds
    v_mfma_f32_16x16x32_f16 v[52:55], v[136:139], v[180:183], v[52:55]
    v_mfma_f32_16x16x32_f16 v[52:55], v[140:143], v[176:179], v[52:55]
    v_mfma_f32_16x16x32_f16 v[52:55], v[144:147], v[172:175], v[52:55]
    s_add_u32 m0, s44, 8192
    s_add_u32 s75, s74, 57344
    buffer_load_dwordx4 v2, s[20:23], s75 offen lds
    v_mfma_f32_16x16x32_f16 v[52:55], v[148:151], v[168:171], v[52:55]
    v_mfma_f32_16x16x32_f16 v[52:55], v[152:155], v[164:167], v[52:55]
    v_mfma_f32_16x16x32_f16 v[52:55], v[156:159], v[160:163], v[52:55]
    s_waitcnt lgkmcnt(0)
    s_add_u32 m0, s44, 9216
    s_add_u32 s75, s74, 64512
    buffer_load_dwordx4 v2, s[20:23], s75 offen lds
    v_mfma_f32_16x16x32_f16 v[52:55], v[64:67], v[124:127], v[52:55]
    ds_read_b64_tr_b16 v[128:129], v16 offset:72
    v_mfma_f32_16x16x32_f16 v[52:55], v[68:71], v[120:123], v[52:55]
    ds_read_b64_tr_b16 v[130:131], v16 offset:64
    s_add_u32 m0, s44, 10240
    s_add_u32 s75, s74, 71680
    buffer_load_dwordx4 v2, s[20:23], s75 offen lds
    v_mfma_f32_16x16x32_f16 v[52:55], v[72:75], v[116:119], v[52:55]
    ds_read_b128 v[160:163], v17 offset:128
    v_mfma_f32_16x16x32_f16 v[52:55], v[76:79], v[112:115], v[52:55]
    v_mfma_f32_16x16x32_f16 v[52:55], v[80:83], v[108:111], v[52:55]
    s_add_u32 m0, s44, 11264
    s_add_u32 s75, s74, 78848
    buffer_load_dwordx4 v2, s[20:23], s75 offen lds
    ds_read_b64_tr_b16 v[132:133], v16 offset:584
    v_mfma_f32_16x16x32_f16 v[52:55], v[84:87], v[104:107], v[52:55]
    ds_read_b64_tr_b16 v[134:135], v16 offset:576
    v_mfma_f32_16x16x32_f16 v[52:55], v[88:91], v[100:103], v[52:55]
    s_add_u32 m0, s44, 12288
    s_add_u32 s75, s74, 86016
    buffer_load_dwordx4 v3, s[20:23], s75 offen lds
    ds_read_b128 v[164:167], v17 offset:640
    v_mfma_f32_16x16x32_f16 v[52:55], v[92:95], v[96:99], v[52:55]
    v_mfma_f32_16x16x32_f16 v[48:51], v[64:67], v[120:123], v[48:51]
    s_add_u32 m0, s44, 13312
    s_add_u32 s75, s74, 186368
    buffer_load_dwordx4 v3, s[20:23], s75 offen lds
    ds_read_b64_tr_b16 v[136:137], v16 offset:1096
    v_mfma_f32_16x16x32_f16 v[48:51], v[68:71], v[116:119], v[48:51]
    ds_read_b64_tr_b16 v[138:139], v16 offset:1088
    v_mfma_f32_16x16x32_f16 v[48:51], v[72:75], v[112:115], v[48:51]
    ds_read_b128 v[168:171], v17 offset:1152
    v_mfma_f32_16x16x32_f16 v[48:51], v[76:79], v[108:111], v[48:51]
    v_mfma_f32_16x16x32_f16 v[48:51], v[80:83], v[104:107], v[48:51]
    ds_read_b64_tr_b16 v[140:141], v16 offset:1608
    v_mfma_f32_16x16x32_f16 v[48:51], v[84:87], v[100:103], v[48:51]
    ds_read_b64_tr_b16 v[142:143], v16 offset:1600
    v_mfma_f32_16x16x32_f16 v[48:51], v[88:91], v[96:99], v[48:51]
    ds_read_b128 v[172:175], v17 offset:1664
    v_mfma_f32_16x16x32_f16 v[44:47], v[64:67], v[116:119], v[44:47]
    v_mfma_f32_16x16x32_f16 v[44:47], v[68:71], v[112:115], v[44:47]
    ds_read_b64_tr_b16 v[144:145], v16 offset:2120
    v_mfma_f32_16x16x32_f16 v[44:47], v[72:75], v[108:111], v[44:47]
    ds_read_b64_tr_b16 v[146:147], v16 offset:2112
    v_mfma_f32_16x16x32_f16 v[44:47], v[76:79], v[104:107], v[44:47]
    ds_read_b128 v[176:179], v17 offset:2176
    v_mfma_f32_16x16x32_f16 v[44:47], v[80:83], v[100:103], v[44:47]
    s_waitcnt vmcnt(9)
    v_cmp_ne_u32 s[36:37], s100, v227
    s_nop 0
    s_and_b32 s37, s36, 0xf
    s_cbranch_scc1 L_zc_9_s
L_zc_9_ok:
    s_xor_b32 s70, s7, 0
    s_mul_i32 s70, s70, 7168
    s_add_u32 s70, s70, s69
    buffer_load_dwordx4 v[192:195], v233, s[24:27], s70 offen offset:0 sc1
    v_mfma_f32_16x16x32_f16 v[44:47], v[84:87], v[96:99], v[44:47]
    ds_read_b64_tr_b16 v[148:149], v16 offset:2632
    v_mfma_f32_16x16x32_f16 v[40:43], v[64:67], v[112:115], v[40:43]
    ds_read_b64_tr_b16 v[150:151], v16 offset:2624
    v_mfma_f32_16x16x32_f16 v[40:43], v[68:71], v[108:111], v[40:43]
    ds_read_b128 v[180:183], v17 offset:2688
    v_mfma_f32_16x16x32_f16 v[40:43], v[72:75], v[104:107], v[40:43]
    v_mfma_f32_16x16x32_f16 v[40:43], v[76:79], v[100:103], v[40:43]
    ds_read_b64_tr_b16 v[152:153], v16 offset:3144
    v_lshrrev_b32 v12, 3, v1
    v_mfma_f32_16x16x32_f16 v[40:43], v[80:83], v[96:99], v[40:43]
    ds_read_b64_tr_b16 v[154:155], v16 offset:3136
    buffer_load_dword v227, v238, s[24:27], s68 offen sc1
    v_lshlrev_b32 v12, 7, v12
    v_mfma_f32_16x16x32_f16 v[36:39], v[64:67], v[108:111], v[36:39]
    ds_read_b128 v[184:187], v17 offset:3200
    v_lshrrev_b32 v7, 2, v1
    buffer_load_dwordx4 v[196:199], v233, s[24:27], s70 offen offset:1024 sc1
    v_mfma_f32_16x16x32_f16 v[36:39], v[68:71], v[104:107], v[36:39]
    v_lshlrev_b32 v7, 10, v7
    v_mfma_f32_16x16x32_f16 v[36:39], v[72:75], v[100:103], v[36:39]
    ds_read_b64_tr_b16 v[156:157], v16 offset:3656
    buffer_load_dword v11, v12, s[24:27], s93 offen sc1
    buffer_load_dword v10, v7, s[24:27], s77 offen sc1
    v_mfma_f32_16x16x32_f16 v[36:39], v[76:79], v[96:99], v[36:39]
    ds_read_b64_tr_b16 v[158:159], v16 offset:3648
    s_xor_b32 s56, s3, 3
    v_mfma_f32_16x16x32_f16 v[32:35], v[64:67], v[104:107], v[32:35]
    ds_read_b128 v[188:191], v17 offset:3712
    s_mul_i32 s56, s56, 11264
    v_mfma_f32_16x16x32_f16 v[32:35], v[68:71], v[100:103], v[32:35]
    s_add_u32 s42, s56, 57344
    v_mfma_f32_16x16x32_f16 v[32:35], v[72:75], v[96:99], v[32:35]
    s_xor_b32 s56, s3, 2
    v_mfma_f32_16x16x32_f16 v[28:31], v[64:67], v[100:103], v[28:31]
    s_mul_i32 s56, s56, 11264
    buffer_load_dwordx4 v[200:203], v233, s[24:27], s70 offen offset:2048 sc1
    v_mfma_f32_16x16x32_f16 v[28:31], v[68:71], v[96:99], v[28:31]
    s_add_u32 s38, s56, 57344
    v_mfma_f32_16x16x32_f16 v[24:27], v[64:67], v[96:99], v[24:27]
    s_xor_b32 s56, s3, 1
    s_waitcnt lgkmcnt(0)
    v_mfma_f32_16x16x32_f16 v[52:55], v[128:131], v[188:191], v[52:55]
    ds_read_b64_tr_b16 v[64:65], v16 offset:8
    s_mul_i32 s56, s56, 11264
    v_mfma_f32_16x16x32_f16 v[52:55], v[132:135], v[184:187], v[52:55]
    ds_read_b64_tr_b16 v[66:67], v16 offset:0
    s_add_u32 s39, s56, 60416
    v_mfma_f32_16x16x32_f16 v[52:55], v[136:139], v[180:183], v[52:55]
    ds_read_b128 v[96:99], v17 offset:192
    s_xor_b32 s56, s3, 0
    v_mfma_f32_16x16x32_f16 v[52:55], v[140:143], v[176:179], v[52:55]
    s_mul_i32 s56, s56, 11264
    v_mfma_f32_16x16x32_f16 v[52:55], v[144:147], v[172:175], v[52:55]
    ds_read_b64_tr_b16 v[68:69], v16 offset:520
    s_add_u32 s43, s56, 63488
    buffer_load_dwordx4 v[204:207], v233, s[24:27], s70 offen offset:3072 sc1
    v_mfma_f32_16x16x32_f16 v[52:55], v[148:151], v[168:171], v[52:55]
    ds_read_b64_tr_b16 v[70:71], v16 offset:512
    s_lshr_b32 s56, s3, 1
    v_mfma_f32_16x16x32_f16 v[52:55], v[152:155], v[164:167], v[52:55]
    ds_read_b128 v[100:103], v17 offset:704
    s_lshl1_add_u32 s56, s46, s56
    v_mfma_f32_16x16x32_f16 v[52:55], v[156:159], v[160:163], v[52:55]
    s_lshl_b32 s56, s56, 7
    v_mfma_f32_16x16x32_f16 v[48:51], v[128:131], v[184:187], v[48:51]
    ds_read_b64_tr_b16 v[72:73], v16 offset:1032
    s_and_b32 s57, s3, 1
    v_mfma_f32_16x16x32_f16 v[48:51], v[132:135], v[180:183], v[48:51]
    ds_read_b64_tr_b16 v[74:75], v16 offset:1024
    s_mul_i32 s57, s57, 917504
    v_mfma_f32_16x16x32_f16 v[48:51], v[136:139], v[176:179], v[48:51]
    ds_read_b128 v[104:107], v17 offset:1216
    s_add_u32 s56, s56, s57
    v_mfma_f32_16x16x32_f16 v[48:51], v[140:143], v[172:175], v[48:51]
    s_mov_b32 s57, 8388608
    s_and_b32 s37, s36, 0xff
    s_cbranch_scc1 L_zc_10_s
L_zc_10_ok:
    s_xor_b32 s71, s7, 2
    s_mul_i32 s71, s71, 7168
    s_add_u32 s71, s71, s69
    buffer_load_dwordx4 v[208:211], v233, s[24:27], s71 offen offset:0 sc1
    v_mfma_f32_16x16x32_f16 v[48:51], v[144:147], v[168:171], v[48:51]
    ds_read_b64_tr_b16 v[76:77], v16 offset:1544
    s_cmp_ge_u32 s2, 224
    s_cselect_b32 s57, 16777216, s57
    v_mfma_f32_16x16x32_f16 v[48:51], v[148:151], v[164:167], v[48:51]
    ds_read_b64_tr_b16 v[78:79], v16 offset:1536
    s_add_u32 s87, s56, s57
    v_mfma_f32_16x16x32_f16 v[48:51], v[152:155], v[160:163], v[48:51]
    ds_read_b128 v[108:111], v17 offset:1728
    s_add_u32 s88, s87, 458752
    v_mfma_f32_16x16x32_f16 v[44:47], v[128:131], v[180:183], v[44:47]
    s_lshl_b32 s57, s3, 12
    v_mfma_f32_16x16x32_f16 v[44:47], v[132:135], v[176:179], v[44:47]
    ds_read_b64_tr_b16 v[80:81], v16 offset:2056
    v_mfma_f32_16x16x32_f16 v[44:47], v[136:139], v[172:175], v[44:47]
    ds_read_b64_tr_b16 v[82:83], v16 offset:2048
    v_mfma_f32_16x16x32_f16 v[44:47], v[140:143], v[168:171], v[44:47]
    ds_read_b128 v[112:115], v17 offset:2240
    buffer_load_dwordx4 v[188:191], v233, s[24:27], s71 offen offset:1024 sc1
    v_mfma_f32_16x16x32_f16 v[44:47], v[144:147], v[164:167], v[44:47]
    s_add_u32 s57, s57, 57344
    v_mfma_f32_16x16x32_f16 v[44:47], v[148:151], v[160:163], v[44:47]
    ds_read_b64_tr_b16 v[84:85], v16 offset:2568
    v_mfma_f32_16x16x32_f16 v[40:43], v[128:131], v[176:179], v[40:43]
    ds_read_b64_tr_b16 v[86:87], v16 offset:2560
    v_mfma_f32_16x16x32_f16 v[40:43], v[132:135], v[172:175], v[40:43]
    ds_read_b128 v[116:119], v17 offset:2752
    v_mfma_f32_16x16x32_f16 v[40:43], v[136:139], v[168:171], v[40:43]
    v_add_u32 v18, s57, v233
    v_mfma_f32_16x16x32_f16 v[40:43], v[140:143], v[164:167], v[40:43]
    ds_read_b64_tr_b16 v[88:89], v16 offset:3080
    v_mfma_f32_16x16x32_f16 v[40:43], v[144:147], v[160:163], v[40:43]
    ds_read_b64_tr_b16 v[90:91], v16 offset:3072
    buffer_load_dwordx4 v[156:159], v233, s[24:27], s71 offen offset:2048 sc1
    v_mfma_f32_16x16x32_f16 v[36:39], v[128:131], v[172:175], v[36:39]
    ds_read_b128 v[120:123], v17 offset:3264
    v_mfma_f32_16x16x32_f16 v[36:39], v[132:135], v[168:171], v[36:39]
    v_xor_b32 v8, 4096, v18
    v_mfma_f32_16x16x32_f16 v[36:39], v[136:139], v[164:167], v[36:39]
    ds_read_b64_tr_b16 v[92:93], v16 offset:3592
    buffer_load_dwordx4 v[184:187], v233, s[24:27], s71 offen offset:3072 sc1
    v_mfma_f32_16x16x32_f16 v[36:39], v[140:143], v[160:163], v[36:39]
    ds_read_b64_tr_b16 v[94:95], v16 offset:3584
    v_mfma_f32_16x16x32_f16 v[32:35], v[128:131], v[168:171], v[32:35]
    ds_read_b128 v[124:127], v17 offset:3776
    v_mfma_f32_16x16x32_f16 v[32:35], v[132:135], v[164:167], v[32:35]
    s_lshl_b32 s57, s3, 3
    s_and_b32 s37, s36, 0xfff
    s_cbranch_scc1 L_zc_11_s
L_zc_11_ok:
    s_xor_b32 s40, s7, 4
    s_mul_i32 s40, s40, 7168
    s_add_u32 s40, s40, s69
    buffer_load_dwordx4 v[152:155], v233, s[24:27], s40 offen offset:0 sc1
    v_mfma_f32_16x16x32_f16 v[32:35], v[136:139], v[160:163], v[32:35]
    s_lshr_b32 s57, 0x64231810, s57
    v_mfma_f32_16x16x32_f16 v[28:31], v[128:131], v[164:167], v[28:31]
    s_and_b32 s57, s57, 255
    v_mfma_f32_16x16x32_f16 v[28:31], v[132:135], v[160:163], v[28:31]
    s_lshl_b32 s57, s57, 10
    buffer_load_dwordx4 v[180:183], v233, s[24:27], s40 offen offset:1024 sc1
    v_mfma_f32_16x16x32_f16 v[24:27], v[128:131], v[160:163], v[24:27]
    s_add_u32 s57, s57, 57344
    v_and_b32 v20, 15, v1
    v_lshlrev_b32 v20, 5, v20
    v_lshrrev_b32 v9, 4, v1
    v_lshl_add_u32 v9, v9, 3, v20
    v_add_u32 v9, s57, v9
    v_add_u32 v221, s57, v233
    v_lshlrev_b32 v234, 16, v232
    v_lshlrev_b32 v235, 16, v232
    v_lshlrev_b32 v236, 16, v232
    v_lshlrev_b32 v237, 16, v232
    s_and_b32 s37, s36, 0xffff
    s_cbranch_scc1 L_zc_12_s
L_zc_12_ok:
    s_waitcnt lgkmcnt(0)
    s_barrier
    s_bitcmp1_b32 s3, 0
    s_cbranch_scc1 L_cv_h1
    v_mfma_f32_16x16x32_f16 v[40:43], v[64:67], v[112:115], v[40:43]
    v_mfma_f32_16x16x32_f16 v[40:43], v[68:71], v[108:111], v[40:43]
    v_mfma_f32_16x16x32_f16 v[40:43], v[72:75], v[104:107], v[40:43]
    buffer_load_dwordx4 v[148:151], v233, s[24:27], s40 offen offset:2048 sc1
    v_mfma_f32_16x16x32_f16 v[40:43], v[76:79], v[100:103], v[40:43]
    v_mfma_f32_16x16x32_f16 v[40:43], v[80:83], v[96:99], v[40:43]
    v_mfma_f32_16x16x32_f16 v[44:47], v[64:67], v[116:119], v[44:47]
    buffer_load_dwordx4 v[176:179], v233, s[24:27], s40 offen offset:3072 sc1
    v_mfma_f32_16x16x32_f16 v[44:47], v[68:71], v[112:115], v[44:47]
    s_nop 4
    ds_write_b128 v18, v[40:43] offset:0
    v_mfma_f32_16x16x32_f16 v[44:47], v[72:75], v[108:111], v[44:47]
    v_mfma_f32_16x16x32_f16 v[44:47], v[76:79], v[104:107], v[44:47]
    s_xor_b32 s41, s7, 6
    s_mul_i32 s41, s41, 7168
    s_add_u32 s41, s41, s69
    buffer_load_dwordx4 v[144:147], v233, s[24:27], s41 offen offset:0 sc1
    v_mfma_f32_16x16x32_f16 v[44:47], v[80:83], v[100:103], v[44:47]
    v_mfma_f32_16x16x32_f16 v[44:47], v[84:87], v[96:99], v[44:47]
    v_mfma_f32_16x16x32_f16 v[48:51], v[64:67], v[120:123], v[48:51]
    buffer_load_dwordx4 v[172:175], v233, s[24:27], s41 offen offset:1024 sc1
    v_mfma_f32_16x16x32_f16 v[48:51], v[68:71], v[116:119], v[48:51]
    s_nop 4
    ds_write_b128 v18, v[44:47] offset:1024
    v_mfma_f32_16x16x32_f16 v[48:51], v[72:75], v[112:115], v[48:51]
    v_mfma_f32_16x16x32_f16 v[48:51], v[76:79], v[108:111], v[48:51]
    buffer_load_dwordx4 v[140:143], v233, s[24:27], s41 offen offset:2048 sc1
    v_mfma_f32_16x16x32_f16 v[48:51], v[80:83], v[104:107], v[48:51]
    v_mfma_f32_16x16x32_f16 v[48:51], v[84:87], v[100:103], v[48:51]
    v_mfma_f32_16x16x32_f16 v[48:51], v[88:91], v[96:99], v[48:51]
    buffer_load_dwordx4 v[168:171], v233, s[24:27], s41 offen offset:3072 sc1
    v_mfma_f32_16x16x32_f16 v[52:55], v[64:67], v[124:127], v[52:55]
    v_mfma_f32_16x16x32_f16 v[52:55], v[68:71], v[120:123], v[52:55]
    s_nop 4
    ds_write_b128 v18, v[48:51] offset:2048
    v_mfma_f32_16x16x32_f16 v[52:55], v[72:75], v[116:119], v[52:55]
    s_xor_b32 s45, s7, 1
    s_mul_i32 s45, s45, 7168
    s_add_u32 s45, s45, s69
    buffer_load_dwordx4 v[136:139], v233, s[24:27], s45 offen offset:0 sc1
    v_mfma_f32_16x16x32_f16 v[52:55], v[76:79], v[112:115], v[52:55]
    v_mfma_f32_16x16x32_f16 v[52:55], v[80:83], v[108:111], v[52:55]
    v_mfma_f32_16x16x32_f16 v[52:55], v[84:87], v[104:107], v[52:55]
    buffer_load_dwordx4 v[164:167], v233, s[24:27], s45 offen offset:1024 sc1
    v_mfma_f32_16x16x32_f16 v[52:55], v[88:91], v[100:103], v[52:55]
    v_mfma_f32_16x16x32_f16 v[52:55], v[92:95], v[96:99], v[52:55]
    v_mfma_f32_16x16x32_f16 v[36:39], v[64:67], v[108:111], v[36:39]
    buffer_load_dwordx4 v[132:135], v233, s[24:27], s45 offen offset:2048 sc1
    v_mfma_f32_16x16x32_f16 v[36:39], v[68:71], v[104:107], v[36:39]
    s_nop 4
    ds_write_b128 v18, v[52:55] offset:3072
    v_mfma_f32_16x16x32_f16 v[36:39], v[72:75], v[100:103], v[36:39]
    v_mfma_f32_16x16x32_f16 v[36:39], v[76:79], v[96:99], v[36:39]
    buffer_load_dwordx4 v[160:163], v233, s[24:27], s45 offen offset:3072 sc1
    v_mfma_f32_16x16x32_f16 v[32:35], v[64:67], v[104:107], v[32:35]
    v_mfma_f32_16x16x32_f16 v[32:35], v[68:71], v[100:103], v[32:35]
    v_mfma_f32_16x16x32_f16 v[32:35], v[72:75], v[96:99], v[32:35]
    s_xor_b32 s46, s7, 3
    s_mul_i32 s46, s46, 7168
    s_add_u32 s46, s46, s69
    buffer_load_dwordx4 v[128:131], v233, s[24:27], s46 offen offset:0 sc1
    v_mfma_f32_16x16x32_f16 v[28:31], v[64:67], v[100:103], v[28:31]
    v_mfma_f32_16x16x32_f16 v[60:63], v[68:71], v[96:99], v[28:31]
    v_mfma_f32_16x16x32_f16 v[40:43], v[64:67], v[96:99], v[24:27]
    s_branch L_cv_j
L_cv_h1:
    v_mfma_f32_16x16x32_f16 v[24:27], v[64:67], v[96:99], v[24:27]
    v_mfma_f32_16x16x32_f16 v[28:31], v[64:67], v[100:103], v[28:31]
    v_mfma_f32_16x16x32_f16 v[28:31], v[68:71], v[96:99], v[28:31]
    s_nop 5
    ds_write_b128 v18, v[24:27] offset:0
    v_mfma_f32_16x16x32_f16 v[32:35], v[64:67], v[104:107], v[32:35]
    buffer_load_dwordx4 v[148:151], v233, s[24:27], s40 offen offset:2048 sc1
    v_mfma_f32_16x16x32_f16 v[32:35], v[68:71], v[100:103], v[32:35]
    ds_write_b128 v18, v[28:31] offset:1024
    v_mfma_f32_16x16x32_f16 v[32:35], v[72:75], v[96:99], v[32:35]
    buffer_load_dwordx4 v[176:179], v233, s[24:27], s40 offen offset:3072 sc1
    v_mfma_f32_16x16x32_f16 v[36:39], v[64:67], v[108:111], v[36:39]
    v_mfma_f32_16x16x32_f16 v[36:39], v[68:71], v[104:107], v[36:39]
    s_nop 4
    ds_write_b128 v18, v[32:35] offset:2048
    v_mfma_f32_16x16x32_f16 v[36:39], v[72:75], v[100:103], v[36:39]
    s_xor_b32 s41, s7, 6
    s_mul_i32 s41, s41, 7168
    s_add_u32 s41, s41, s69
    buffer_load_dwordx4 v[144:147], v233, s[24:27], s41 offen offset:0 sc1
    v_mfma_f32_16x16x32_f16 v[36:39], v[76:79], v[96:99], v[36:39]
    v_mfma_f32_16x16x32_f16 v[52:55], v[64:67], v[124:127], v[52:55]
    v_mfma_f32_16x16x32_f16 v[52:55], v[68:71], v[120:123], v[52:55]
    s_nop 5
    ds_write_b128 v18, v[36:39] offset:3072
    v_mfma_f32_16x16x32_f16 v[52:55], v[72:75], v[116:119], v[52:55]
    buffer_load_dwordx4 v[172:175], v233, s[24:27], s41 offen offset:1024 sc1
    v_mfma_f32_16x16x32_f16 v[52:55], v[76:79], v[112:115], v[52:55]
    v_mfma_f32_16x16x32_f16 v[52:55], v[80:83], v[108:111], v[52:55]
    buffer_load_dwordx4 v[140:143], v233, s[24:27], s41 offen offset:2048 sc1
    v_mfma_f32_16x16x32_f16 v[52:55], v[84:87], v[104:107], v[52:55]
    v_mfma_f32_16x16x32_f16 v[52:55], v[88:91], v[100:103], v[52:55]
    v_mfma_f32_16x16x32_f16 v[36:39], v[92:95], v[96:99], v[52:55]
    buffer_load_dwordx4 v[168:171], v233, s[24:27], s41 offen offset:3072 sc1
    v_mfma_f32_16x16x32_f16 v[48:51], v[64:67], v[120:123], v[48:51]
    v_mfma_f32_16x16x32_f16 v[48:51], v[68:71], v[116:119], v[48:51]
    v_mfma_f32_16x16x32_f16 v[48:51], v[72:75], v[112:115], v[48:51]
    s_xor_b32 s45, s7, 1
    s_mul_i32 s45, s45, 7168
    s_add_u32 s45, s45, s69
    buffer_load_dwordx4 v[136:139], v233, s[24:27], s45 offen offset:0 sc1
    v_mfma_f32_16x16x32_f16 v[48:51], v[76:79], v[108:111], v[48:51]
    v_mfma_f32_16x16x32_f16 v[48:51], v[80:83], v[104:107], v[48:51]
    v_mfma_f32_16x16x32_f16 v[48:51], v[84:87], v[100:103], v[48:51]
    buffer_load_dwordx4 v[164:167], v233, s[24:27], s45 offen offset:1024 sc1
    v_mfma_f32_16x16x32_f16 v[32:35], v[88:91], v[96:99], v[48:51]
    v_mfma_f32_16x16x32_f16 v[44:47], v[64:67], v[116:119], v[44:47]
    v_mfma_f32_16x16x32_f16 v[44:47], v[68:71], v[112:115], v[44:47]
    buffer_load_dwordx4 v[132:135], v233, s[24:27], s45 offen offset:2048 sc1
    v_mfma_f32_16x16x32_f16 v[44:47], v[72:75], v[108:111], v[44:47]
    v_mfma_f32_16x16x32_f16 v[44:47], v[76:79], v[104:107], v[44:47]
    v_mfma_f32_16x16x32_f16 v[44:47], v[80:83], v[100:103], v[44:47]
    buffer_load_dwordx4 v[160:163], v233, s[24:27], s45 offen offset:3072 sc1
    v_mfma_f32_16x16x32_f16 v[60:63], v[84:87], v[96:99], v[44:47]
    v_mfma_f32_16x16x32_f16 v[40:43], v[64:67], v[112:115], v[40:43]
    v_mfma_f32_16x16x32_f16 v[40:43], v[68:71], v[108:111], v[40:43]
    s_xor_b32 s46, s7, 3
    s_mul_i32 s46, s46, 7168
    s_add_u32 s46, s46, s69
    buffer_load_dwordx4 v[128:131], v233, s[24:27], s46 offen offset:0 sc1
    v_mfma_f32_16x16x32_f16 v[40:43], v[72:75], v[104:107], v[40:43]
    v_mfma_f32_16x16x32_f16 v[40:43], v[76:79], v[100:103], v[40:43]
    v_mfma_f32_16x16x32_f16 v[40:43], v[80:83], v[96:99], v[40:43]
L_cv_j:
    s_waitcnt lgkmcnt(0)
    s_waitcnt vmcnt(18)
    v_mfma_f32_16x16x32_bf16 v[16:19], v[192:195], a[0:3], v[234:237]
    v_mfma_f32_16x16x32_bf16 v[44:47], v[192:195], a[4:7], 0
    v_mfma_f32_16x16x32_bf16 v[72:75], v[192:195], a[8:11], 0
    v_mfma_f32_16x16x32_bf16 v[100:103], v[192:195], a[12:15], 0
    buffer_load_dwordx4 v[192:195], v233, s[24:27], s46 offen offset:1024 sc1
    v_mfma_f32_16x16x32_bf16 v[20:23], v[196:199], a[0:3], v[234:237]
    v_mfma_f32_16x16x32_bf16 v[48:51], v[196:199], a[4:7], 0
    v_mfma_f32_16x16x32_bf16 v[76:79], v[196:199], a[8:11], 0
    v_mfma_f32_16x16x32_bf16 v[104:107], v[196:199], a[12:15], 0
    buffer_load_dwordx4 v[196:199], v233, s[24:27], s46 offen offset:2048 sc1
    v_mfma_f32_16x16x32_bf16 v[24:27], v[200:203], a[0:3], v[234:237]
    s_barrier
    v_mfma_f32_16x16x32_bf16 v[52:55], v[200:203], a[4:7], 0
    ds_read_b128 v[64:67], v8 offset:0
    v_mfma_f32_16x16x32_bf16 v[80:83], v[200:203], a[8:11], 0
    ds_read_b128 v[68:71], v8 offset:1024
    v_mfma_f32_16x16x32_bf16 v[108:111], v[200:203], a[12:15], 0
    buffer_load_dwordx4 v[200:203], v233, s[24:27], s46 offen offset:3072 sc1
    s_waitcnt vmcnt(18)
    v_mfma_f32_16x16x32_bf16 v[28:31], v[204:207], a[0:3], v[234:237]
    ds_read_b128 v[88:91], v8 offset:2048
    v_mfma_f32_16x16x32_bf16 v[56:59], v[204:207], a[4:7], 0
    ds_read_b128 v[92:95], v8 offset:3072
    v_mfma_f32_16x16x32_bf16 v[84:87], v[204:207], a[8:11], 0
    v_mov_b32 v228, 3222493025
    v_mfma_f32_16x16x32_bf16 v[112:115], v[204:207], a[12:15], 0
    s_xor_b32 s47, s7, 5
    s_mul_i32 s47, s47, 7168
    s_add_u32 s47, s47, s69
    buffer_load_dwordx4 v[204:207], v233, s[24:27], s47 offen offset:0 sc1
    v_mfma_f32_16x16x32_bf16 v[16:19], v[208:211], a[16:19], v[16:19]
    v_mov_b32 v229, 3184710632
    v_lshlrev_b32 v2, 16, v240
    v_mfma_f32_16x16x32_bf16 v[44:47], v[208:211], a[20:23], v[44:47]
    v_and_b32 v3, s54, v240
    v_mul_f32 v223, v2, v2
    v_mfma_f32_16x16x32_bf16 v[72:75], v[208:211], a[24:27], v[72:75]
    v_mul_f32 v224, v3, v3
    v_fma_f32 v223, v223, v229, v228
    v_mfma_f32_16x16x32_bf16 v[100:103], v[208:211], a[28:31], v[100:103]
    buffer_load_dwordx4 v[208:211], v233, s[24:27], s47 offen offset:1024 sc1
    v_mfma_f32_16x16x32_bf16 v[20:23], v[188:191], a[16:19], v[20:23]
    v_fma_f32 v224, v224, v229, v228
    v_mul_f32 v223, v223, v2
    v_mfma_f32_16x16x32_bf16 v[48:51], v[188:191], a[20:23], v[48:51]
    v_mul_f32 v224, v224, v3
    v_mfma_f32_16x16x32_bf16 v[76:79], v[188:191], a[24:27], v[76:79]
    v_exp_f32 v223, v223
    v_mfma_f32_16x16x32_bf16 v[104:107], v[188:191], a[28:31], v[104:107]
    buffer_load_dwordx4 v[188:191], v233, s[24:27], s47 offen offset:2048 sc1
    s_waitcnt vmcnt(18)
    v_mfma_f32_16x16x32_bf16 v[24:27], v[156:159], a[16:19], v[24:27]
    v_exp_f32 v224, v224
    v_mfma_f32_16x16x32_bf16 v[52:55], v[156:159], a[20:23], v[52:55]
    v_add_f32 v223, 1.0, v223
    v_add_f32 v224, 1.0, v224
    v_mfma_f32_16x16x32_bf16 v[80:83], v[156:159], a[24:27], v[80:83]
    v_rcp_f32 v223, v223
    v_mfma_f32_16x16x32_bf16 v[108:111], v[156:159], a[28:31], v[108:111]
    buffer_load_dwordx4 v[156:159], v233, s[24:27], s47 offen offset:3072 sc1
    v_mfma_f32_16x16x32_bf16 v[28:31], v[184:187], a[16:19], v[28:31]
    v_rcp_f32 v224, v224
    v_mfma_f32_16x16x32_bf16 v[56:59], v[184:187], a[20:23], v[56:59]
    v_mul_f32 v2, v2, v223
    v_mul_f32 v3, v3, v224
    v_mfma_f32_16x16x32_bf16 v[84:87], v[184:187], a[24:27], v[84:87]
    v_cvt_pk_bf16_f32 v240, v2, v3
    s_waitcnt lgkmcnt(3)
    v_add_f32 v40, v40, v64
    v_mfma_f32_16x16x32_bf16 v[112:115], v[184:187], a[28:31], v[112:115]
    s_xor_b32 s52, s7, 7
    s_mul_i32 s52, s52, 7168
    s_add_u32 s52, s52, s69
    buffer_load_dwordx4 v[184:187], v233, s[24:27], s52 offen offset:0 sc1
    v_mfma_f32_16x16x32_bf16 v[16:19], v[152:155], a[32:35], v[16:19]
    v_add_f32 v41, v41, v65
    v_add_f32 v42, v42, v66
    v_mfma_f32_16x16x32_bf16 v[44:47], v[152:155], a[36:39], v[44:47]
    v_add_f32 v43, v43, v67
    v_mul_f32 v40, v40, v230
    v_mfma_f32_16x16x32_bf16 v[72:75], v[152:155], a[40:43], v[72:75]
    v_mul_f32 v41, v41, v230
    v_mul_f32 v42, v42, v230
    v_mfma_f32_16x16x32_bf16 v[100:103], v[152:155], a[44:47], v[100:103]
    buffer_load_dwordx4 v[152:155], v233, s[24:27], s52 offen offset:1024 sc1
    s_waitcnt vmcnt(18)
    v_mfma_f32_16x16x32_bf16 v[20:23], v[180:183], a[32:35], v[20:23]
    v_mul_f32 v43, v43, v230
    v_cvt_pk_bf16_f32 v40, v40, v41
    v_mfma_f32_16x16x32_bf16 v[48:51], v[180:183], a[36:39], v[48:51]
    v_cvt_pk_bf16_f32 v41, v42, v43
    v_mfma_f32_16x16x32_bf16 v[76:79], v[180:183], a[40:43], v[76:79]
    ds_write_b64 v9, v[40:41] offset:0
    v_mfma_f32_16x16x32_bf16 v[104:107], v[180:183], a[44:47], v[104:107]
    buffer_load_dwordx4 v[180:183], v233, s[24:27], s52 offen offset:2048 sc1
    v_mfma_f32_16x16x32_bf16 v[24:27], v[148:151], a[32:35], v[24:27]
    s_waitcnt lgkmcnt(3)
    v_add_f32 v60, v60, v68
    v_add_f32 v61, v61, v69
    v_mfma_f32_16x16x32_bf16 v[52:55], v[148:151], a[36:39], v[52:55]
    v_add_f32 v62, v62, v70
    v_add_f32 v63, v63, v71
    v_mfma_f32_16x16x32_bf16 v[80:83], v[148:151], a[40:43], v[80:83]
    v_mul_f32 v60, v60, v230
    v_mul_f32 v61, v61, v230
    v_mfma_f32_16x16x32_bf16 v[108:111], v[148:151], a[44:47], v[108:111]
    buffer_load_dwordx4 v[148:151], v233, s[24:27], s52 offen offset:3072 sc1
    v_mfma_f32_16x16x32_bf16 v[28:31], v[176:179], a[32:35], v[28:31]
    v_mul_f32 v62, v62, v230
    v_mul_f32 v63, v63, v230
    v_mfma_f32_16x16x32_bf16 v[56:59], v[176:179], a[36:39], v[56:59]
    v_cvt_pk_bf16_f32 v60, v60, v61
    v_mfma_f32_16x16x32_bf16 v[84:87], v[176:179], a[40:43], v[84:87]
    v_cvt_pk_bf16_f32 v61, v62, v63
    v_mfma_f32_16x16x32_bf16 v[112:115], v[176:179], a[44:47], v[112:115]
    v_cmp_ne_u32 s[36:37], s100, v227
    s_nop 0
    s_and_b32 s37, s36, 0xfffff
    s_cbranch_scc1 L_zc_13_s
L_zc_13_ok:
    s_xor_b32 s53, s7, 8
    s_mul_i32 s53, s53, 7168
    s_add_u32 s53, s53, s69
    buffer_load_dwordx4 v[176:179], v233, s[24:27], s53 offen offset:0 sc1
    s_waitcnt vmcnt(18)
    v_mfma_f32_16x16x32_bf16 v[16:19], v[144:147], a[48:51], v[16:19]
    ds_write_b64 v9, v[60:61] offset:512
    v_mfma_f32_16x16x32_bf16 v[44:47], v[144:147], a[52:55], v[44:47]
    s_waitcnt lgkmcnt(3)
    v_add_f32 v32, v32, v88
    v_add_f32 v33, v33, v89
    v_mfma_f32_16x16x32_bf16 v[72:75], v[144:147], a[56:59], v[72:75]
    v_add_f32 v34, v34, v90
    v_add_f32 v35, v35, v91
    v_mfma_f32_16x16x32_bf16 v[100:103], v[144:147], a[60:63], v[100:103]
    buffer_load_dwordx4 v[144:147], v233, s[24:27], s53 offen offset:1024 sc1
    v_mfma_f32_16x16x32_bf16 v[20:23], v[172:175], a[48:51], v[20:23]
    v_mul_f32 v32, v32, v230
    v_mul_f32 v33, v33, v230
    v_mfma_f32_16x16x32_bf16 v[48:51], v[172:175], a[52:55], v[48:51]
    v_mul_f32 v34, v34, v230
    v_mul_f32 v35, v35, v230
    v_mfma_f32_16x16x32_bf16 v[76:79], v[172:175], a[56:59], v[76:79]
    v_cvt_pk_bf16_f32 v32, v32, v33
    v_mfma_f32_16x16x32_bf16 v[104:107], v[172:175], a[60:63], v[104:107]
    buffer_load_dwordx4 v[172:175], v233, s[24:27], s53 offen offset:2048 sc1
    v_mfma_f32_16x16x32_bf16 v[24:27], v[140:143], a[48:51], v[24:27]
    v_cvt_pk_bf16_f32 v33, v34, v35
    v_mfma_f32_16x16x32_bf16 v[52:55], v[140:143], a[52:55], v[52:55]
    ds_write_b64 v9, v[32:33] offset:3072
    v_mfma_f32_16x16x32_bf16 v[80:83], v[140:143], a[56:59], v[80:83]
    s_waitcnt lgkmcnt(3)
    v_add_f32 v36, v36, v92
    v_add_f32 v37, v37, v93
    v_mfma_f32_16x16x32_bf16 v[108:111], v[140:143], a[60:63], v[108:111]
    buffer_load_dwordx4 v[140:143], v233, s[24:27], s53 offen offset:3072 sc1
    s_waitcnt vmcnt(18)
    v_mfma_f32_16x16x32_bf16 v[28:31], v[168:171], a[48:51], v[28:31]
    v_add_f32 v38, v38, v94
    v_add_f32 v39, v39, v95
    v_mfma_f32_16x16x32_bf16 v[56:59], v[168:171], a[52:55], v[56:59]
    v_mul_f32 v36, v36, v230
    v_mul_f32 v37, v37, v230
    v_mfma_f32_16x16x32_bf16 v[84:87], v[168:171], a[56:59], v[84:87]
    v_mul_f32 v38, v38, v230
    v_mul_f32 v39, v39, v230
    v_mfma_f32_16x16x32_bf16 v[112:115], v[168:171], a[60:63], v[112:115]
    s_and_b32 s37, s36, 0xffffff
    s_cbranch_scc1 L_zc_14_s
L_zc_14_ok:
    s_xor_b32 s55, s7, 10
    s_mul_i32 s55, s55, 7168
    s_add_u32 s55, s55, s69
    buffer_load_dwordx4 v[168:171], v233, s[24:27], s55 offen offset:0 sc1
    v_mfma_f32_16x16x32_bf16 v[16:19], v[136:139], a[64:67], v[16:19]
    v_cvt_pk_bf16_f32 v36, v36, v37
    v_mfma_f32_16x16x32_bf16 v[44:47], v[136:139], a[68:71], v[44:47]
    v_cvt_pk_bf16_f32 v37, v38, v39
    v_mfma_f32_16x16x32_bf16 v[72:75], v[136:139], a[72:75], v[72:75]
    ds_write_b64 v9, v[36:37] offset:3584
    v_mfma_f32_16x16x32_bf16 v[100:103], v[136:139], a[76:79], v[100:103]
    buffer_load_dwordx4 v[136:139], v233, s[24:27], s55 offen offset:1024 sc1
    v_mfma_f32_16x16x32_bf16 v[20:23], v[164:167], a[64:67], v[20:23]
    v_lshlrev_b32 v2, 16, v241
    v_and_b32 v3, s54, v241
    v_mfma_f32_16x16x32_bf16 v[48:51], v[164:167], a[68:71], v[48:51]
    v_mul_f32 v223, v2, v2
    v_mul_f32 v224, v3, v3
    v_mfma_f32_16x16x32_bf16 v[76:79], v[164:167], a[72:75], v[76:79]
    v_fma_f32 v223, v223, v229, v228
    v_mfma_f32_16x16x32_bf16 v[104:107], v[164:167], a[76:79], v[104:107]
    buffer_load_dwordx4 v[164:167], v233, s[24:27], s55 offen offset:2048 sc1
    s_waitcnt vmcnt(18)
    v_mfma_f32_16x16x32_bf16 v[24:27], v[132:135], a[64:67], v[24:27]
    v_fma_f32 v224, v224, v229, v228
    v_mul_f32 v223, v223, v2
    v_mfma_f32_16x16x32_bf16 v[52:55], v[132:135], a[68:71], v[52:55]
    v_mul_f32 v224, v224, v3
    v_mfma_f32_16x16x32_bf16 v[80:83], v[132:135], a[72:75], v[80:83]
    v_exp_f32 v223, v223
    v_mfma_f32_16x16x32_bf16 v[108:111], v[132:135], a[76:79], v[108:111]
    buffer_load_dwordx4 v[132:135], v233, s[24:27], s55 offen offset:3072 sc1
    v_mfma_f32_16x16x32_bf16 v[28:31], v[160:163], a[64:67], v[28:31]
    v_exp_f32 v224, v224
    v_mfma_f32_16x16x32_bf16 v[56:59], v[160:163], a[68:71], v[56:59]
    v_add_f32 v223, 1.0, v223
    v_add_f32 v224, 1.0, v224
    v_mfma_f32_16x16x32_bf16 v[84:87], v[160:163], a[72:75], v[84:87]
    v_rcp_f32 v223, v223
    v_mfma_f32_16x16x32_bf16 v[112:115], v[160:163], a[76:79], v[112:115]
    s_and_b32 s37, s36, 0xfffffff
    s_cbranch_scc1 L_zc_15_s
L_zc_15_ok:
    s_xor_b32 s64, s7, 12
    s_mul_i32 s64, s64, 7168
    s_add_u32 s64, s64, s69
    buffer_load_dwordx4 v[160:163], v233, s[24:27], s64 offen offset:0 sc1
    v_mfma_f32_16x16x32_bf16 v[16:19], v[128:131], a[80:83], v[16:19]
    v_rcp_f32 v224, v224
    v_mfma_f32_16x16x32_bf16 v[44:47], v[128:131], a[84:87], v[44:47]
    v_mul_f32 v2, v2, v223
    v_mul_f32 v3, v3, v224
    v_mfma_f32_16x16x32_bf16 v[72:75], v[128:131], a[88:91], v[72:75]
    v_cvt_pk_bf16_f32 v241, v2, v3
    v_lshlrev_b32 v2, 16, v242
    v_mfma_f32_16x16x32_bf16 v[100:103], v[128:131], a[92:95], v[100:103]
    buffer_load_dwordx4 v[128:131], v233, s[24:27], s64 offen offset:1024 sc1
    s_waitcnt vmcnt(18)
    v_mfma_f32_16x16x32_bf16 v[20:23], v[192:195], a[80:83], v[20:23]
    v_and_b32 v3, s54, v242
    v_mul_f32 v223, v2, v2
    v_mfma_f32_16x16x32_bf16 v[48:51], v[192:195], a[84:87], v[48:51]
    v_mul_f32 v224, v3, v3
    v_fma_f32 v223, v223, v229, v228
    v_mfma_f32_16x16x32_bf16 v[76:79], v[192:195], a[88:91], v[76:79]
    v_fma_f32 v224, v224, v229, v228
    v_mul_f32 v223, v223, v2
    v_mfma_f32_16x16x32_bf16 v[104:107], v[192:195], a[92:95], v[104:107]
    buffer_load_dwordx4 v[192:195], v233, s[24:27], s64 offen offset:2048 sc1
    v_mfma_f32_16x16x32_bf16 v[24:27], v[196:199], a[80:83], v[24:27]
    v_mul_f32 v224, v224, v3
    v_mfma_f32_16x16x32_bf16 v[52:55], v[196:199], a[84:87], v[52:55]
    v_exp_f32 v223, v223
    v_mfma_f32_16x16x32_bf16 v[80:83], v[196:199], a[88:91], v[80:83]
    v_exp_f32 v224, v224
    v_mfma_f32_16x16x32_bf16 v[108:111], v[196:199], a[92:95], v[108:111]
    buffer_load_dwordx4 v[196:199], v233, s[24:27], s64 offen offset:3072 sc1
    v_mfma_f32_16x16x32_bf16 v[28:31], v[200:203], a[80:83], v[28:31]
    v_add_f32 v223, 1.0, v223
    v_add_f32 v224, 1.0, v224
    v_mfma_f32_16x16x32_bf16 v[56:59], v[200:203], a[84:87], v[56:59]
    v_rcp_f32 v223, v223
    v_mfma_f32_16x16x32_bf16 v[84:87], v[200:203], a[88:91], v[84:87]
    v_rcp_f32 v224, v224
    v_mfma_f32_16x16x32_bf16 v[112:115], v[200:203], a[92:95], v[112:115]
    s_and_b32 s37, s36, -1
    s_cbranch_scc1 L_zc_16_s
L_zc_16_ok:
    s_xor_b32 s65, s7, 14
    s_mul_i32 s65, s65, 7168
    s_add_u32 s65, s65, s69
    buffer_load_dwordx4 v[200:203], v233, s[24:27], s65 offen offset:0 sc1
    s_waitcnt vmcnt(18)
    v_mfma_f32_16x16x32_bf16 v[16:19], v[204:207], a[96:99], v[16:19]
    v_mul_f32 v2, v2, v223
    v_mul_f32 v3, v3, v224
    v_mfma_f32_16x16x32_bf16 v[44:47], v[204:207], a[100:103], v[44:47]
    v_cvt_pk_bf16_f32 v242, v2, v3
    v_lshlrev_b32 v2, 16, v243
    v_mfma_f32_16x16x32_bf16 v[72:75], v[204:207], a[104:107], v[72:75]
    v_and_b32 v3, s54, v243
    v_mul_f32 v223, v2, v2
    v_mfma_f32_16x16x32_bf16 v[100:103], v[204:207], a[108:111], v[100:103]
    buffer_load_dwordx4 v[204:207], v233, s[24:27], s65 offen offset:1024 sc1
    v_mfma_f32_16x16x32_bf16 v[20:23], v[208:211], a[96:99], v[20:23]
    v_mul_f32 v224, v3, v3
    v_fma_f32 v223, v223, v229, v228
    v_mfma_f32_16x16x32_bf16 v[48:51], v[208:211], a[100:103], v[48:51]
    v_fma_f32 v224, v224, v229, v228
    v_mul_f32 v223, v223, v2
    v_mfma_f32_16x16x32_bf16 v[76:79], v[208:211], a[104:107], v[76:79]
    v_mul_f32 v224, v224, v3
    v_mfma_f32_16x16x32_bf16 v[104:107], v[208:211], a[108:111], v[104:107]
    buffer_load_dwordx4 v[208:211], v233, s[24:27], s65 offen offset:2048 sc1
    v_mfma_f32_16x16x32_bf16 v[24:27], v[188:191], a[96:99], v[24:27]
    v_exp_f32 v223, v223
    v_mfma_f32_16x16x32_bf16 v[52:55], v[188:191], a[100:103], v[52:55]
    v_exp_f32 v224, v224
    v_mfma_f32_16x16x32_bf16 v[80:83], v[188:191], a[104:107], v[80:83]
    v_add_f32 v223, 1.0, v223
    v_add_f32 v224, 1.0, v224
    v_mfma_f32_16x16x32_bf16 v[108:111], v[188:191], a[108:111], v[108:111]
    buffer_load_dwordx4 v[188:191], v233, s[24:27], s65 offen offset:3072 sc1
    s_waitcnt vmcnt(18)
    v_mfma_f32_16x16x32_bf16 v[28:31], v[156:159], a[96:99], v[28:31]
    v_rcp_f32 v223, v223
    v_mfma_f32_16x16x32_bf16 v[56:59], v[156:159], a[100:103], v[56:59]
    v_rcp_f32 v224, v224
    v_mfma_f32_16x16x32_bf16 v[84:87], v[156:159], a[104:107], v[84:87]
    v_mul_f32 v2, v2, v223
    v_mul_f32 v3, v3, v224
    v_mfma_f32_16x16x32_bf16 v[112:115], v[156:159], a[108:111], v[112:115]
    s_xor_b32 s66, s7, 9
    s_mul_i32 s66, s66, 7168
    s_add_u32 s66, s66, s69
    buffer_load_dwordx4 v[156:159], v233, s[24:27], s66 offen offset:0 sc1
    v_mfma_f32_16x16x32_bf16 v[16:19], v[184:187], a[112:115], v[16:19]
    v_cvt_pk_bf16_f32 v243, v2, v3
    v_lshlrev_b32 v2, 16, v244
    v_mfma_f32_16x16x32_bf16 v[44:47], v[184:187], a[116:119], v[44:47]
    v_and_b32 v3, s54, v244
    v_mul_f32 v223, v2, v2
    v_mfma_f32_16x16x32_bf16 v[72:75], v[184:187], a[120:123], v[72:75]
    v_mul_f32 v224, v3, v3
    v_fma_f32 v223, v223, v229, v228
    v_mfma_f32_16x16x32_bf16 v[100:103], v[184:187], a[124:127], v[100:103]
    buffer_load_dwordx4 v[184:187], v233, s[24:27], s66 offen offset:1024 sc1
    v_mfma_f32_16x16x32_bf16 v[20:23], v[152:155], a[112:115], v[20:23]
    v_fma_f32 v224, v224, v229, v228
    v_mul_f32 v223, v223, v2
    v_mfma_f32_16x16x32_bf16 v[48:51], v[152:155], a[116:119], v[48:51]
    v_mul_f32 v224, v224, v3
    v_mfma_f32_16x16x32_bf16 v[76:79], v[152:155], a[120:123], v[76:79]
    v_exp_f32 v223, v223
    v_mfma_f32_16x16x32_bf16 v[104:107], v[152:155], a[124:127], v[104:107]
    buffer_load_dwordx4 v[152:155], v233, s[24:27], s66 offen offset:2048 sc1
    s_waitcnt vmcnt(18)
    v_mfma_f32_16x16x32_bf16 v[24:27], v[180:183], a[112:115], v[24:27]
    v_exp_f32 v224, v224
    v_mfma_f32_16x16x32_bf16 v[52:55], v[180:183], a[116:119], v[52:55]
    v_add_f32 v223, 1.0, v223
    v_add_f32 v224, 1.0, v224
    v_mfma_f32_16x16x32_bf16 v[80:83], v[180:183], a[120:123], v[80:83]
    v_rcp_f32 v223, v223
    v_mfma_f32_16x16x32_bf16 v[108:111], v[180:183], a[124:127], v[108:111]
    buffer_load_dwordx4 v[180:183], v233, s[24:27], s66 offen offset:3072 sc1
    v_mfma_f32_16x16x32_bf16 v[28:31], v[148:151], a[112:115], v[28:31]
    v_rcp_f32 v224, v224
    v_mfma_f32_16x16x32_bf16 v[56:59], v[148:151], a[116:119], v[56:59]
    v_mul_f32 v2, v2, v223
    v_mul_f32 v3, v3, v224
    v_mfma_f32_16x16x32_bf16 v[84:87], v[148:151], a[120:123], v[84:87]
    v_cvt_pk_bf16_f32 v244, v2, v3
    v_lshlrev_b32 v2, 16, v245
    v_mfma_f32_16x16x32_bf16 v[112:115], v[148:151], a[124:127], v[112:115]
    s_xor_b32 s67, s7, 11
    s_mul_i32 s67, s67, 7168
    s_add_u32 s67, s67, s69
    buffer_load_dwordx4 v[148:151], v233, s[24:27], s67 offen offset:0 sc1
    v_mfma_f32_16x16x32_bf16 v[16:19], v[176:179], a[128:131], v[16:19]
    v_and_b32 v3, s54, v245
    v_mul_f32 v223, v2, v2
    v_mfma_f32_16x16x32_bf16 v[44:47], v[176:179], a[132:135], v[44:47]
    v_mul_f32 v224, v3, v3
    v_fma_f32 v223, v223, v229, v228
    v_mfma_f32_16x16x32_bf16 v[72:75], v[176:179], a[136:139], v[72:75]
    v_fma_f32 v224, v224, v229, v228
    v_mul_f32 v223, v223, v2
    v_mfma_f32_16x16x32_bf16 v[100:103], v[176:179], a[140:143], v[100:103]
    buffer_load_dwordx4 v[176:179], v233, s[24:27], s67 offen offset:1024 sc1
    s_waitcnt vmcnt(18)
    v_mfma_f32_16x16x32_bf16 v[20:23], v[144:147], a[128:131], v[20:23]
    v_mul_f32 v224, v224, v3
    v_mfma_f32_16x16x32_bf16 v[48:51], v[144:147], a[132:135], v[48:51]
    v_exp_f32 v223, v223
    v_mfma_f32_16x16x32_bf16 v[76:79], v[144:147], a[136:139], v[76:79]
    v_exp_f32 v224, v224
    v_mfma_f32_16x16x32_bf16 v[104:107], v[144:147], a[140:143], v[104:107]
    buffer_load_dwordx4 v[144:147], v233, s[24:27], s67 offen offset:2048 sc1
    v_mfma_f32_16x16x32_bf16 v[24:27], v[172:175], a[128:131], v[24:27]
    v_add_f32 v223, 1.0, v223
    v_add_f32 v224, 1.0, v224
    v_mfma_f32_16x16x32_bf16 v[52:55], v[172:175], a[132:135], v[52:55]
    v_rcp_f32 v223, v223
    v_mfma_f32_16x16x32_bf16 v[80:83], v[172:175], a[136:139], v[80:83]
    v_rcp_f32 v224, v224
    v_mfma_f32_16x16x32_bf16 v[108:111], v[172:175], a[140:143], v[108:111]
    buffer_load_dwordx4 v[172:175], v233, s[24:27], s67 offen offset:3072 sc1
    v_mfma_f32_16x16x32_bf16 v[28:31], v[140:143], a[128:131], v[28:31]
    v_mul_f32 v2, v2, v223
    v_mul_f32 v3, v3, v224
    v_mfma_f32_16x16x32_bf16 v[56:59], v[140:143], a[132:135], v[56:59]
    v_cvt_pk_bf16_f32 v245, v2, v3
    v_lshlrev_b32 v2, 16, v246
    v_mfma_f32_16x16x32_bf16 v[84:87], v[140:143], a[136:139], v[84:87]
    v_and_b32 v3, s54, v246
    v_mul_f32 v223, v2, v2
    v_mfma_f32_16x16x32_bf16 v[112:115], v[140:143], a[140:143], v[112:115]
    s_xor_b32 s94, s7, 13
    s_mul_i32 s94, s94, 7168
    s_add_u32 s94, s94, s69
    buffer_load_dwordx4 v[140:143], v233, s[24:27], s94 offen offset:0 sc1
    s_waitcnt vmcnt(18)
    v_mfma_f32_16x16x32_bf16 v[16:19], v[168:171], a[144:147], v[16:19]
    v_mul_f32 v224, v3, v3
    v_fma_f32 v223, v223, v229, v228
    v_mfma_f32_16x16x32_bf16 v[44:47], v[168:171], a[148:151], v[44:47]
    v_fma_f32 v224, v224, v229, v228
    v_mul_f32 v223, v223, v2
    v_mfma_f32_16x16x32_bf16 v[72:75], v[168:171], a[152:155], v[72:75]
    v_mul_f32 v224, v224, v3
    v_mfma_f32_16x16x32_bf16 v[100:103], v[168:171], a[156:159], v[100:103]
    buffer_load_dwordx4 v[168:171], v233, s[24:27], s94 offen offset:1024 sc1
    v_mfma_f32_16x16x32_bf16 v[20:23], v[136:139], a[144:147], v[20:23]
    v_exp_f32 v223, v223
    v_mfma_f32_16x16x32_bf16 v[48:51], v[136:139], a[148:151], v[48:51]
    v_exp_f32 v224, v224
    v_mfma_f32_16x16x32_bf16 v[76:79], v[136:139], a[152:155], v[76:79]
    v_add_f32 v223, 1.0, v223
    v_add_f32 v224, 1.0, v224
    v_mfma_f32_16x16x32_bf16 v[104:107], v[136:139], a[156:159], v[104:107]
    buffer_load_dwordx4 v[136:139], v233, s[24:27], s94 offen offset:2048 sc1
    v_mfma_f32_16x16x32_bf16 v[24:27], v[164:167], a[144:147], v[24:27]
    v_rcp_f32 v223, v223
    v_mfma_f32_16x16x32_bf16 v[52:55], v[164:167], a[148:151], v[52:55]
    v_rcp_f32 v224, v224
    v_mfma_f32_16x16x32_bf16 v[80:83], v[164:167], a[152:155], v[80:83]
    v_mul_f32 v2, v2, v223
    v_mul_f32 v3, v3, v224
    v_mfma_f32_16x16x32_bf16 v[108:111], v[164:167], a[156:159], v[108:111]
    buffer_load_dwordx4 v[164:167], v233, s[24:27], s94 offen offset:3072 sc1
    s_waitcnt vmcnt(18)
    v_mfma_f32_16x16x32_bf16 v[28:31], v[132:135], a[144:147], v[28:31]
    v_cvt_pk_bf16_f32 v246, v2, v3
    v_lshlrev_b32 v2, 16, v247
    v_mfma_f32_16x16x32_bf16 v[56:59], v[132:135], a[148:151], v[56:59]
    v_and_b32 v3, s54, v247
    v_mul_f32 v223, v2, v2
    v_mfma_f32_16x16x32_bf16 v[84:87], v[132:135], a[152:155], v[84:87]
    v_mul_f32 v224, v3, v3
    v_fma_f32 v223, v223, v229, v228
    v_mfma_f32_16x16x32_bf16 v[112:115], v[132:135], a[156:159], v[112:115]
    s_xor_b32 s95, s7, 15
    s_mul_i32 s95, s95, 7168
    s_add_u32 s95, s95, s69
    buffer_load_dwordx4 v[132:135], v233, s[24:27], s95 offen offset:0 sc1
    v_mfma_f32_16x16x32_bf16 v[16:19], v[160:163], a[160:163], v[16:19]
    v_fma_f32 v224, v224, v229, v228
    v_mul_f32 v223, v223, v2
    v_mfma_f32_16x16x32_bf16 v[44:47], v[160:163], a[164:167], v[44:47]
    v_mul_f32 v224, v224, v3
    v_mfma_f32_16x16x32_bf16 v[72:75], v[160:163], a[168:171], v[72:75]
    v_exp_f32 v223, v223
    v_mfma_f32_16x16x32_bf16 v[100:103], v[160:163], a[172:175], v[100:103]
    buffer_load_dwordx4 v[160:163], v233, s[24:27], s95 offen offset:1024 sc1
    v_mfma_f32_16x16x32_bf16 v[20:23], v[128:131], a[160:163], v[20:23]
    v_exp_f32 v224, v224
    v_mfma_f32_16x16x32_bf16 v[48:51], v[128:131], a[164:167], v[48:51]
    v_add_f32 v223, 1.0, v223
    v_add_f32 v224, 1.0, v224
    v_mfma_f32_16x16x32_bf16 v[76:79], v[128:131], a[168:171], v[76:79]
    v_rcp_f32 v223, v223
    v_mfma_f32_16x16x32_bf16 v[104:107], v[128:131], a[172:175], v[104:107]
    buffer_load_dwordx4 v[128:131], v233, s[24:27], s95 offen offset:2048 sc1
    s_waitcnt vmcnt(18)
    v_mfma_f32_16x16x32_bf16 v[24:27], v[192:195], a[160:163], v[24:27]
    v_rcp_f32 v224, v224
    v_mfma_f32_16x16x32_bf16 v[52:55], v[192:195], a[164:167], v[52:55]
    v_mul_f32 v2, v2, v223
    v_mul_f32 v3, v3, v224
    v_mfma_f32_16x16x32_bf16 v[80:83], v[192:195], a[168:171], v[80:83]
    v_cvt_pk_bf16_f32 v247, v2, v3
    v_lshrrev_b32 v226, 3, v1
    v_mfma_f32_16x16x32_bf16 v[108:111], v[192:195], a[172:175], v[108:111]
    buffer_load_dwordx4 v[192:195], v233, s[24:27], s95 offen offset:3072 sc1
    v_mfma_f32_16x16x32_bf16 v[28:31], v[196:199], a[160:163], v[28:31]
    v_and_b32 v220, 0x70, v233
    v_mfma_f32_16x16x32_bf16 v[56:59], v[196:199], a[164:167], v[56:59]
    v_mul_u32_u24 v226, 57344, v226
    v_add_u32 v220, v220, v226
    v_mfma_f32_16x16x32_bf16 v[84:87], v[196:199], a[168:171], v[84:87]
    v_add_u32 v234, s38, v233
    v_add_u32 v235, s39, v233
    v_mfma_f32_16x16x32_bf16 v[112:115], v[196:199], a[172:175], v[112:115]
    buffer_load_dwordx4 v[196:199], v222, s[24:27], s70 offen offset:0 sc1
    v_mfma_f32_16x16x32_bf16 v[16:19], v[200:203], a[176:179], v[16:19]
    v_add_u32 v236, s43, v233
    v_add_u32 v237, s42, v233
    v_mfma_f32_16x16x32_bf16 v[44:47], v[200:203], a[180:183], v[44:47]
    s_barrier
    v_mfma_f32_16x16x32_bf16 v[72:75], v[200:203], a[184:187], v[72:75]
    v_lshlrev_b32 v32, 16, v232
    v_lshlrev_b32 v33, 16, v232
    v_mfma_f32_16x16x32_bf16 v[100:103], v[200:203], a[188:191], v[100:103]
    buffer_load_dwordx4 v[200:203], v222, s[24:27], s70 offen offset:1024 sc1
    s_waitcnt vmcnt(18)
    v_mfma_f32_16x16x32_bf16 v[20:23], v[204:207], a[176:179], v[20:23]
    v_lshlrev_b32 v34, 16, v232
    v_lshlrev_b32 v35, 16, v232
    v_mfma_f32_16x16x32_bf16 v[48:51], v[204:207], a[180:183], v[48:51]
    v_lshrrev_b32 v216, 5, v1
    v_lshlrev_b32 v216, 8, v216
    v_mfma_f32_16x16x32_bf16 v[76:79], v[204:207], a[184:187], v[76:79]
    v_and_b32 v217, 15, v1
    v_lshl_add_u32 v225, v217, 4, v216
    v_mfma_f32_16x16x32_bf16 v[104:107], v[204:207], a[188:191], v[104:107]
    buffer_load_dwordx4 v[204:207], v222, s[24:27], s70 offen offset:2048 sc1
    v_mfma_f32_16x16x32_bf16 v[24:27], v[208:211], a[176:179], v[24:27]
    v_and_b32 v212, 1, v1
    v_lshlrev_b32 v212, 4, v212
    v_mfma_f32_16x16x32_bf16 v[52:55], v[208:211], a[180:183], v[52:55]
    v_mov_b32 v213, 0x3f80
    v_lshlrev_b32 v212, v212, v213
    v_mfma_f32_16x16x32_bf16 v[80:83], v[208:211], a[184:187], v[80:83]
    v_bfe_u32 v213, v1, 1, 3
    v_lshrrev_b32 v218, 3, v1
    v_mfma_f32_16x16x32_bf16 v[108:111], v[208:211], a[188:191], v[108:111]
    buffer_load_dwordx4 v[208:211], v222, s[24:27], s71 offen offset:0 sc1
    v_mfma_f32_16x16x32_bf16 v[28:31], v[188:191], a[176:179], v[28:31]
    v_and_b32 v218, 6, v218
    v_sub_u32 v213, v213, v218
    v_mfma_f32_16x16x32_bf16 v[56:59], v[188:191], a[180:183], v[56:59]
    v_cmp_eq_u32 vcc, 0, v213
    v_mov_b32 v218, 0
    v_mfma_f32_16x16x32_bf16 v[84:87], v[188:191], a[184:187], v[84:87]
    v_cndmask_b32 v214, 0, v212, vcc
    v_cndmask_b32 v216, 0, v212, vcc
    v_mfma_f32_16x16x32_bf16 v[112:115], v[188:191], a[188:191], v[112:115]
    buffer_load_dwordx4 v[188:191], v222, s[24:27], s71 offen offset:1024 sc1
    s_waitcnt vmcnt(18)
    v_mfma_f32_16x16x32_bf16 v[16:19], v[156:159], a[192:195], v[16:19]
    v_cmp_eq_u32 vcc, 1, v213
    v_mov_b32 v219, 0
    v_mfma_f32_16x16x32_bf16 v[44:47], v[156:159], a[196:199], v[44:47]
    v_cndmask_b32 v215, 0, v212, vcc
    v_cndmask_b32 v217, 0, v212, vcc
    v_mfma_f32_16x16x32_bf16 v[72:75], v[156:159], a[200:203], v[72:75]
    v_mov_b32 v212, 0
    v_mov_b32 v213, 0
    v_mfma_f32_16x16x32_bf16 v[100:103], v[156:159], a[204:207], v[100:103]
    buffer_load_dwordx4 v[156:159], v222, s[24:27], s71 offen offset:2048 sc1
    v_mfma_f32_16x16x32_bf16 v[20:23], v[184:187], a[192:195], v[20:23]
    v_cmp_ne_u32 vcc, s100, v11
    s_cbranch_vccnz L_poll_17_s
L_poll_17_ok:
    v_cmp_ne_u32 vcc, s100, v10
    s_cbranch_vccnz L_poll_18_s
L_poll_18_ok:
    v_mfma_f32_16x16x32_bf16 v[48:51], v[184:187], a[196:199], v[48:51]
    v_and_b32 v11, 15, v1
    v_mul_u32_u24 v6, 896, v11
    v_mfma_f32_16x16x32_bf16 v[76:79], v[184:187], a[200:203], v[76:79]
    v_and_b32 v12, 16, v1
    v_lshl_add_u32 v6, v12, 1, v6
    v_mfma_f32_16x16x32_bf16 v[104:107], v[184:187], a[204:207], v[104:107]
    buffer_load_dwordx4 v[184:187], v222, s[24:27], s40 offen offset:0 sc1
    v_mfma_f32_16x16x32_bf16 v[24:27], v[152:155], a[192:195], v[24:27]
    v_lshrrev_b32 v12, 5, v1
    v_lshl_add_u32 v6, v12, 4, v6
    v_mfma_f32_16x16x32_bf16 v[52:55], v[152:155], a[196:199], v[52:55]
    v_lshl_add_u32 v13, v1, 3, s42
    v_lshrrev_b32 v11, 2, v1
    v_mfma_f32_16x16x32_bf16 v[80:83], v[152:155], a[200:203], v[80:83]
    v_lshlrev_b32 v11, 7, v11
    v_and_b32 v12, 3, v1
    v_mfma_f32_16x16x32_bf16 v[108:111], v[152:155], a[204:207], v[108:111]
    buffer_load_dwordx4 v[152:155], v222, s[24:27], s40 offen offset:1024 sc1
    s_waitcnt vmcnt(18)
    v_mfma_f32_16x16x32_bf16 v[28:31], v[180:183], a[192:195], v[28:31]
    v_lshl_add_u32 v11, v12, 3, v11
    v_mfma_f32_16x16x32_bf16 v[56:59], v[180:183], a[196:199], v[56:59]
    v_bfe_u32 v12, v1, 3, 2
    v_mfma_f32_16x16x32_bf16 v[84:87], v[180:183], a[200:203], v[84:87]
    v_lshl_add_u32 v4, v12, 5, v11
    v_xor_b32 v5, 32, v4
    v_mfma_f32_16x16x32_bf16 v[112:115], v[180:183], a[204:207], v[112:115]
    buffer_load_dwordx4 v[180:183], v222, s[24:27], s40 offen offset:2048 sc1
    v_mfma_f32_16x16x32_bf16 v[16:19], v[148:151], a[208:211], v[16:19]
    v_xor_b32 v14, 64, v4
    v_xor_b32 v15, 64, v5
    v_mfma_f32_16x16x32_bf16 v[44:47], v[148:151], a[212:215], v[44:47]
    v_bfe_u32 v11, v1, 3, 2
    v_mfma_f32_16x16x32_bf16 v[72:75], v[148:151], a[216:219], v[72:75]
    v_mul_u32_u24 v9, 7168, v11
    v_lshlrev_b32 v12, 2, v1
    v_mfma_f32_16x16x32_bf16 v[100:103], v[148:151], a[220:223], v[100:103]
    buffer_load_dwordx4 v[148:151], v222, s[24:27], s41 offen offset:0 sc1
    v_mfma_f32_16x16x32_bf16 v[20:23], v[176:179], a[208:211], v[20:23]
    s_mov_b32 s62, 0xeca87642
    v_mfma_f32_16x16x32_bf16 v[48:51], v[176:179], a[212:215], v[48:51]
    v_bfe_u32 v11, s62, v12, 4
    v_mfma_f32_16x16x32_bf16 v[76:79], v[176:179], a[216:219], v[76:79]
    v_lshl_add_u32 v9, v11, 9, v9
    v_lshrrev_b32 v11, 1, v1
    v_mfma_f32_16x16x32_bf16 v[104:107], v[176:179], a[220:223], v[104:107]
    buffer_load_dwordx4 v[176:179], v222, s[24:27], s41 offen offset:1024 sc1
    s_waitcnt vmcnt(18)
    v_mfma_f32_16x16x32_bf16 v[24:27], v[144:147], a[208:211], v[24:27]
    v_and_b32 v12, 1, v1
    v_lshlrev_b32 v8, 7, v11
    v_mfma_f32_16x16x32_bf16 v[52:55], v[144:147], a[212:215], v[52:55]
    v_lshl_add_u32 v8, v12, 4, v8
    v_lshrrev_b32 v11, 5, v1
    v_mfma_f32_16x16x32_bf16 v[80:83], v[144:147], a[216:219], v[80:83]
    v_lshl_add_u32 v9, v11, 30, v9
    v_add_u32 v227, 8, v237
    v_mfma_f32_16x16x32_bf16 v[108:111], v[144:147], a[220:223], v[108:111]
    buffer_load_dwordx4 v[144:147], v222, s[24:27], s41 offen offset:2048 sc1
    v_mfma_f32_16x16x32_bf16 v[28:31], v[172:175], a[208:211], v[28:31]
    v_lshlrev_b32 v2, 16, v248
    v_and_b32 v3, s54, v248
    v_mfma_f32_16x16x32_bf16 v[56:59], v[172:175], a[212:215], v[56:59]
    v_mul_f32 v223, v2, v2
    v_mul_f32 v224, v3, v3
    v_mfma_f32_16x16x32_bf16 v[84:87], v[172:175], a[216:219], v[84:87]
    v_fma_f32 v223, v223, v229, v228
    v_mfma_f32_16x16x32_bf16 v[112:115], v[172:175], a[220:223], v[112:115]
    buffer_load_dwordx4 v[172:175], v222, s[24:27], s45 offen offset:0 sc1
    v_mfma_f32_16x16x32_bf16 v[16:19], v[140:143], a[224:227], v[16:19]
    v_fma_f32 v224, v224, v229, v228
    v_mul_f32 v223, v223, v2
    v_mfma_f32_16x16x32_bf16 v[44:47], v[140:143], a[228:231], v[44:47]
    v_mul_f32 v224, v224, v3
    v_mfma_f32_16x16x32_bf16 v[72:75], v[140:143], a[232:235], v[72:75]
    v_exp_f32 v223, v223
    v_mfma_f32_16x16x32_bf16 v[100:103], v[140:143], a[236:239], v[100:103]
    buffer_load_dwordx4 v[140:143], v222, s[24:27], s45 offen offset:1024 sc1
    s_waitcnt vmcnt(18)
    v_mfma_f32_16x16x32_bf16 v[20:23], v[168:171], a[224:227], v[20:23]
    v_exp_f32 v224, v224
    v_mfma_f32_16x16x32_bf16 v[48:51], v[168:171], a[228:231], v[48:51]
    v_add_f32 v223, 1.0, v223
    v_add_f32 v224, 1.0, v224
    v_mfma_f32_16x16x32_bf16 v[76:79], v[168:171], a[232:235], v[76:79]
    v_rcp_f32 v223, v223
    v_mfma_f32_16x16x32_bf16 v[104:107], v[168:171], a[236:239], v[104:107]
    buffer_load_dwordx4 v[168:171], v222, s[24:27], s45 offen offset:2048 sc1
    v_mfma_f32_16x16x32_bf16 v[24:27], v[136:139], a[224:227], v[24:27]
    v_rcp_f32 v224, v224
    v_mfma_f32_16x16x32_bf16 v[52:55], v[136:139], a[228:231], v[52:55]
    v_mul_f32 v2, v2, v223
    v_mul_f32 v3, v3, v224
    v_mfma_f32_16x16x32_bf16 v[80:83], v[136:139], a[232:235], v[80:83]
    v_cvt_pk_bf16_f32 v248, v2, v3
    v_lshlrev_b32 v2, 16, v249
    v_mfma_f32_16x16x32_bf16 v[108:111], v[136:139], a[236:239], v[108:111]
    buffer_load_dwordx4 v[136:139], v222, s[24:27], s46 offen offset:0 sc1
    v_mfma_f32_16x16x32_bf16 v[28:31], v[164:167], a[224:227], v[28:31]
    v_and_b32 v3, s54, v249
    v_mul_f32 v223, v2, v2
    v_mfma_f32_16x16x32_bf16 v[56:59], v[164:167], a[228:231], v[56:59]
    v_mul_f32 v224, v3, v3
    v_fma_f32 v223, v223, v229, v228
    v_mfma_f32_16x16x32_bf16 v[84:87], v[164:167], a[232:235], v[84:87]
    v_fma_f32 v224, v224, v229, v228
    v_mul_f32 v223, v223, v2
    v_mfma_f32_16x16x32_bf16 v[112:115], v[164:167], a[236:239], v[112:115]
    buffer_load_dwordx4 v[164:167], v222, s[24:27], s46 offen offset:1024 sc1
    s_waitcnt vmcnt(18)
    v_mfma_f32_16x16x32_bf16 v[44:47], v[132:135], a[244:247], v[44:47]
    v_mul_f32 v224, v224, v3
    v_mfma_f32_16x16x32_bf16 v[48:51], v[160:163], a[244:247], v[48:51]
    v_exp_f32 v223, v223
    v_mfma_f32_16x16x32_bf16 v[52:55], v[128:131], a[244:247], v[52:55]
    v_exp_f32 v224, v224
    s_waitcnt vmcnt(15)
    v_mfma_f32_16x16x32_bf16 v[56:59], v[192:195], a[244:247], v[56:59]
    s_nop 0
    v_cvt_pk_bf16_f32 v44, v44, v45
    v_cvt_pk_bf16_f32 v45, v46, v47
    v_mfma_f32_16x16x32_bf16 v[72:75], v[132:135], a[248:251], v[72:75]
    v_cvt_pk_bf16_f32 v46, v48, v49
    v_cvt_pk_bf16_f32 v47, v50, v51
    v_mfma_f32_16x16x32_bf16 v[76:79], v[160:163], a[248:251], v[76:79]
    ds_write_b128 v234, v[44:47] offset:0
    v_mfma_f32_16x16x32_bf16 v[80:83], v[128:131], a[248:251], v[80:83]
    v_cvt_pk_bf16_f32 v52, v52, v53
    v_cvt_pk_bf16_f32 v53, v54, v55
    v_mfma_f32_16x16x32_bf16 v[84:87], v[192:195], a[248:251], v[84:87]
    v_cvt_pk_bf16_f32 v54, v56, v57
    v_cvt_pk_bf16_f32 v55, v58, v59
    v_mfma_f32_16x16x32_bf16 v[100:103], v[132:135], a[252:255], v[100:103]
    ds_write_b128 v234, v[52:55] offset:1024
    v_mfma_f32_16x16x32_bf16 v[104:107], v[160:163], a[252:255], v[104:107]
    v_cvt_pk_bf16_f32 v72, v72, v73
    v_cvt_pk_bf16_f32 v73, v74, v75
    v_mfma_f32_16x16x32_bf16 v[108:111], v[128:131], a[252:255], v[108:111]
    v_cvt_pk_bf16_f32 v74, v76, v77
    v_cvt_pk_bf16_f32 v75, v78, v79
    v_mfma_f32_16x16x32_bf16 v[112:115], v[192:195], a[252:255], v[112:115]
    ds_write_b128 v235, v[72:75] offset:0
    v_mfma_f32_16x16x32_bf16 v[16:19], v[132:135], a[240:243], v[16:19]
    buffer_load_dwordx4 v[132:135], v222, s[24:27], s46 offen offset:2048 sc1
    v_mfma_f32_16x16x32_bf16 v[20:23], v[160:163], a[240:243], v[20:23]
    v_cvt_pk_bf16_f32 v80, v80, v81
    v_cvt_pk_bf16_f32 v81, v82, v83
    v_mfma_f32_16x16x32_bf16 v[24:27], v[128:131], a[240:243], v[24:27]
    v_cvt_pk_bf16_f32 v82, v84, v85
    v_cvt_pk_bf16_f32 v83, v86, v87
    v_mfma_f32_16x16x32_bf16 v[28:31], v[192:195], a[240:243], v[28:31]
    buffer_load_dwordx4 v[160:163], v222, s[24:27], s47 offen offset:0 sc1
    s_waitcnt vmcnt(14)
    v_mfma_f32_16x16x32_bf16 v[40:43], v[204:207], a[0:3], v[32:35]
    ds_write_b128 v235, v[80:83] offset:1024
    v_mfma_f32_16x16x32_bf16 v[68:71], v[204:207], a[4:7], 0
    v_cvt_pk_bf16_f32 v100, v100, v101
    v_cvt_pk_bf16_f32 v101, v102, v103
    v_mfma_f32_16x16x32_bf16 v[96:99], v[204:207], a[8:11], 0
    buffer_load_dwordx4 v[128:131], v222, s[24:27], s47 offen offset:1024 sc1
    v_mfma_f32_16x16x32_bf16 v[124:127], v[204:207], a[12:15], 0
    v_cvt_pk_bf16_f32 v102, v104, v105
    v_cvt_pk_bf16_f32 v103, v106, v107
    v_mfma_f32_16x16x32_bf16 v[36:39], v[200:203], a[0:3], v[32:35]
    ds_write_b128 v236, v[100:103] offset:0
    v_mfma_f32_16x16x32_bf16 v[64:67], v[200:203], a[4:7], 0
    buffer_load_dwordx4 v[192:195], v222, s[24:27], s47 offen offset:2048 sc1
    v_mfma_f32_16x16x32_bf16 v[92:95], v[200:203], a[8:11], 0
    v_cvt_pk_bf16_f32 v108, v108, v109
    v_cvt_pk_bf16_f32 v109, v110, v111
    v_mfma_f32_16x16x32_bf16 v[120:123], v[200:203], a[12:15], 0
    v_cvt_pk_bf16_f32 v110, v112, v113
    v_cvt_pk_bf16_f32 v111, v114, v115
    v_mfma_f32_16x16x32_bf16 v[32:35], v[196:199], a[0:3], v[32:35]
    buffer_load_dwordx4 v[204:207], v222, s[24:27], s52 offen offset:0 sc1
    v_mfma_f32_16x16x32_bf16 v[60:63], v[196:199], a[4:7], 0
    ds_write_b128 v236, v[108:111] offset:1024
    v_mfma_f32_16x16x32_bf16 v[88:91], v[196:199], a[8:11], 0
    ds_read_b128 v[108:111], v221 offset:0
    ds_read_b128 v[112:115], v221 offset:3072
    v_mfma_f32_16x16x32_bf16 v[116:119], v[196:199], a[12:15], 0
    buffer_load_dwordx4 v[200:203], v222, s[24:27], s52 offen offset:1024 sc1
    v_mfma_f32_16x16x32_bf16 v[32:35], v[208:211], a[16:19], v[32:35]
    v_add_f32 v223, 1.0, v223
    v_add_f32 v224, 1.0, v224
    v_mfma_f32_16x16x32_bf16 v[60:63], v[208:211], a[20:23], v[60:63]
    v_rcp_f32 v223, v223
    v_mfma_f32_16x16x32_bf16 v[88:91], v[208:211], a[24:27], v[88:91]
    buffer_load_dwordx4 v[196:199], v222, s[24:27], s52 offen offset:2048 sc1
    v_mfma_f32_16x16x32_bf16 v[116:119], v[208:211], a[28:31], v[116:119]
    s_waitcnt lgkmcnt(0)
    s_barrier
    v_mfma_f32_16x16x32_bf16 v[36:39], v[188:191], a[16:19], v[36:39]
    ds_read_b128 v[100:103], v237 offset:6144
    ds_read2st64_b64 v[72:75], v237 offset0:0 offset1:6
    v_mfma_f32_16x16x32_bf16 v[64:67], v[188:191], a[20:23], v[64:67]
    buffer_load_dwordx4 v[208:211], v222, s[24:27], s53 offen offset:0 sc1
    v_mfma_f32_16x16x32_bf16 v[92:95], v[188:191], a[24:27], v[92:95]
    ds_read2st64_b64 v[76:79], v227 offset0:0 offset1:6
    ds_read_b128 v[104:107], v237 offset:7168
    v_mfma_f32_16x16x32_bf16 v[120:123], v[188:191], a[28:31], v[120:123]
    ds_read2st64_b64 v[80:83], v237 offset0:2 offset1:8
    ds_read2st64_b64 v[84:87], v227 offset0:2 offset1:8
    s_waitcnt vmcnt(17)
    v_mfma_f32_16x16x32_bf16 v[40:43], v[156:159], a[16:19], v[40:43]
    buffer_load_dwordx4 v[188:191], v222, s[24:27], s53 offen offset:1024 sc1
    v_mfma_f32_16x16x32_bf16 v[68:71], v[156:159], a[20:23], v[68:71]
    v_lshlrev_b32 v44, 16, v240
    v_and_b32 v45, s54, v240
    v_mfma_f32_16x16x32_bf16 v[96:99], v[156:159], a[24:27], v[96:99]
    v_lshlrev_b32 v46, 16, v241
    v_and_b32 v47, s54, v241
    v_mfma_f32_16x16x32_bf16 v[124:127], v[156:159], a[28:31], v[124:127]
    buffer_load_dwordx4 v[156:159], v222, s[24:27], s53 offen offset:2048 sc1
    s_waitcnt lgkmcnt(4)
    v_mfma_f32_16x16x32_bf16 v[16:19], v[214:217], v[72:75], v[16:19]
    v_lshlrev_b32 v48, 16, v242
    v_and_b32 v49, s54, v242
    v_mfma_f32_16x16x32_bf16 v[32:35], v[184:187], a[32:35], v[32:35]
    v_lshlrev_b32 v50, 16, v243
    v_and_b32 v51, s54, v243
    v_mfma_f32_16x16x32_bf16 v[16:19], v[216:219], v[100:103], v[16:19]
    v_lshlrev_b32 v52, 16, v244
    v_and_b32 v53, s54, v244
    v_mfma_f32_16x16x32_bf16 v[60:63], v[184:187], a[36:39], v[60:63]
    v_lshlrev_b32 v54, 16, v245
    v_and_b32 v55, s54, v245
    v_mfma_f32_16x16x32_bf16 v[88:91], v[184:187], a[40:43], v[88:91]
    v_lshlrev_b32 v56, 16, v246
    v_and_b32 v57, s54, v246
    s_waitcnt lgkmcnt(3)
    v_mfma_f32_16x16x32_bf16 v[20:23], v[214:217], v[76:79], v[20:23]
    v_mul_f32 v16, v16, v44
    v_mul_f32 v17, v17, v45
    v_mfma_f32_16x16x32_bf16 v[116:119], v[184:187], a[44:47], v[116:119]
    buffer_load_dwordx4 v[184:187], v222, s[24:27], s55 offen offset:0 sc1
    v_mfma_f32_16x16x32_bf16 v[20:23], v[212:215], v[100:103], v[20:23]
    v_mul_f32 v18, v18, v46
    v_mul_f32 v19, v19, v47
    v_mfma_f32_16x16x32_bf16 v[36:39], v[152:155], a[32:35], v[36:39]
    v_cvt_pk_bf16_f32 v240, v16, v17
    v_cvt_pk_bf16_f32 v241, v18, v19
    v_mfma_f32_16x16x32_bf16 v[64:67], v[152:155], a[36:39], v[64:67]
    v_lshlrev_b32 v58, 16, v247
    v_and_b32 v59, s54, v247
    s_waitcnt lgkmcnt(1)
    v_mfma_f32_16x16x32_bf16 v[24:27], v[214:217], v[80:83], v[24:27]
    v_mul_f32 v20, v20, v48
    v_mul_f32 v21, v21, v49
    v_mfma_f32_16x16x32_bf16 v[92:95], v[152:155], a[40:43], v[92:95]
    v_mul_f32 v22, v22, v50
    v_mul_f32 v23, v23, v51
    v_mfma_f32_16x16x32_bf16 v[24:27], v[216:219], v[104:107], v[24:27]
    v_cvt_pk_bf16_f32 v242, v20, v21
    v_cvt_pk_bf16_f32 v243, v22, v23
    v_mfma_f32_16x16x32_bf16 v[120:123], v[152:155], a[44:47], v[120:123]
    buffer_load_dwordx4 v[152:155], v222, s[24:27], s55 offen offset:1024 sc1
    s_waitcnt vmcnt(18)
    v_mfma_f32_16x16x32_bf16 v[40:43], v[180:183], a[32:35], v[40:43]
    buffer_store_dwordx4 v[240:243], v233, s[24:27], s72 offen offset:0 sc1
    s_waitcnt lgkmcnt(0)
    v_mfma_f32_16x16x32_bf16 v[28:31], v[214:217], v[84:87], v[28:31]
    v_mul_f32 v24, v24, v52
    v_mul_f32 v25, v25, v53
    v_mfma_f32_16x16x32_bf16 v[68:71], v[180:183], a[36:39], v[68:71]
    v_mul_f32 v26, v26, v54
    v_mul_f32 v27, v27, v55
    v_mfma_f32_16x16x32_bf16 v[28:31], v[212:215], v[104:107], v[28:31]
    v_cvt_pk_bf16_f32 v244, v24, v25
    v_cvt_pk_bf16_f32 v245, v26, v27
    v_mfma_f32_16x16x32_bf16 v[96:99], v[180:183], a[40:43], v[96:99]
    v_rcp_f32 v224, v224
    v_mfma_f32_16x16x32_bf16 v[124:127], v[180:183], a[44:47], v[124:127]
    buffer_load_dwordx4 v[180:183], v222, s[24:27], s55 offen offset:2048 sc1
    v_mfma_f32_16x16x32_bf16 v[32:35], v[148:151], a[48:51], v[32:35]
    s_nop 0
    v_mul_f32 v28, v28, v56
    v_mul_f32 v29, v29, v57
    v_mfma_f32_16x16x32_bf16 v[60:63], v[148:151], a[52:55], v[60:63]
    v_mul_f32 v30, v30, v58
    v_mul_f32 v31, v31, v59
    v_mfma_f32_16x16x32_bf16 v[88:91], v[148:151], a[56:59], v[88:91]
    v_cvt_pk_bf16_f32 v246, v28, v29
    v_cvt_pk_bf16_f32 v247, v30, v31
    v_mfma_f32_16x16x32_bf16 v[116:119], v[148:151], a[60:63], v[116:119]
    buffer_load_dwordx4 v[148:151], v222, s[24:27], s64 offen offset:0 sc1
    v_mfma_f32_16x16x32_bf16 v[36:39], v[176:179], a[48:51], v[36:39]
    buffer_store_dwordx4 v[244:247], v233, s[24:27], s72 offen offset:1024 sc1
    v_mfma_f32_16x16x32_bf16 v[64:67], v[176:179], a[52:55], v[64:67]
    v_mul_f32 v2, v2, v223
    v_mfma_f32_16x16x32_bf16 v[92:95], v[176:179], a[56:59], v[92:95]
    v_mul_f32 v3, v3, v224
    v_cvt_pk_bf16_f32 v249, v2, v3
    v_mfma_f32_16x16x32_bf16 v[120:123], v[176:179], a[60:63], v[120:123]
    buffer_load_dwordx4 v[176:179], v222, s[24:27], s64 offen offset:1024 sc1
    s_waitcnt vmcnt(20)
    v_mfma_f32_16x16x32_bf16 v[40:43], v[144:147], a[48:51], v[40:43]
    v_lshlrev_b32 v2, 16, v250
    v_and_b32 v3, s54, v250
    v_mfma_f32_16x16x32_bf16 v[68:71], v[144:147], a[52:55], v[68:71]
    v_mul_f32 v223, v2, v2
    v_mul_f32 v224, v3, v3
    v_mfma_f32_16x16x32_bf16 v[96:99], v[144:147], a[56:59], v[96:99]
    v_fma_f32 v223, v223, v229, v228
    v_mfma_f32_16x16x32_bf16 v[124:127], v[144:147], a[60:63], v[124:127]
    buffer_load_dwordx4 v[144:147], v222, s[24:27], s64 offen offset:2048 sc1
    v_mfma_f32_16x16x32_bf16 v[32:35], v[172:175], a[64:67], v[32:35]
    v_fma_f32 v224, v224, v229, v228
    v_mul_f32 v223, v223, v2
    v_mfma_f32_16x16x32_bf16 v[60:63], v[172:175], a[68:71], v[60:63]
    v_mul_f32 v224, v224, v3
    v_mfma_f32_16x16x32_bf16 v[88:91], v[172:175], a[72:75], v[88:91]
    v_exp_f32 v223, v223
    v_mfma_f32_16x16x32_bf16 v[116:119], v[172:175], a[76:79], v[116:119]
    buffer_load_dwordx4 v[172:175], v222, s[24:27], s65 offen offset:0 sc1
    v_mfma_f32_16x16x32_bf16 v[36:39], v[140:143], a[64:67], v[36:39]
    v_exp_f32 v224, v224
    v_mfma_f32_16x16x32_bf16 v[64:67], v[140:143], a[68:71], v[64:67]
    v_add_f32 v223, 1.0, v223
    v_add_f32 v224, 1.0, v224
    v_mfma_f32_16x16x32_bf16 v[92:95], v[140:143], a[72:75], v[92:95]
    v_rcp_f32 v223, v223
    v_mfma_f32_16x16x32_bf16 v[120:123], v[140:143], a[76:79], v[120:123]
    buffer_load_dwordx4 v[140:143], v222, s[24:27], s65 offen offset:1024 sc1
    s_waitcnt vmcnt(20)
    v_mfma_f32_16x16x32_bf16 v[40:43], v[168:171], a[64:67], v[40:43]
    v_rcp_f32 v224, v224
    v_mfma_f32_16x16x32_bf16 v[68:71], v[168:171], a[68:71], v[68:71]
    v_mul_f32 v2, v2, v223
    v_mul_f32 v3, v3, v224
    v_mfma_f32_16x16x32_bf16 v[96:99], v[168:171], a[72:75], v[96:99]
    v_cvt_pk_bf16_f32 v250, v2, v3
    v_lshlrev_b32 v2, 16, v251
    v_mfma_f32_16x16x32_bf16 v[124:127], v[168:171], a[76:79], v[124:127]
    buffer_load_dwordx4 v[168:171], v222, s[24:27], s65 offen offset:2048 sc1
    v_mfma_f32_16x16x32_bf16 v[32:35], v[136:139], a[80:83], v[32:35]
    v_and_b32 v3, s54, v251
    v_mul_f32 v223, v2, v2
    v_mfma_f32_16x16x32_bf16 v[60:63], v[136:139], a[84:87], v[60:63]
    v_mul_f32 v224, v3, v3
    v_fma_f32 v223, v223, v229, v228
    v_mfma_f32_16x16x32_bf16 v[88:91], v[136:139], a[88:91], v[88:91]
    v_fma_f32 v224, v224, v229, v228
    v_mul_f32 v223, v223, v2
    v_mfma_f32_16x16x32_bf16 v[116:119], v[136:139], a[92:95], v[116:119]
    buffer_load_dwordx4 v[136:139], v222, s[24:27], s66 offen offset:0 sc1
    v_mfma_f32_16x16x32_bf16 v[36:39], v[164:167], a[80:83], v[36:39]
    v_mul_f32 v224, v224, v3
    v_mfma_f32_16x16x32_bf16 v[64:67], v[164:167], a[84:87], v[64:67]
    v_exp_f32 v223, v223
    v_mfma_f32_16x16x32_bf16 v[92:95], v[164:167], a[88:91], v[92:95]
    v_exp_f32 v224, v224
    v_mfma_f32_16x16x32_bf16 v[120:123], v[164:167], a[92:95], v[120:123]
    buffer_load_dwordx4 v[164:167], v222, s[24:27], s66 offen offset:1024 sc1
    s_waitcnt vmcnt(20)
    v_mfma_f32_16x16x32_bf16 v[40:43], v[132:135], a[80:83], v[40:43]
    v_add_f32 v223, 1.0, v223
    v_add_f32 v224, 1.0, v224
    v_mfma_f32_16x16x32_bf16 v[68:71], v[132:135], a[84:87], v[68:71]
    v_rcp_f32 v223, v223
    v_mfma_f32_16x16x32_bf16 v[96:99], v[132:135], a[88:91], v[96:99]
    v_rcp_f32 v224, v224
    v_mfma_f32_16x16x32_bf16 v[124:127], v[132:135], a[92:95], v[124:127]
    buffer_load_dwordx4 v[132:135], v222, s[24:27], s66 offen offset:2048 sc1
    v_mfma_f32_16x16x32_bf16 v[32:35], v[160:163], a[96:99], v[32:35]
    v_mul_f32 v2, v2, v223
    v_mul_f32 v3, v3, v224
    v_mfma_f32_16x16x32_bf16 v[60:63], v[160:163], a[100:103], v[60:63]
    v_cvt_pk_bf16_f32 v251, v2, v3
    v_lshlrev_b32 v2, 16, v252
    v_mfma_f32_16x16x32_bf16 v[88:91], v[160:163], a[104:107], v[88:91]
    v_and_b32 v3, s54, v252
    v_mul_f32 v223, v2, v2
    v_mfma_f32_16x16x32_bf16 v[116:119], v[160:163], a[108:111], v[116:119]
    buffer_load_dwordx4 v[160:163], v222, s[24:27], s67 offen offset:0 sc1
    v_mfma_f32_16x16x32_bf16 v[36:39], v[128:131], a[96:99], v[36:39]
    v_mul_f32 v224, v3, v3
    v_fma_f32 v223, v223, v229, v228
    v_mfma_f32_16x16x32_bf16 v[64:67], v[128:131], a[100:103], v[64:67]
    v_fma_f32 v224, v224, v229, v228
    v_mul_f32 v223, v223, v2
    v_mfma_f32_16x16x32_bf16 v[92:95], v[128:131], a[104:107], v[92:95]
    v_mul_f32 v224, v224, v3
    v_mfma_f32_16x16x32_bf16 v[120:123], v[128:131], a[108:111], v[120:123]
    buffer_load_dwordx4 v[128:131], v222, s[24:27], s67 offen offset:1024 sc1
    s_waitcnt vmcnt(20)
    v_mfma_f32_16x16x32_bf16 v[40:43], v[192:195], a[96:99], v[40:43]
    v_exp_f32 v223, v223
    v_mfma_f32_16x16x32_bf16 v[68:71], v[192:195], a[100:103], v[68:71]
    v_exp_f32 v224, v224
    v_mfma_f32_16x16x32_bf16 v[96:99], v[192:195], a[104:107], v[96:99]
    v_add_f32 v223, 1.0, v223
    v_add_f32 v224, 1.0, v224
    v_mfma_f32_16x16x32_bf16 v[124:127], v[192:195], a[108:111], v[124:127]
    buffer_load_dwordx4 v[192:195], v222, s[24:27], s67 offen offset:2048 sc1
    v_mfma_f32_16x16x32_bf16 v[32:35], v[204:207], a[112:115], v[32:35]
    v_rcp_f32 v223, v223
    v_mfma_f32_16x16x32_bf16 v[60:63], v[204:207], a[116:119], v[60:63]
    v_rcp_f32 v224, v224
    v_mfma_f32_16x16x32_bf16 v[88:91], v[204:207], a[120:123], v[88:91]
    v_mul_f32 v2, v2, v223
    v_mul_f32 v3, v3, v224
    v_mfma_f32_16x16x32_bf16 v[116:119], v[204:207], a[124:127], v[116:119]
    buffer_load_dwordx4 v[204:207], v222, s[24:27], s94 offen offset:0 sc1
    v_mfma_f32_16x16x32_bf16 v[36:39], v[200:203], a[112:115], v[36:39]
    v_cvt_pk_bf16_f32 v252, v2, v3
    v_lshlrev_b32 v2, 16, v253
    v_mfma_f32_16x16x32_bf16 v[64:67], v[200:203], a[116:119], v[64:67]
    v_and_b32 v3, s54, v253
    v_mul_f32 v223, v2, v2
    v_mfma_f32_16x16x32_bf16 v[92:95], v[200:203], a[120:123], v[92:95]
    v_mul_f32 v224, v3, v3
    v_fma_f32 v223, v223, v229, v228
    v_mfma_f32_16x16x32_bf16 v[120:123], v[200:203], a[124:127], v[120:123]
    buffer_load_dwordx4 v[200:203], v222, s[24:27], s94 offen offset:1024 sc1
    s_waitcnt vmcnt(20)
    v_mfma_f32_16x16x32_bf16 v[40:43], v[196:199], a[112:115], v[40:43]
    v_fma_f32 v224, v224, v229, v228
    v_mul_f32 v223, v223, v2
    v_mfma_f32_16x16x32_bf16 v[68:71], v[196:199], a[116:119], v[68:71]
    v_mul_f32 v224, v224, v3
    v_mfma_f32_16x16x32_bf16 v[96:99], v[196:199], a[120:123], v[96:99]
    v_exp_f32 v223, v223
    v_mfma_f32_16x16x32_bf16 v[124:127], v[196:199], a[124:127], v[124:127]
    buffer_load_dwordx4 v[196:199], v222, s[24:27], s94 offen offset:2048 sc1
    v_mfma_f32_16x16x32_bf16 v[32:35], v[208:211], a[128:131], v[32:35]
    v_exp_f32 v224, v224
    v_mfma_f32_16x16x32_bf16 v[60:63], v[208:211], a[132:135], v[60:63]
    v_add_f32 v223, 1.0, v223
    v_add_f32 v224, 1.0, v224
    v_mfma_f32_16x16x32_bf16 v[88:91], v[208:211], a[136:139], v[88:91]
    v_rcp_f32 v223, v223
    v_mfma_f32_16x16x32_bf16 v[116:119], v[208:211], a[140:143], v[116:119]
    buffer_load_dwordx4 v[208:211], v222, s[24:27], s95 offen offset:0 sc1
    v_mfma_f32_16x16x32_bf16 v[36:39], v[188:191], a[128:131], v[36:39]
    v_rcp_f32 v224, v224
    v_mfma_f32_16x16x32_bf16 v[64:67], v[188:191], a[132:135], v[64:67]
    v_mul_f32 v2, v2, v223
    v_mul_f32 v3, v3, v224
    v_mfma_f32_16x16x32_bf16 v[92:95], v[188:191], a[136:139], v[92:95]
    v_cvt_pk_bf16_f32 v253, v2, v3
    v_mfma_f32_16x16x32_bf16 v[120:123], v[188:191], a[140:143], v[120:123]
    buffer_load_dwordx4 v[188:191], v222, s[24:27], s95 offen offset:1024 sc1
    s_waitcnt vmcnt(20)
    v_mfma_f32_16x16x32_bf16 v[40:43], v[156:159], a[128:131], v[40:43]
    v_add_u32 v228, 102400, v4
    v_mfma_f32_16x16x32_bf16 v[68:71], v[156:159], a[132:135], v[68:71]
    v_add_u32 v229, 102400, v5
    v_mfma_f32_16x16x32_bf16 v[96:99], v[156:159], a[136:139], v[96:99]
    v_add_u32 v230, 102400, v14
    v_mfma_f32_16x16x32_bf16 v[124:127], v[156:159], a[140:143], v[124:127]
    buffer_load_dwordx4 v[156:159], v222, s[24:27], s95 offen offset:2048 sc1
    v_mfma_f32_16x16x32_bf16 v[32:35], v[184:187], a[144:147], v[32:35]
    buffer_store_dwordx4 v[108:111], v220, s[24:27], s87 offen sc1
    buffer_store_dwordx4 v[112:115], v220, s[24:27], s88 offen sc1
    v_mfma_f32_16x16x32_bf16 v[60:63], v[184:187], a[148:151], v[60:63]
    v_add_u32 v231, 102400, v15
    ds_read_b64_tr_b16 a[4:5], v5 offset:0
    v_mfma_f32_16x16x32_bf16 v[88:91], v[184:187], a[152:155], v[88:91]
    ds_read_b64_tr_b16 a[6:7], v5 offset:2048
    ds_read_b64_tr_b16 a[8:9], v14 offset:0
    v_mfma_f32_16x16x32_bf16 v[116:119], v[184:187], a[156:159], v[116:119]
    ds_read_b64_tr_b16 a[10:11], v14 offset:2048
    ds_read_b64_tr_b16 a[12:13], v15 offset:0
    v_mfma_f32_16x16x32_bf16 v[36:39], v[152:155], a[144:147], v[36:39]
    ds_read_b64_tr_b16 a[14:15], v15 offset:2048
    ds_read_b64_tr_b16 a[0:1], v4 offset:0
    v_mfma_f32_16x16x32_bf16 v[64:67], v[152:155], a[148:151], v[64:67]
    ds_read_b64_tr_b16 a[2:3], v4 offset:2048
    ds_read_b64_tr_b16 a[20:21], v5 offset:14336
    v_mfma_f32_16x16x32_bf16 v[92:95], v[152:155], a[152:155], v[92:95]
    ds_read_b64_tr_b16 a[22:23], v5 offset:16384
    ds_read_b64_tr_b16 a[24:25], v14 offset:14336
    v_mfma_f32_16x16x32_bf16 v[120:123], v[152:155], a[156:159], v[120:123]
    ds_read_b64_tr_b16 a[26:27], v14 offset:16384
    ds_read_b64_tr_b16 a[28:29], v15 offset:14336
    s_waitcnt vmcnt(18)
    v_mfma_f32_16x16x32_bf16 v[40:43], v[180:183], a[144:147], v[40:43]
    buffer_load_dwordx4 v[184:187], v6, s[8:11], s76 offen offset:0
    buffer_load_dwordx4 v[152:155], v6, s[8:11], s76 offen offset:64
    v_mfma_f32_16x16x32_bf16 v[68:71], v[180:183], a[148:151], v[68:71]
    ds_read_b64_tr_b16 a[30:31], v15 offset:16384
    ds_read_b64_tr_b16 a[16:17], v4 offset:14336
    v_mfma_f32_16x16x32_bf16 v[96:99], v[180:183], a[152:155], v[96:99]
    ds_read_b64_tr_b16 a[18:19], v4 offset:16384
    ds_read_b64_tr_b16 a[36:37], v5 offset:28672
    v_mfma_f32_16x16x32_bf16 v[124:127], v[180:183], a[156:159], v[124:127]
    ds_read_b64_tr_b16 a[38:39], v5 offset:30720
    ds_read_b64_tr_b16 a[40:41], v14 offset:28672
    v_mfma_f32_16x16x32_bf16 v[32:35], v[148:151], a[160:163], v[32:35]
    ds_read_b64_tr_b16 a[42:43], v14 offset:30720
    ds_read_b64_tr_b16 a[44:45], v15 offset:28672
    v_mfma_f32_16x16x32_bf16 v[60:63], v[148:151], a[164:167], v[60:63]
    ds_read_b64_tr_b16 a[46:47], v15 offset:30720
    ds_read_b64_tr_b16 a[32:33], v4 offset:28672
    v_mfma_f32_16x16x32_bf16 v[88:91], v[148:151], a[168:171], v[88:91]
    ds_read_b64_tr_b16 a[34:35], v4 offset:30720
    ds_read_b64_tr_b16 a[52:53], v5 offset:43008
    v_mfma_f32_16x16x32_bf16 v[116:119], v[148:151], a[172:175], v[116:119]
    ds_read_b64_tr_b16 a[54:55], v5 offset:45056
    ds_read_b64_tr_b16 a[56:57], v14 offset:43008
    v_mfma_f32_16x16x32_bf16 v[36:39], v[176:179], a[160:163], v[36:39]
    ds_read_b64_tr_b16 a[58:59], v14 offset:45056
    ds_read_b64_tr_b16 a[60:61], v15 offset:43008
    v_mfma_f32_16x16x32_bf16 v[64:67], v[176:179], a[164:167], v[64:67]
    ds_read_b64_tr_b16 a[62:63], v15 offset:45056
    ds_read_b64_tr_b16 a[48:49], v4 offset:43008
    v_mfma_f32_16x16x32_bf16 v[92:95], v[176:179], a[168:171], v[92:95]
    ds_read_b64_tr_b16 a[50:51], v4 offset:45056
    ds_read_b64_tr_b16 a[68:69], v5 offset:4096
    v_mfma_f32_16x16x32_bf16 v[120:123], v[176:179], a[172:175], v[120:123]
    ds_read_b64_tr_b16 a[70:71], v5 offset:6144
    ds_read_b64_tr_b16 a[72:73], v14 offset:4096
    s_waitcnt vmcnt(17)
    v_mfma_f32_16x16x32_bf16 v[40:43], v[144:147], a[160:163], v[40:43]
    ds_read_b64_tr_b16 a[74:75], v14 offset:6144
    ds_read_b64_tr_b16 a[76:77], v15 offset:4096
    v_mfma_f32_16x16x32_bf16 v[68:71], v[144:147], a[164:167], v[68:71]
    ds_read_b64_tr_b16 a[78:79], v15 offset:6144
    ds_read_b64_tr_b16 a[64:65], v4 offset:4096
    v_mfma_f32_16x16x32_bf16 v[96:99], v[144:147], a[168:171], v[96:99]
    ds_read_b64_tr_b16 a[66:67], v4 offset:6144
    ds_read_b64_tr_b16 a[84:85], v5 offset:18432
    v_mfma_f32_16x16x32_bf16 v[124:127], v[144:147], a[172:175], v[124:127]
    ds_read_b64_tr_b16 a[86:87], v5 offset:20480
    ds_read_b64_tr_b16 a[88:89], v14 offset:18432
    v_mfma_f32_16x16x32_bf16 v[32:35], v[172:175], a[176:179], v[32:35]
    ds_read_b64_tr_b16 a[90:91], v14 offset:20480
    ds_read_b64_tr_b16 a[92:93], v15 offset:18432
    v_mfma_f32_16x16x32_bf16 v[60:63], v[172:175], a[180:183], v[60:63]
    ds_read_b64_tr_b16 a[94:95], v15 offset:20480
    ds_read_b64_tr_b16 a[80:81], v4 offset:18432
    v_mfma_f32_16x16x32_bf16 v[88:91], v[172:175], a[184:187], v[88:91]
    ds_read_b64_tr_b16 a[82:83], v4 offset:20480
    ds_read_b64_tr_b16 a[100:101], v5 offset:32768
    v_mfma_f32_16x16x32_bf16 v[116:119], v[172:175], a[188:191], v[116:119]
    ds_read_b64_tr_b16 a[102:103], v5 offset:34816
    ds_read_b64_tr_b16 a[104:105], v14 offset:32768
    v_mfma_f32_16x16x32_bf16 v[36:39], v[140:143], a[176:179], v[36:39]
    ds_read_b64_tr_b16 a[106:107], v14 offset:34816
    ds_read_b64_tr_b16 a[108:109], v15 offset:32768
    v_mfma_f32_16x16x32_bf16 v[64:67], v[140:143], a[180:183], v[64:67]
    v_mov_b32 v174, 0
    v_mov_b32 v175, 0
    v_mfma_f32_16x16x32_bf16 v[92:95], v[140:143], a[184:187], v[92:95]
    v_lshlrev_b32 v180, 16, v248
    v_and_b32 v181, s54, v248
    v_mfma_f32_16x16x32_bf16 v[120:123], v[140:143], a[188:191], v[120:123]
    v_lshlrev_b32 v182, 16, v249
    v_and_b32 v183, s54, v249
    s_waitcnt vmcnt(14)
    v_mfma_f32_16x16x32_bf16 v[40:43], v[168:171], a[176:179], v[40:43]
    buffer_load_dword v11, v9, s[24:27], s79 offen sc1
    v_mfma_f32_16x16x32_bf16 v[68:71], v[168:171], a[180:183], v[68:71]
    v_lshlrev_b32 v148, 16, v250
    v_and_b32 v149, s54, v250
    v_mfma_f32_16x16x32_bf16 v[96:99], v[168:171], a[184:187], v[96:99]
    v_lshlrev_b32 v150, 16, v251
    v_and_b32 v151, s54, v251
    v_mfma_f32_16x16x32_bf16 v[124:127], v[168:171], a[188:191], v[124:127]
    v_lshlrev_b32 v176, 16, v252
    v_and_b32 v177, s54, v252
    v_mfma_f32_16x16x32_bf16 v[60:63], v[136:139], a[196:199], v[60:63]
    buffer_load_dwordx4 v[16:19], v233, s[24:27], s80 offen offset:0 sc1
    v_mfma_f32_16x16x32_bf16 v[88:91], v[136:139], a[200:203], v[88:91]
    v_lshlrev_b32 v178, 16, v253
    v_and_b32 v179, s54, v253
    v_mfma_f32_16x16x32_bf16 v[116:119], v[136:139], a[204:207], v[116:119]
    ds_read_b64_tr_b16 a[110:111], v15 offset:34816
    ds_read_b64_tr_b16 a[96:97], v4 offset:32768
    v_mfma_f32_16x16x32_bf16 v[64:67], v[164:167], a[196:199], v[64:67]
    ds_read_b64_tr_b16 a[98:99], v4 offset:34816
    ds_read_b64_tr_b16 a[116:117], v5 offset:47104
    v_mfma_f32_16x16x32_bf16 v[92:95], v[164:167], a[200:203], v[92:95]
    ds_read_b64_tr_b16 a[118:119], v5 offset:49152
    ds_read_b64_tr_b16 a[120:121], v14 offset:47104
    v_mfma_f32_16x16x32_bf16 v[120:123], v[164:167], a[204:207], v[120:123]
    ds_read_b64_tr_b16 a[122:123], v14 offset:49152
    ds_read_b64_tr_b16 a[124:125], v15 offset:47104
    s_waitcnt vmcnt(13)
    v_mfma_f32_16x16x32_bf16 v[68:71], v[132:135], a[196:199], v[68:71]
    buffer_load_dwordx4 v[20:23], v233, s[24:27], s81 offen offset:3072 sc1
    v_mfma_f32_16x16x32_bf16 v[96:99], v[132:135], a[200:203], v[96:99]
    ds_read_b64_tr_b16 a[126:127], v15 offset:49152
    ds_read_b64_tr_b16 a[112:113], v4 offset:47104
    v_mfma_f32_16x16x32_bf16 v[124:127], v[132:135], a[204:207], v[124:127]
    ds_read_b64_tr_b16 a[114:115], v4 offset:49152
    ds_read_b64_tr_b16 a[132:133], v229 offset:2048
    v_mfma_f32_16x16x32_bf16 v[60:63], v[160:163], a[212:215], v[60:63]
    ds_read_b64_tr_b16 a[134:135], v229 offset:4096
    ds_read_b64_tr_b16 a[136:137], v230 offset:2048
    v_mfma_f32_16x16x32_bf16 v[88:91], v[160:163], a[216:219], v[88:91]
    ds_read_b64_tr_b16 a[138:139], v230 offset:4096
    ds_read_b64_tr_b16 a[140:141], v231 offset:2048
    v_mfma_f32_16x16x32_bf16 v[116:119], v[160:163], a[220:223], v[116:119]
    ds_read_b64_tr_b16 a[142:143], v231 offset:4096
    ds_read_b64_tr_b16 a[128:129], v228 offset:2048
    v_mfma_f32_16x16x32_bf16 v[64:67], v[128:131], a[212:215], v[64:67]
    buffer_load_dwordx4 v[24:27], v233, s[24:27], s83 offen offset:2048 sc1
    v_mfma_f32_16x16x32_bf16 v[92:95], v[128:131], a[216:219], v[92:95]
    ds_read_b64_tr_b16 a[130:131], v228 offset:4096
    ds_read_b64_tr_b16 a[148:149], v229 offset:16384
    v_mfma_f32_16x16x32_bf16 v[120:123], v[128:131], a[220:223], v[120:123]
    ds_read_b64_tr_b16 a[150:151], v229 offset:18432
    ds_read_b64_tr_b16 a[152:153], v230 offset:16384
    s_waitcnt vmcnt(12)
    v_mfma_f32_16x16x32_bf16 v[68:71], v[192:195], a[212:215], v[68:71]
    ds_read_b64_tr_b16 a[154:155], v230 offset:18432
    ds_read_b64_tr_b16 a[156:157], v231 offset:16384
    v_mfma_f32_16x16x32_bf16 v[96:99], v[192:195], a[216:219], v[96:99]
    ds_read_b64_tr_b16 a[158:159], v231 offset:18432
    ds_read_b64_tr_b16 a[144:145], v228 offset:16384
    v_mfma_f32_16x16x32_bf16 v[124:127], v[192:195], a[220:223], v[124:127]
    ds_read_b64_tr_b16 a[146:147], v228 offset:18432
    ds_read_b64_tr_b16 a[164:165], v229 offset:30720
    v_mfma_f32_16x16x32_bf16 v[60:63], v[204:207], a[228:231], v[60:63]
    buffer_load_dwordx4 v[28:31], v233, s[24:27], s85 offen offset:1024 sc1
    v_mfma_f32_16x16x32_bf16 v[64:67], v[200:203], a[228:231], v[64:67]
    ds_read_b64_tr_b16 a[166:167], v229 offset:32768
    ds_read_b64_tr_b16 a[168:169], v230 offset:30720
    s_waitcnt vmcnt(10)
    v_mfma_f32_16x16x32_bf16 v[68:71], v[196:199], a[228:231], v[68:71]
    ds_read_b64_tr_b16 a[170:171], v230 offset:32768
    ds_read_b64_tr_b16 a[172:173], v231 offset:30720
    v_mfma_f32_16x16x32_bf16 v[60:63], v[208:211], a[244:247], v[60:63]
    ds_read_b64_tr_b16 a[174:175], v231 offset:32768
    ds_read_b64_tr_b16 a[160:161], v228 offset:30720
    v_mfma_f32_16x16x32_bf16 v[64:67], v[188:191], a[244:247], v[64:67]
    ds_read_b64_tr_b16 a[162:163], v228 offset:32768
    ds_read_b64_tr_b16 a[180:181], v229 offset:45056
    s_waitcnt vmcnt(9)
    v_mfma_f32_16x16x32_bf16 v[68:71], v[156:159], a[244:247], v[68:71]
    ds_read_b64_tr_b16 a[182:183], v229 offset:47104
    ds_read_b64_tr_b16 a[184:185], v230 offset:45056
    v_mfma_f32_16x16x32_bf16 v[88:91], v[204:207], a[232:235], v[88:91]
    v_cvt_pk_bf16_f32 v60, v60, v61
    v_cvt_pk_bf16_f32 v61, v62, v63
    v_mfma_f32_16x16x32_bf16 v[92:95], v[200:203], a[232:235], v[92:95]
    v_cvt_pk_bf16_f32 v62, v64, v65
    v_cvt_pk_bf16_f32 v63, v66, v67
    v_mfma_f32_16x16x32_bf16 v[96:99], v[196:199], a[232:235], v[96:99]
    ds_write_b128 v234, v[60:63] offset:2048
    v_mfma_f32_16x16x32_bf16 v[88:91], v[208:211], a[248:251], v[88:91]
    v_cvt_pk_bf16_f32 v68, v68, v69
    v_cvt_pk_bf16_f32 v69, v70, v71
    v_mfma_f32_16x16x32_bf16 v[92:95], v[188:191], a[248:251], v[92:95]
    ds_write_b64 v234, v[68:69] offset:9216
    v_mfma_f32_16x16x32_bf16 v[96:99], v[156:159], a[248:251], v[96:99]
    buffer_load_dwordx4 v[44:47], v233, s[24:27], s80 offen offset:1024 sc1
    v_mfma_f32_16x16x32_bf16 v[116:119], v[204:207], a[236:239], v[116:119]
    s_nop 0
    v_cvt_pk_bf16_f32 v88, v88, v89
    v_cvt_pk_bf16_f32 v89, v90, v91
    v_mfma_f32_16x16x32_bf16 v[120:123], v[200:203], a[236:239], v[120:123]
    v_cvt_pk_bf16_f32 v90, v92, v93
    v_cvt_pk_bf16_f32 v91, v94, v95
    v_mfma_f32_16x16x32_bf16 v[124:127], v[196:199], a[236:239], v[124:127]
    ds_write_b128 v235, v[88:91] offset:2048
    v_mfma_f32_16x16x32_bf16 v[116:119], v[208:211], a[252:255], v[116:119]
    v_cvt_pk_bf16_f32 v96, v96, v97
    v_cvt_pk_bf16_f32 v97, v98, v99
    v_mfma_f32_16x16x32_bf16 v[120:123], v[188:191], a[252:255], v[120:123]
    ds_write_b64 v235, v[96:97] offset:6152
    v_mfma_f32_16x16x32_bf16 v[124:127], v[156:159], a[252:255], v[124:127]
    buffer_load_dwordx4 v[48:51], v233, s[24:27], s82 offen offset:0 sc1
    v_mfma_f32_16x16x32_bf16 v[40:43], v[132:135], a[192:195], v[40:43]
    s_nop 0
    v_cvt_pk_bf16_f32 v116, v116, v117
    v_cvt_pk_bf16_f32 v117, v118, v119
    v_mfma_f32_16x16x32_bf16 v[40:43], v[192:195], a[208:211], v[40:43]
    v_cvt_pk_bf16_f32 v118, v120, v121
    v_cvt_pk_bf16_f32 v119, v122, v123
    v_mfma_f32_16x16x32_bf16 v[40:43], v[196:199], a[224:227], v[40:43]
    ds_write_b128 v236, v[116:119] offset:2048
    v_cvt_pk_bf16_f32 v124, v124, v125
    v_mfma_f32_16x16x32_bf16 v[40:43], v[156:159], a[240:243], v[40:43]
    v_cvt_pk_bf16_f32 v125, v126, v127
    ds_read_b64_tr_b16 a[186:187], v230 offset:47104
    v_mfma_f32_16x16x32_bf16 v[32:35], v[136:139], a[192:195], v[32:35]
    ds_write_b64 v236, v[124:125] offset:4096
    v_mfma_f32_16x16x32_bf16 v[32:35], v[160:163], a[208:211], v[32:35]
    v_mfma_f32_16x16x32_bf16 v[32:35], v[204:207], a[224:227], v[32:35]
    s_waitcnt lgkmcnt(0)
    s_barrier
    ds_read_b128 v[144:147], v237 offset:8192
    v_mfma_f32_16x16x32_bf16 v[32:35], v[208:211], a[240:243], v[32:35]
    ds_read2st64_b64 v[88:91], v237 offset0:4 offset1:10
    ds_read2st64_b64 v[92:95], v227 offset0:4 offset1:10
    ds_read_b64 v[172:173], v237 offset:10240
    v_mfma_f32_16x16x32_bf16 v[36:39], v[164:167], a[192:195], v[36:39]
    ds_read_b128 v[96:99], v237 offset:9216
    ds_read_b64_tr_b16 a[188:189], v231 offset:45056
    v_mfma_f32_16x16x32_bf16 v[36:39], v[128:131], a[208:211], v[36:39]
    ds_read_b64_tr_b16 a[190:191], v231 offset:47104
    ds_read_b64_tr_b16 a[176:177], v228 offset:45056
    s_waitcnt lgkmcnt(3)
    v_mfma_f32_16x16x32_bf16 v[40:43], v[214:217], v[96:99], v[40:43]
    ds_read_b64_tr_b16 a[178:179], v228 offset:47104
    ds_read_b64_tr_b16 a[196:197], v229 offset:6144
    v_mfma_f32_16x16x32_bf16 v[40:43], v[216:219], v[172:175], v[40:43]
    ds_read_b64_tr_b16 a[198:199], v229 offset:8192
    ds_read_b64_tr_b16 a[200:201], v230 offset:6144
    v_mfma_f32_16x16x32_bf16 v[36:39], v[200:203], a[224:227], v[36:39]
    ds_read_b64_tr_b16 a[202:203], v230 offset:8192
    ds_read_b64_tr_b16 a[204:205], v231 offset:6144
    v_mfma_f32_16x16x32_bf16 v[32:35], v[214:217], v[88:91], v[32:35]
    ds_read_b64_tr_b16 a[206:207], v231 offset:8192
    ds_read_b64_tr_b16 a[192:193], v228 offset:6144
    v_mfma_f32_16x16x32_bf16 v[32:35], v[216:219], v[144:147], v[32:35]
    v_mul_f32 v40, v40, v176
    v_mul_f32 v41, v41, v177
    v_mul_f32 v42, v42, v178
    v_mfma_f32_16x16x32_bf16 v[36:39], v[188:191], a[240:243], v[36:39]
    v_mul_f32 v43, v43, v179
    v_cvt_pk_bf16_f32 v252, v40, v41
    v_cvt_pk_bf16_f32 v253, v42, v43
    v_mfma_f32_16x16x32_bf16 v[36:39], v[214:217], v[92:95], v[36:39]
    v_cvt_pk_bf16_f32 v254, v40, v41
    v_cvt_pk_bf16_f32 v255, v42, v43
    s_nop 0
    v_permlane16_swap_b32 v252, v254
    v_mfma_f32_16x16x32_bf16 v[36:39], v[212:215], v[144:147], v[36:39]
    v_permlane16_swap_b32 v253, v255
    buffer_store_dwordx4 v[252:255], v225, s[24:27], s73 offen offset:3072 sc1
    v_mul_f32 v32, v32, v180
    v_mul_f32 v33, v33, v181
    v_mul_f32 v34, v34, v182
    v_mul_f32 v35, v35, v183
    v_cvt_pk_bf16_f32 v248, v32, v33
    v_cvt_pk_bf16_f32 v249, v34, v35
    v_mul_f32 v36, v36, v148
    v_mul_f32 v37, v37, v149
    v_mul_f32 v38, v38, v150
    v_mul_f32 v39, v39, v151
    v_cvt_pk_bf16_f32 v250, v36, v37
    v_cvt_pk_bf16_f32 v251, v38, v39
    buffer_store_dwordx4 v[248:251], v233, s[24:27], s72 offen offset:2048 sc1
    s_cmp_eq_u32 s49, 7
    s_cbranch_scc1 L_done
    s_waitcnt vmcnt(9)
    s_mov_b32 s57, 0
    s_mov_b32 s58, 0x63636363
    s_mov_b32 s59, 0x9c9c9c9c
    buffer_load_dwordx4 v[52:55], v233, s[24:27], s83 offen offset:3072 sc1
    v_permlane16_swap_b32 v184, v186
    v_permlane16_swap_b32 v185, v187
    v_permlane16_swap_b32 v152, v154
    v_permlane16_swap_b32 v153, v155
    v_mov_b32 v224, 3216550459
    buffer_load_dwordx4 v[56:59], v233, s[24:27], s85 offen offset:2048 sc1
    v_lshlrev_b32 v240, 16, v184
    v_and_b32 v241, s54, v184
    v_lshlrev_b32 v242, 16, v185
    v_and_b32 v243, s54, v185
    v_lshlrev_b32 v244, 16, v186
    buffer_load_dwordx4 v[72:75], v233, s[24:27], s81 offen offset:0 sc1
    v_and_b32 v245, s54, v186
    v_lshlrev_b32 v246, 16, v187
    v_and_b32 v247, s54, v187
    v_lshlrev_b32 v248, 16, v152
    v_and_b32 v249, s54, v152
    buffer_load_dwordx4 v[76:79], v233, s[24:27], s82 offen offset:3072 sc1
    v_lshlrev_b32 v250, 16, v153
    v_and_b32 v251, s54, v153
    v_lshlrev_b32 v252, 16, v154
    v_and_b32 v253, s54, v154
    v_lshlrev_b32 v254, 16, v155
    buffer_load_dwordx4 v[80:83], v233, s[24:27], s84 offen offset:2048 sc1
    v_and_b32 v255, s54, v155
    buffer_load_dwordx4 v[84:87], v233, s[24:27], s86 offen offset:1024 sc1
    s_waitcnt vmcnt(14)
    v_cmp_eq_u32 vcc, -1, v11
    s_nop 0
    s_and_b32 s60, vcc_lo, s58
    s_cbranch_scc0 L_hgoA
L_hreA:
    buffer_load_dword v11, v9, s[24:27], s79 offen sc1
    buffer_load_dwordx4 v[16:19], v233, s[24:27], s80 offen offset:0 sc1
    buffer_load_dwordx4 v[20:23], v233, s[24:27], s81 offen offset:3072 sc1
    buffer_load_dwordx4 v[24:27], v233, s[24:27], s83 offen offset:2048 sc1
    buffer_load_dwordx4 v[28:31], v233, s[24:27], s85 offen offset:1024 sc1
    buffer_load_dwordx4 v[44:47], v233, s[24:27], s80 offen offset:1024 sc1
    buffer_load_dwordx4 v[48:51], v233, s[24:27], s82 offen offset:0 sc1
    buffer_load_dword v10, v9, s[24:27], s79 offen sc1
    buffer_load_dword v10, v9, s[24:27], s79 offen sc1
    buffer_load_dwordx4 v[52:55], v233, s[24:27], s83 offen offset:3072 sc1
    buffer_load_dwordx4 v[56:59], v233, s[24:27], s85 offen offset:2048 sc1
    buffer_load_dwordx4 v[72:75], v233, s[24:27], s81 offen offset:0 sc1
    buffer_load_dwordx4 v[76:79], v233, s[24:27], s82 offen offset:3072 sc1
    buffer_load_dwordx4 v[80:83], v233, s[24:27], s84 offen offset:2048 sc1
    buffer_load_dwordx4 v[84:87], v233, s[24:27], s86 offen offset:1024 sc1
    s_add_u32 s57, s57, 1
    s_waitcnt vmcnt(14)
    v_cmp_eq_u32 vcc, -1, v11
    s_nop 0
    s_and_b32 s60, vcc_lo, s58
    s_cselect_b32 s60, s57, 200000
    s_cmp_lt_u32 s60, 200000
    s_cbranch_scc1 L_hreA
L_hgoA:
    s_waitcnt vmcnt(13)
    v_mfma_f32_16x16x32_bf16 v[128:131], a[0:3], v[16:19], 0
    v_max_u32 v226, v16, v19
    ds_read_b64_tr_b16 a[194:195], v228 offset:8192
    v_mfma_f32_16x16x32_bf16 v[132:135], a[4:7], v[16:19], 0
    buffer_load_dwordx4 v[100:103], v233, s[24:27], s81 offen offset:1024 sc1
    ds_read_b64_tr_b16 a[212:213], v229 offset:20480
    v_mfma_f32_16x16x32_bf16 v[136:139], a[8:11], v[16:19], 0
    ds_read_b64_tr_b16 a[214:215], v229 offset:22528
    ds_read_b64_tr_b16 a[216:217], v230 offset:20480
    v_mfma_f32_16x16x32_bf16 v[140:143], a[12:15], v[16:19], 0
    ds_read_b64_tr_b16 a[218:219], v230 offset:22528
    ds_read_b64_tr_b16 a[220:221], v231 offset:20480
    s_waitcnt vmcnt(13)
    v_mfma_f32_16x16x32_bf16 v[128:131], a[16:19], v[20:23], v[128:131]
    v_max3_u32 v226, v226, v20, v23
    ds_read_b64_tr_b16 a[222:223], v231 offset:22528
    v_mfma_f32_16x16x32_bf16 v[132:135], a[20:23], v[20:23], v[132:135]
    buffer_load_dwordx4 v[104:107], v233, s[24:27], s83 offen offset:0 sc1
    ds_read_b64_tr_b16 a[208:209], v228 offset:20480
    v_mfma_f32_16x16x32_bf16 v[136:139], a[24:27], v[20:23], v[136:139]
    ds_read_b64_tr_b16 a[210:211], v228 offset:22528
    ds_read_b64_tr_b16 a[228:229], v229 offset:34816
    v_mfma_f32_16x16x32_bf16 v[140:143], a[28:31], v[20:23], v[140:143]
    ds_read_b64_tr_b16 a[230:231], v229 offset:36864
    ds_read_b64_tr_b16 a[232:233], v230 offset:34816
    buffer_load_dwordx4 v[208:211], v8, s[24:27], s78 offen sc1
    buffer_load_dwordx4 v[212:215], v8, s[24:27], s89 offen sc1
    s_waitcnt vmcnt(15)
    v_mfma_f32_16x16x32_bf16 v[128:131], a[32:35], v[24:27], v[128:131]
    v_max3_u32 v226, v226, v24, v27
    ds_read_b64_tr_b16 a[234:235], v230 offset:36864
    v_mfma_f32_16x16x32_bf16 v[132:135], a[36:39], v[24:27], v[132:135]
    buffer_load_dwordx4 v[108:111], v233, s[24:27], s84 offen offset:3072 sc1
    ds_read_b64_tr_b16 a[236:237], v231 offset:34816
    v_mfma_f32_16x16x32_bf16 v[136:139], a[40:43], v[24:27], v[136:139]
    ds_read_b64_tr_b16 a[238:239], v231 offset:36864
    ds_read_b64_tr_b16 a[224:225], v228 offset:34816
    v_mfma_f32_16x16x32_bf16 v[140:143], a[44:47], v[24:27], v[140:143]
    ds_read_b64_tr_b16 a[226:227], v228 offset:36864
    ds_read_b64_tr_b16 a[244:245], v229 offset:49152
    s_waitcnt vmcnt(15)
    v_mfma_f32_16x16x32_bf16 v[128:131], a[48:51], v[28:31], v[128:131]
    v_max3_u32 v226, v226, v28, v31
    ds_read_b64_tr_b16 a[246:247], v229 offset:51200
    v_mfma_f32_16x16x32_bf16 v[132:135], a[52:55], v[28:31], v[132:135]
    buffer_load_dwordx4 v[112:115], v233, s[24:27], s86 offen offset:2048 sc1
    ds_read_b64_tr_b16 a[248:249], v230 offset:49152
    v_mfma_f32_16x16x32_bf16 v[136:139], a[56:59], v[28:31], v[136:139]
    ds_read_b64_tr_b16 a[250:251], v230 offset:51200
    ds_read_b64_tr_b16 a[252:253], v231 offset:49152
    v_mfma_f32_16x16x32_bf16 v[140:143], a[60:63], v[28:31], v[140:143]
    ds_read_b64_tr_b16 a[254:255], v231 offset:51200
    ds_read_b64_tr_b16 a[240:241], v228 offset:49152
    s_waitcnt vmcnt(15)
    v_mfma_f32_16x16x32_bf16 v[128:131], a[64:67], v[44:47], v[128:131]
    v_max3_u32 v226, v226, v44, v47
    ds_read_b64_tr_b16 a[242:243], v228 offset:51200
    v_mfma_f32_16x16x32_bf16 v[132:135], a[68:71], v[44:47], v[132:135]
    ds_read_b64_tr_b16 v[148:149], v5 offset:8192
    ds_read_b64_tr_b16 v[150:151], v5 offset:10240
    v_mfma_f32_16x16x32_bf16 v[136:139], a[72:75], v[44:47], v[136:139]
    ds_read_b64_tr_b16 v[152:153], v14 offset:8192
    ds_read_b64_tr_b16 v[154:155], v14 offset:10240
    v_mfma_f32_16x16x32_bf16 v[140:143], a[76:79], v[44:47], v[140:143]
    ds_read_b64_tr_b16 v[156:157], v15 offset:8192
    ds_read_b64_tr_b16 v[158:159], v15 offset:10240
    s_waitcnt vmcnt(14)
    v_mfma_f32_16x16x32_bf16 v[128:131], a[80:83], v[48:51], v[128:131]
    v_max3_u32 v226, v226, v48, v51
    ds_read_b64_tr_b16 v[144:145], v4 offset:8192
    v_mfma_f32_16x16x32_bf16 v[132:135], a[84:87], v[48:51], v[132:135]
    ds_read_b64_tr_b16 v[146:147], v4 offset:10240
    ds_read_b64_tr_b16 v[164:165], v5 offset:22528
    v_mfma_f32_16x16x32_bf16 v[136:139], a[88:91], v[48:51], v[136:139]
    ds_read_b64_tr_b16 v[166:167], v5 offset:24576
    ds_read_b64_tr_b16 v[168:169], v14 offset:22528
    v_mfma_f32_16x16x32_bf16 v[140:143], a[92:95], v[48:51], v[140:143]
    ds_read_b64_tr_b16 v[170:171], v14 offset:24576
    ds_read_b64_tr_b16 v[172:173], v15 offset:22528
    s_waitcnt vmcnt(11)
    v_mfma_f32_16x16x32_bf16 v[128:131], a[96:99], v[52:55], v[128:131]
    v_max3_u32 v226, v226, v52, v55
    ds_read_b64_tr_b16 v[174:175], v15 offset:24576
    v_mfma_f32_16x16x32_bf16 v[132:135], a[100:103], v[52:55], v[132:135]
    ds_read_b64_tr_b16 v[160:161], v4 offset:22528
    ds_read_b64_tr_b16 v[162:163], v4 offset:24576
    v_mfma_f32_16x16x32_bf16 v[136:139], a[104:107], v[52:55], v[136:139]
    ds_read_b64_tr_b16 v[180:181], v5 offset:36864
    ds_read_b64_tr_b16 v[182:183], v5 offset:38912
    v_mfma_f32_16x16x32_bf16 v[140:143], a[108:111], v[52:55], v[140:143]
    ds_read_b64_tr_b16 v[184:185], v14 offset:36864
    ds_read_b64_tr_b16 v[186:187], v14 offset:38912
    s_waitcnt vmcnt(10)
    v_mfma_f32_16x16x32_bf16 v[128:131], a[112:115], v[56:59], v[128:131]
    v_max3_u32 v226, v226, v56, v59
    ds_read_b64_tr_b16 v[188:189], v15 offset:36864
    v_mfma_f32_16x16x32_bf16 v[132:135], a[116:119], v[56:59], v[132:135]
    ds_read_b64_tr_b16 v[190:191], v15 offset:38912
    ds_read_b64_tr_b16 v[176:177], v4 offset:36864
    v_mfma_f32_16x16x32_bf16 v[136:139], a[120:123], v[56:59], v[136:139]
    ds_read_b64_tr_b16 v[178:179], v4 offset:38912
    ds_read_b64_tr_b16 a[4:5], v5 offset:51200
    v_mfma_f32_16x16x32_bf16 v[140:143], a[124:127], v[56:59], v[140:143]
    ds_read_b64_tr_b16 a[6:7], v5 offset:53248
    ds_read_b64_tr_b16 a[8:9], v14 offset:51200
    s_waitcnt vmcnt(9)
    v_mfma_f32_16x16x32_bf16 v[128:131], a[128:131], v[72:75], v[128:131]
    v_max3_u32 v226, v226, v72, v75
    ds_read_b64_tr_b16 a[10:11], v14 offset:53248
    v_mfma_f32_16x16x32_bf16 v[132:135], a[132:135], v[72:75], v[132:135]
    ds_read_b64_tr_b16 a[12:13], v15 offset:51200
    ds_read_b64_tr_b16 a[14:15], v15 offset:53248
    v_mfma_f32_16x16x32_bf16 v[136:139], a[136:139], v[72:75], v[136:139]
    ds_read_b64_tr_b16 a[0:1], v4 offset:51200
    ds_read_b64_tr_b16 a[2:3], v4 offset:53248
    v_mfma_f32_16x16x32_bf16 v[140:143], a[140:143], v[72:75], v[140:143]
    ds_read_b64_tr_b16 a[20:21], v229 offset:10240
    ds_read_b64_tr_b16 a[22:23], v229 offset:12288
    s_waitcnt vmcnt(8)
    v_mfma_f32_16x16x32_bf16 v[128:131], a[144:147], v[76:79], v[128:131]
    v_max3_u32 v226, v226, v76, v79
    ds_read_b64_tr_b16 a[24:25], v230 offset:10240
    v_mfma_f32_16x16x32_bf16 v[132:135], a[148:151], v[76:79], v[132:135]
    ds_read_b64_tr_b16 a[26:27], v230 offset:12288
    ds_read_b64_tr_b16 a[28:29], v231 offset:10240
    v_mfma_f32_16x16x32_bf16 v[136:139], a[152:155], v[76:79], v[136:139]
    ds_read_b64_tr_b16 a[30:31], v231 offset:12288
    ds_read_b64_tr_b16 a[16:17], v228 offset:10240
    v_mfma_f32_16x16x32_bf16 v[140:143], a[156:159], v[76:79], v[140:143]
    ds_read_b64_tr_b16 a[18:19], v228 offset:12288
    ds_read_b64_tr_b16 a[36:37], v229 offset:24576
    s_waitcnt vmcnt(7)
    v_mfma_f32_16x16x32_bf16 v[128:131], a[160:163], v[80:83], v[128:131]
    v_max3_u32 v226, v226, v80, v83
    ds_read_b64_tr_b16 a[38:39], v229 offset:26624
    v_mfma_f32_16x16x32_bf16 v[132:135], a[164:167], v[80:83], v[132:135]
    ds_read_b64_tr_b16 a[40:41], v230 offset:24576
    ds_read_b64_tr_b16 a[42:43], v230 offset:26624
    v_mfma_f32_16x16x32_bf16 v[136:139], a[168:171], v[80:83], v[136:139]
    ds_read_b64_tr_b16 a[44:45], v231 offset:24576
    ds_read_b64_tr_b16 a[46:47], v231 offset:26624
    v_mfma_f32_16x16x32_bf16 v[140:143], a[172:175], v[80:83], v[140:143]
    ds_read_b64_tr_b16 a[32:33], v228 offset:24576
    ds_read_b64_tr_b16 a[34:35], v228 offset:26624
    s_waitcnt vmcnt(6)
    s_waitcnt lgkmcnt(15)
    v_mfma_f32_16x16x32_bf16 v[128:131], a[176:179], v[84:87], v[128:131]
    v_max3_u32 v226, v226, v84, v87
    ds_read_b64_tr_b16 a[52:53], v229 offset:38912
    v_mfma_f32_16x16x32_bf16 v[132:135], a[180:183], v[84:87], v[132:135]
    ds_read_b64_tr_b16 a[54:55], v229 offset:40960
    ds_read_b64_tr_b16 a[56:57], v230 offset:38912
    v_mfma_f32_16x16x32_bf16 v[136:139], a[184:187], v[84:87], v[136:139]
    ds_read_b64_tr_b16 a[58:59], v230 offset:40960
    ds_read_b64_tr_b16 a[60:61], v231 offset:38912
    v_mfma_f32_16x16x32_bf16 v[140:143], a[188:191], v[84:87], v[140:143]
    ds_read_b64_tr_b16 a[62:63], v231 offset:40960
    ds_read_b64_tr_b16 a[48:49], v228 offset:38912
    s_waitcnt vmcnt(2)
    v_max3_u32 v200, v208, v211, v212
    v_max_u32 v200, v200, v215
    v_cmp_eq_u32 vcc, -1, v200
    s_cbranch_vccnz L_sv_s
L_sv_ok:
    v_mfma_f32_16x16x32_bf16 v[128:131], a[192:195], v[100:103], v[128:131]
    v_max3_u32 v226, v226, v100, v103
    ds_read_b64_tr_b16 a[50:51], v228 offset:40960
    v_mfma_f32_16x16x32_bf16 v[132:135], a[196:199], v[100:103], v[132:135]
    buffer_load_dword v11, v9, s[24:27], s79 offen sc1
    buffer_load_dwordx4 v[60:63], v233, s[24:27], s80 offen offset:2048 sc1
    buffer_load_dwordx4 v[64:67], v233, s[24:27], s82 offen offset:1024 sc1
    ds_write_b128 v237, v[208:211]
    v_mfma_f32_16x16x32_bf16 v[136:139], a[200:203], v[100:103], v[136:139]
    ds_write_b128 v237, v[212:215] offset:1024
    v_mfma_f32_16x16x32_bf16 v[140:143], a[204:207], v[100:103], v[140:143]
    ds_read_b64_tr_b16 v[200:201], v13 offset:0
    ds_read_b64_tr_b16 a[68:69], v229 offset:53248
    v_mfma_f32_16x16x32_bf16 v[128:131], a[208:211], v[104:107], v[128:131]
    v_max3_u32 v226, v226, v104, v107
    ds_read_b64_tr_b16 a[70:71], v229 offset:55296
    v_mfma_f32_16x16x32_bf16 v[132:135], a[212:215], v[104:107], v[132:135]
    buffer_load_dwordx4 v[68:71], v233, s[24:27], s84 offen offset:0 sc1
    buffer_load_dwordx4 v[116:119], v233, s[24:27], s85 offen offset:3072 sc1
    ds_read_b64_tr_b16 v[202:203], v13 offset:512
    v_mfma_f32_16x16x32_bf16 v[136:139], a[216:219], v[104:107], v[136:139]
    ds_read_b64_tr_b16 v[204:205], v13 offset:1024
    ds_read_b64_tr_b16 a[72:73], v230 offset:53248
    v_mfma_f32_16x16x32_bf16 v[140:143], a[220:223], v[104:107], v[140:143]
    ds_read_b64_tr_b16 v[206:207], v13 offset:1536
    ds_read_b64_tr_b16 a[74:75], v230 offset:55296
    s_waitcnt vmcnt(6)
    v_mfma_f32_16x16x32_bf16 v[128:131], a[224:227], v[108:111], v[128:131]
    v_max3_u32 v226, v226, v108, v111
    ds_read_b64_tr_b16 a[76:77], v231 offset:53248
    v_mfma_f32_16x16x32_bf16 v[132:135], a[228:231], v[108:111], v[132:135]
    buffer_load_dwordx4 v[120:123], v233, s[24:27], s81 offen offset:2048 sc1
    buffer_load_dwordx4 v[124:127], v233, s[24:27], s83 offen offset:1024 sc1
    v_mfma_f32_16x16x32_bf16 v[136:139], a[232:235], v[108:111], v[136:139]
    ds_read_b64_tr_b16 a[78:79], v231 offset:55296
    ds_read_b64_tr_b16 a[64:65], v228 offset:53248
    v_mfma_f32_16x16x32_bf16 v[140:143], a[236:239], v[108:111], v[140:143]
    ds_read_b64_tr_b16 a[66:67], v228 offset:55296
    ds_read_b64_tr_b16 a[84:85], v5 offset:12288
    s_waitcnt vmcnt(7)
    v_mfma_f32_16x16x32_bf16 v[128:131], a[240:243], v[112:115], v[128:131]
    v_max3_u32 v226, v226, v112, v115
    ds_read_b64_tr_b16 a[86:87], v229 offset:0
    v_mfma_f32_16x16x32_bf16 v[132:135], a[244:247], v[112:115], v[132:135]
    buffer_load_dwordx4 v[88:91], v233, s[24:27], s85 offen offset:0 sc1
    buffer_load_dwordx4 v[92:95], v233, s[24:27], s86 offen offset:3072 sc1
    s_waitcnt lgkmcnt(7)
    v_mfma_f32_16x16x32_bf16 v[136:139], a[248:251], v[112:115], v[136:139]
    v_lshlrev_b32 v208, 16, v200
    v_and_b32 v209, s54, v200
    v_mfma_f32_16x16x32_bf16 v[140:143], a[252:255], v[112:115], v[140:143]
    v_lshlrev_b32 v210, 16, v201
    v_and_b32 v211, s54, v201
    buffer_load_dwordx4 v[96:99], v233, s[24:27], s80 offen offset:3072 sc1
    buffer_load_dwordx4 v[32:35], v233, s[24:27], s82 offen offset:2048 sc1
    buffer_load_dwordx4 v[36:39], v233, s[24:27], s84 offen offset:1024 sc1
    buffer_load_dwordx4 v[40:43], v233, s[24:27], s86 offen offset:0 sc1
    ds_read_b64_tr_b16 a[88:89], v14 offset:12288
    ds_read_b64_tr_b16 a[90:91], v230 offset:0
    ds_read_b64_tr_b16 a[92:93], v15 offset:12288
    ds_read_b64_tr_b16 a[94:95], v231 offset:0
    ds_read_b64_tr_b16 a[80:81], v4 offset:12288
    ds_read_b64_tr_b16 a[82:83], v228 offset:0
    ds_read_b64_tr_b16 a[100:101], v5 offset:26624
    ds_read_b64_tr_b16 a[102:103], v229 offset:14336
    ds_read_b64_tr_b16 a[104:105], v14 offset:26624
    ds_read_b64_tr_b16 a[106:107], v230 offset:14336
    ds_read_b64_tr_b16 a[108:109], v15 offset:26624
    ds_read_b64_tr_b16 a[110:111], v231 offset:14336
    ds_read_b64_tr_b16 a[96:97], v4 offset:26624
    ds_read_b64_tr_b16 a[98:99], v228 offset:14336
    ds_read_b64_tr_b16 a[116:117], v5 offset:40960
    ds_read_b64_tr_b16 a[118:119], v229 offset:28672
    ds_read_b64_tr_b16 a[120:121], v14 offset:40960
    ds_read_b64_tr_b16 a[122:123], v230 offset:28672
    ds_read_b64_tr_b16 a[124:125], v15 offset:40960
    ds_read_b64_tr_b16 a[126:127], v231 offset:28672
    ds_read_b64_tr_b16 a[112:113], v4 offset:40960
    ds_read_b64_tr_b16 a[114:115], v228 offset:28672
    ds_read_b64_tr_b16 a[132:133], v5 offset:55296
    ds_read_b64_tr_b16 a[134:135], v229 offset:43008
    ds_read_b64_tr_b16 a[136:137], v14 offset:55296
    ds_read_b64_tr_b16 a[138:139], v230 offset:43008
    ds_read_b64_tr_b16 a[140:141], v15 offset:55296
    ds_read_b64_tr_b16 a[142:143], v231 offset:43008
    ds_read_b64_tr_b16 a[128:129], v4 offset:55296
    ds_read_b64_tr_b16 a[130:131], v228 offset:43008
    s_waitcnt vmcnt(12)
    v_cmp_eq_u32 vcc, -1, v11
    s_nop 0
    s_and_b32 s60, vcc_lo, s59
    s_cbranch_scc0 L_hgoB
L_hreB:
    buffer_load_dword v11, v9, s[24:27], s79 offen sc1
    buffer_load_dwordx4 v[60:63], v233, s[24:27], s80 offen offset:2048 sc1
    buffer_load_dwordx4 v[64:67], v233, s[24:27], s82 offen offset:1024 sc1
    buffer_load_dwordx4 v[68:71], v233, s[24:27], s84 offen offset:0 sc1
    buffer_load_dwordx4 v[116:119], v233, s[24:27], s85 offen offset:3072 sc1
    buffer_load_dwordx4 v[120:123], v233, s[24:27], s81 offen offset:2048 sc1
    buffer_load_dwordx4 v[124:127], v233, s[24:27], s83 offen offset:1024 sc1
    buffer_load_dwordx4 v[88:91], v233, s[24:27], s85 offen offset:0 sc1
    buffer_load_dwordx4 v[92:95], v233, s[24:27], s86 offen offset:3072 sc1
    buffer_load_dwordx4 v[96:99], v233, s[24:27], s80 offen offset:3072 sc1
    buffer_load_dwordx4 v[32:35], v233, s[24:27], s82 offen offset:2048 sc1
    buffer_load_dwordx4 v[36:39], v233, s[24:27], s84 offen offset:1024 sc1
    buffer_load_dwordx4 v[40:43], v233, s[24:27], s86 offen offset:0 sc1
    s_add_u32 s57, s57, 1
    s_waitcnt vmcnt(12)
    v_cmp_eq_u32 vcc, -1, v11
    s_nop 0
    s_and_b32 s60, vcc_lo, s59
    s_cselect_b32 s60, s57, 200000
    s_cmp_lt_u32 s60, 200000
    s_cbranch_scc1 L_hreB
L_hgoB:
    s_waitcnt vmcnt(11)
    v_mfma_f32_16x16x32_bf16 v[128:131], v[144:147], v[60:63], v[128:131]
    v_max3_u32 v226, v226, v60, v63
    v_mfma_f32_16x16x32_bf16 v[132:135], v[148:151], v[60:63], v[132:135]
    v_lshlrev_b32 v212, 16, v202
    v_and_b32 v213, s54, v202
    v_mfma_f32_16x16x32_bf16 v[136:139], v[152:155], v[60:63], v[136:139]
    v_lshlrev_b32 v214, 16, v203
    v_and_b32 v215, s54, v203
    v_mfma_f32_16x16x32_bf16 v[140:143], v[156:159], v[60:63], v[140:143]
    v_lshlrev_b32 v216, 16, v204
    v_and_b32 v217, s54, v204
    s_waitcnt vmcnt(10)
    v_mfma_f32_16x16x32_bf16 v[128:131], v[160:163], v[64:67], v[128:131]
    v_max3_u32 v226, v226, v64, v67
    v_mfma_f32_16x16x32_bf16 v[132:135], v[164:167], v[64:67], v[132:135]
    v_lshlrev_b32 v218, 16, v205
    v_and_b32 v219, s54, v205
    v_mfma_f32_16x16x32_bf16 v[136:139], v[168:171], v[64:67], v[136:139]
    v_lshlrev_b32 v220, 16, v206
    v_and_b32 v221, s54, v206
    v_mfma_f32_16x16x32_bf16 v[140:143], v[172:175], v[64:67], v[140:143]
    v_lshlrev_b32 v222, 16, v207
    v_and_b32 v223, s54, v207
    s_waitcnt vmcnt(9)
    v_mfma_f32_16x16x32_bf16 v[128:131], v[176:179], v[68:71], v[128:131]
    v_max3_u32 v226, v226, v68, v71
    v_mfma_f32_16x16x32_bf16 v[132:135], v[180:183], v[68:71], v[132:135]
    v_mfma_f32_16x16x32_bf16 v[136:139], v[184:187], v[68:71], v[136:139]
    v_mfma_f32_16x16x32_bf16 v[140:143], v[188:191], v[68:71], v[140:143]
    s_waitcnt vmcnt(8)
    v_mfma_f32_16x16x32_bf16 v[128:131], a[0:3], v[116:119], v[128:131]
    v_max3_u32 v226, v226, v116, v119
    v_mfma_f32_16x16x32_bf16 v[132:135], a[4:7], v[116:119], v[132:135]
    v_mfma_f32_16x16x32_bf16 v[136:139], a[8:11], v[116:119], v[136:139]
    v_mfma_f32_16x16x32_bf16 v[140:143], a[12:15], v[116:119], v[140:143]
    s_waitcnt vmcnt(7)
    v_mfma_f32_16x16x32_bf16 v[128:131], a[16:19], v[120:123], v[128:131]
    v_max3_u32 v226, v226, v120, v123
    v_mfma_f32_16x16x32_bf16 v[132:135], a[20:23], v[120:123], v[132:135]
    v_mfma_f32_16x16x32_bf16 v[136:139], a[24:27], v[120:123], v[136:139]
    v_mfma_f32_16x16x32_bf16 v[140:143], a[28:31], v[120:123], v[140:143]
    s_waitcnt vmcnt(6)
    v_mfma_f32_16x16x32_bf16 v[128:131], a[32:35], v[124:127], v[128:131]
    v_max3_u32 v226, v226, v124, v127
    v_mfma_f32_16x16x32_bf16 v[132:135], a[36:39], v[124:127], v[132:135]
    v_mfma_f32_16x16x32_bf16 v[136:139], a[40:43], v[124:127], v[136:139]
    v_mfma_f32_16x16x32_bf16 v[140:143], a[44:47], v[124:127], v[140:143]
    s_waitcnt vmcnt(5)
    v_mfma_f32_16x16x32_bf16 v[128:131], a[48:51], v[88:91], v[128:131]
    v_max3_u32 v226, v226, v88, v91
    v_mfma_f32_16x16x32_bf16 v[132:135], a[52:55], v[88:91], v[132:135]
    v_mfma_f32_16x16x32_bf16 v[136:139], a[56:59], v[88:91], v[136:139]
    v_mfma_f32_16x16x32_bf16 v[140:143], a[60:63], v[88:91], v[140:143]
    s_waitcnt vmcnt(4)
    s_waitcnt lgkmcnt(15)
    v_mfma_f32_16x16x32_bf16 v[128:131], a[64:67], v[92:95], v[128:131]
    v_max3_u32 v226, v226, v92, v95
    v_mfma_f32_16x16x32_bf16 v[132:135], a[68:71], v[92:95], v[132:135]
    v_mfma_f32_16x16x32_bf16 v[136:139], a[72:75], v[92:95], v[136:139]
    v_mfma_f32_16x16x32_bf16 v[140:143], a[76:79], v[92:95], v[140:143]
    s_waitcnt vmcnt(3)
    v_mfma_f32_16x16x32_bf16 v[128:131], a[80:83], v[96:99], v[128:131]
    v_max3_u32 v226, v226, v96, v99
    v_mfma_f32_16x16x32_bf16 v[132:135], a[84:87], v[96:99], v[132:135]
    v_mfma_f32_16x16x32_bf16 v[136:139], a[88:91], v[96:99], v[136:139]
    v_mfma_f32_16x16x32_bf16 v[140:143], a[92:95], v[96:99], v[140:143]
    s_waitcnt vmcnt(2)
    v_mfma_f32_16x16x32_bf16 v[128:131], a[96:99], v[32:35], v[128:131]
    v_max3_u32 v226, v226, v32, v35
    v_mfma_f32_16x16x32_bf16 v[132:135], a[100:103], v[32:35], v[132:135]
    v_mfma_f32_16x16x32_bf16 v[136:139], a[104:107], v[32:35], v[136:139]
    v_mfma_f32_16x16x32_bf16 v[140:143], a[108:111], v[32:35], v[140:143]
    s_waitcnt vmcnt(1)
    s_waitcnt lgkmcnt(8)
    v_mfma_f32_16x16x32_bf16 v[128:131], a[112:115], v[36:39], v[128:131]
    v_max3_u32 v226, v226, v36, v39
    v_mfma_f32_16x16x32_bf16 v[132:135], a[116:119], v[36:39], v[132:135]
    v_mfma_f32_16x16x32_bf16 v[136:139], a[120:123], v[36:39], v[136:139]
    v_mfma_f32_16x16x32_bf16 v[140:143], a[124:127], v[36:39], v[140:143]
    s_waitcnt vmcnt(0)
    s_waitcnt lgkmcnt(0)
    v_mfma_f32_16x16x32_bf16 v[128:131], a[128:131], v[40:43], v[128:131]
    v_max3_u32 v226, v226, v40, v43
    v_mfma_f32_16x16x32_bf16 v[132:135], a[132:135], v[40:43], v[132:135]
    v_mfma_f32_16x16x32_bf16 v[136:139], a[136:139], v[40:43], v[136:139]
    v_mfma_f32_16x16x32_bf16 v[140:143], a[140:143], v[40:43], v[140:143]
    v_cmp_eq_u32 vcc, -1, v226
    s_cbranch_vccnz L_hbad
L_hok:
    s_nop 1
    v_pk_mul_f32 v[80:81], v[128:129], v[224:225] op_sel_hi:[1,0]
    v_exp_f32 v80, v80
    v_exp_f32 v81, v81
    v_pk_mul_f32 v[84:85], v[130:131], v[224:225] op_sel_hi:[1,0]
    v_exp_f32 v84, v84
    v_exp_f32 v85, v85
    v_pk_add_f32 v[80:81], v[80:81], 1.0 op_sel_hi:[1,0]
    v_pk_mul_f32 v[128:129], v[128:129], v[208:209]
    v_rcp_f32 v80, v80
    v_rcp_f32 v81, v81
    v_pk_add_f32 v[84:85], v[84:85], 1.0 op_sel_hi:[1,0]
    v_pk_mul_f32 v[130:131], v[130:131], v[210:211]
    v_rcp_f32 v84, v84
    v_rcp_f32 v85, v85
    v_pk_fma_f32 v[128:129], v[128:129], v[80:81], v[240:241]
    v_cvt_pk_bf16_f32 v96, v128, v129
    v_pk_fma_f32 v[130:131], v[130:131], v[84:85], v[242:243]
    v_cvt_pk_bf16_f32 v97, v130, v131
    v_pk_mul_f32 v[80:81], v[132:133], v[224:225] op_sel_hi:[1,0]
    v_exp_f32 v80, v80
    v_exp_f32 v81, v81
    v_pk_mul_f32 v[84:85], v[134:135], v[224:225] op_sel_hi:[1,0]
    v_exp_f32 v84, v84
    v_exp_f32 v85, v85
    v_pk_add_f32 v[80:81], v[80:81], 1.0 op_sel_hi:[1,0]
    v_pk_mul_f32 v[132:133], v[132:133], v[212:213]
    v_rcp_f32 v80, v80
    v_rcp_f32 v81, v81
    v_pk_add_f32 v[84:85], v[84:85], 1.0 op_sel_hi:[1,0]
    v_pk_mul_f32 v[134:135], v[134:135], v[214:215]
    v_rcp_f32 v84, v84
    v_rcp_f32 v85, v85
    v_pk_fma_f32 v[132:133], v[132:133], v[80:81], v[244:245]
    v_cvt_pk_bf16_f32 v98, v132, v133
    v_pk_fma_f32 v[134:135], v[134:135], v[84:85], v[246:247]
    v_cvt_pk_bf16_f32 v99, v134, v135
    v_permlane16_swap_b32 v96, v98
    s_nop 0
    v_permlane16_swap_b32 v97, v99
    buffer_store_dwordx4 v[96:99], v6, s[28:31], s76 offen offset:0 sc1
    v_pk_mul_f32 v[80:81], v[136:137], v[224:225] op_sel_hi:[1,0]
    v_exp_f32 v80, v80
    v_exp_f32 v81, v81
    v_pk_mul_f32 v[84:85], v[138:139], v[224:225] op_sel_hi:[1,0]
    v_exp_f32 v84, v84
    v_exp_f32 v85, v85
    v_pk_add_f32 v[80:81], v[80:81], 1.0 op_sel_hi:[1,0]
    v_pk_mul_f32 v[136:137], v[136:137], v[216:217]
    v_rcp_f32 v80, v80
    v_rcp_f32 v81, v81
    v_pk_add_f32 v[84:85], v[84:85], 1.0 op_sel_hi:[1,0]
    v_pk_mul_f32 v[138:139], v[138:139], v[218:219]
    v_rcp_f32 v84, v84
    v_rcp_f32 v85, v85
    v_pk_fma_f32 v[136:137], v[136:137], v[80:81], v[248:249]
    v_cvt_pk_bf16_f32 v100, v136, v137
    v_pk_fma_f32 v[138:139], v[138:139], v[84:85], v[250:251]
    v_cvt_pk_bf16_f32 v101, v138, v139
    v_pk_mul_f32 v[80:81], v[140:141], v[224:225] op_sel_hi:[1,0]
    v_exp_f32 v80, v80
    v_exp_f32 v81, v81
    v_pk_mul_f32 v[84:85], v[142:143], v[224:225] op_sel_hi:[1,0]
    v_exp_f32 v84, v84
    v_exp_f32 v85, v85
    v_pk_add_f32 v[80:81], v[80:81], 1.0 op_sel_hi:[1,0]
    v_pk_mul_f32 v[140:141], v[140:141], v[220:221]
    v_rcp_f32 v80, v80
    v_rcp_f32 v81, v81
    v_pk_add_f32 v[84:85], v[84:85], 1.0 op_sel_hi:[1,0]
    v_pk_mul_f32 v[142:143], v[142:143], v[222:223]
    v_rcp_f32 v84, v84
    v_rcp_f32 v85, v85
    v_pk_fma_f32 v[140:141], v[140:141], v[80:81], v[252:253]
    v_cvt_pk_bf16_f32 v102, v140, v141
    v_pk_fma_f32 v[142:143], v[142:143], v[84:85], v[254:255]
    v_cvt_pk_bf16_f32 v103, v142, v143
    v_permlane16_swap_b32 v100, v102
    s_nop 0
    v_permlane16_swap_b32 v101, v103
    buffer_store_dwordx4 v[100:103], v6, s[28:31], s76 offen offset:64 sc1
L_done:
    s_endpgm
L_hbad:
    s_add_u32 s57, s57, 200
    s_cmp_ge_u32 s57, 200000
    s_cbranch_scc1 L_hok
    s_waitcnt vmcnt(0) lgkmcnt(0)
    s_nop 15
    ds_read_b64_tr_b16 a[4:5], v5 offset:0
    ds_read_b64_tr_b16 a[6:7], v5 offset:2048
    ds_read_b64_tr_b16 a[8:9], v14 offset:0
    ds_read_b64_tr_b16 a[10:11], v14 offset:2048
    ds_read_b64_tr_b16 a[12:13], v15 offset:0
    ds_read_b64_tr_b16 a[14:15], v15 offset:2048
    ds_read_b64_tr_b16 a[0:1], v4 offset:0
    ds_read_b64_tr_b16 a[2:3], v4 offset:2048
    ds_read_b64_tr_b16 a[20:21], v5 offset:14336
    ds_read_b64_tr_b16 a[22:23], v5 offset:16384
    ds_read_b64_tr_b16 a[24:25], v14 offset:14336
    ds_read_b64_tr_b16 a[26:27], v14 offset:16384
    ds_read_b64_tr_b16 a[28:29], v15 offset:14336
    ds_read_b64_tr_b16 a[30:31], v15 offset:16384
    ds_read_b64_tr_b16 a[16:17], v4 offset:14336
    ds_read_b64_tr_b16 a[18:19], v4 offset:16384
    ds_read_b64_tr_b16 a[36:37], v5 offset:28672
    ds_read_b64_tr_b16 a[38:39], v5 offset:30720
    ds_read_b64_tr_b16 a[40:41], v14 offset:28672
    ds_read_b64_tr_b16 a[42:43], v14 offset:30720
    ds_read_b64_tr_b16 a[44:45], v15 offset:28672
    ds_read_b64_tr_b16 a[46:47], v15 offset:30720
    ds_read_b64_tr_b16 a[32:33], v4 offset:28672
    ds_read_b64_tr_b16 a[34:35], v4 offset:30720
    ds_read_b64_tr_b16 a[52:53], v5 offset:43008
    ds_read_b64_tr_b16 a[54:55], v5 offset:45056
    ds_read_b64_tr_b16 a[56:57], v14 offset:43008
    ds_read_b64_tr_b16 a[58:59], v14 offset:45056
    ds_read_b64_tr_b16 a[60:61], v15 offset:43008
    ds_read_b64_tr_b16 a[62:63], v15 offset:45056
    ds_read_b64_tr_b16 a[48:49], v4 offset:43008
    ds_read_b64_tr_b16 a[50:51], v4 offset:45056
    ds_read_b64_tr_b16 a[68:69], v5 offset:4096
    ds_read_b64_tr_b16 a[70:71], v5 offset:6144
    ds_read_b64_tr_b16 a[72:73], v14 offset:4096
    ds_read_b64_tr_b16 a[74:75], v14 offset:6144
    ds_read_b64_tr_b16 a[76:77], v15 offset:4096
    ds_read_b64_tr_b16 a[78:79], v15 offset:6144
    ds_read_b64_tr_b16 a[64:65], v4 offset:4096
    ds_read_b64_tr_b16 a[66:67], v4 offset:6144
    ds_read_b64_tr_b16 a[84:85], v5 offset:18432
    ds_read_b64_tr_b16 a[86:87], v5 offset:20480
    ds_read_b64_tr_b16 a[88:89], v14 offset:18432
    ds_read_b64_tr_b16 a[90:91], v14 offset:20480
    ds_read_b64_tr_b16 a[92:93], v15 offset:18432
    ds_read_b64_tr_b16 a[94:95], v15 offset:20480
    ds_read_b64_tr_b16 a[80:81], v4 offset:18432
    ds_read_b64_tr_b16 a[82:83], v4 offset:20480
    ds_read_b64_tr_b16 a[100:101], v5 offset:32768
    ds_read_b64_tr_b16 a[102:103], v5 offset:34816
    ds_read_b64_tr_b16 a[104:105], v14 offset:32768
    ds_read_b64_tr_b16 a[106:107], v14 offset:34816
    ds_read_b64_tr_b16 a[108:109], v15 offset:32768
    ds_read_b64_tr_b16 a[110:111], v15 offset:34816
    ds_read_b64_tr_b16 a[96:97], v4 offset:32768
    ds_read_b64_tr_b16 a[98:99], v4 offset:34816
    ds_read_b64_tr_b16 a[116:117], v5 offset:47104
    ds_read_b64_tr_b16 a[118:119], v5 offset:49152
    ds_read_b64_tr_b16 a[120:121], v14 offset:47104
    ds_read_b64_tr_b16 a[122:123], v14 offset:49152
    ds_read_b64_tr_b16 a[124:125], v15 offset:47104
    ds_read_b64_tr_b16 a[126:127], v15 offset:49152
    ds_read_b64_tr_b16 a[112:113], v4 offset:47104
    ds_read_b64_tr_b16 a[114:115], v4 offset:49152
    ds_read_b64_tr_b16 a[132:133], v229 offset:2048
    ds_read_b64_tr_b16 a[134:135], v229 offset:4096
    ds_read_b64_tr_b16 a[136:137], v230 offset:2048
    ds_read_b64_tr_b16 a[138:139], v230 offset:4096
    ds_read_b64_tr_b16 a[140:141], v231 offset:2048
    ds_read_b64_tr_b16 a[142:143], v231 offset:4096
    ds_read_b64_tr_b16 a[128:129], v228 offset:2048
    ds_read_b64_tr_b16 a[130:131], v228 offset:4096
    ds_read_b64_tr_b16 a[148:149], v229 offset:16384
    ds_read_b64_tr_b16 a[150:151], v229 offset:18432
    ds_read_b64_tr_b16 a[152:153], v230 offset:16384
    ds_read_b64_tr_b16 a[154:155], v230 offset:18432
    ds_read_b64_tr_b16 a[156:157], v231 offset:16384
    ds_read_b64_tr_b16 a[158:159], v231 offset:18432
    ds_read_b64_tr_b16 a[144:145], v228 offset:16384
    ds_read_b64_tr_b16 a[146:147], v228 offset:18432
    ds_read_b64_tr_b16 a[164:165], v229 offset:30720
    ds_read_b64_tr_b16 a[166:167], v229 offset:32768
    ds_read_b64_tr_b16 a[168:169], v230 offset:30720
    ds_read_b64_tr_b16 a[170:171], v230 offset:32768
    ds_read_b64_tr_b16 a[172:173], v231 offset:30720
    ds_read_b64_tr_b16 a[174:175], v231 offset:32768
    ds_read_b64_tr_b16 a[160:161], v228 offset:30720
    ds_read_b64_tr_b16 a[162:163], v228 offset:32768
    ds_read_b64_tr_b16 a[180:181], v229 offset:45056
    ds_read_b64_tr_b16 a[182:183], v229 offset:47104
    ds_read_b64_tr_b16 a[184:185], v230 offset:45056
    ds_read_b64_tr_b16 a[186:187], v230 offset:47104
    ds_read_b64_tr_b16 a[188:189], v231 offset:45056
    ds_read_b64_tr_b16 a[190:191], v231 offset:47104
    ds_read_b64_tr_b16 a[176:177], v228 offset:45056
    ds_read_b64_tr_b16 a[178:179], v228 offset:47104
    ds_read_b64_tr_b16 a[196:197], v229 offset:6144
    ds_read_b64_tr_b16 a[198:199], v229 offset:8192
    ds_read_b64_tr_b16 a[200:201], v230 offset:6144
    ds_read_b64_tr_b16 a[202:203], v230 offset:8192
    ds_read_b64_tr_b16 a[204:205], v231 offset:6144
    ds_read_b64_tr_b16 a[206:207], v231 offset:8192
    ds_read_b64_tr_b16 a[192:193], v228 offset:6144
    s_waitcnt lgkmcnt(0)
    s_branch L_hreA
L_poll_4_s:
    s_mov_b32 s56, 0
L_poll_4:
    buffer_load_dword v207, v206, s[32:35], 0 offen sc1
    s_add_u32 s56, s56, 1
    s_waitcnt vmcnt(0)
    v_cmp_eq_u32 vcc, 0, v207
    s_cbranch_vccz L_poll_4_ok
    s_sleep 8
    s_cmp_lt_u32 s56, 200000
    s_cbranch_scc1 L_poll_4
    s_branch L_poll_4_ok
L_st_7_s:
    s_mov_b32 s56, 0
L_st_7:
    buffer_load_dwordx4 v[234:237], v209, s[24:27], s64 offen sc1
    buffer_load_dwordx4 v[8:11], v209, s[24:27], s64 offen offset:16 sc1
    s_add_u32 s56, s56, 1
    s_waitcnt vmcnt(0)
    v_xor_b32 v236, v236, v234
    v_xor_b32 v10, v10, v8
    v_xor_b32 v236, v236, v235
    v_xor_b32 v10, v10, v9
    v_cmp_ne_u64 vcc, s[40:41], v[236:237]
    v_cmp_ne_u64 s[58:59], s[40:41], v[10:11]
    s_nop 0
    s_or_b64 vcc, vcc, s[58:59]
    s_cbranch_scc0 L_st_7_ok
    s_cmp_lt_u32 s56, 200000
    s_cbranch_scc1 L_st_7
    s_branch L_st_7_ok
L_poll_8_s:
    s_mov_b32 s92, 0
L_poll_8:
    buffer_load_dword v198, v197, s[24:27], 0 offen sc1
    s_add_u32 s92, s92, 1
    s_waitcnt vmcnt(0)
    v_cmp_ne_u32 vcc, s100, v198
    s_cbranch_vccz L_poll_8_ok
    s_sleep 1
    s_cmp_lt_u32 s92, 200000
    s_cbranch_scc1 L_poll_8
    s_branch L_poll_8_ok
L_zc_9_s:
    s_mov_b32 s92, 0
L_zc_9:
    buffer_load_dword v227, v238, s[24:27], s68 offen sc1
    s_add_u32 s92, s92, 1
    s_waitcnt vmcnt(0)
    v_cmp_ne_u32 s[36:37], s100, v227
    s_nop 0
    s_and_b32 s37, s36, 0xf
    s_cbranch_scc0 L_zc_9_ok
    s_sleep 1
    s_cmp_lt_u32 s92, 200000
    s_cbranch_scc1 L_zc_9
    s_branch L_zc_9_ok
L_zc_10_s:
    s_waitcnt vmcnt(5)
    v_cmp_ne_u32 s[36:37], s100, v227
    s_nop 0
    s_and_b32 s37, s36, 0xff
    s_cbranch_scc0 L_zc_10_ok
    s_mov_b32 s92, 0
L_zc_10:
    buffer_load_dword v227, v238, s[24:27], s68 offen sc1
    s_add_u32 s92, s92, 1
    s_waitcnt vmcnt(0)
    v_cmp_ne_u32 s[36:37], s100, v227
    s_nop 0
    s_and_b32 s37, s36, 0xff
    s_cbranch_scc0 L_zc_10_ok
    s_sleep 1
    s_cmp_lt_u32 s92, 200000
    s_cbranch_scc1 L_zc_10
    s_branch L_zc_10_ok
L_zc_11_s:
    s_waitcnt vmcnt(9)
    v_cmp_ne_u32 s[36:37], s100, v227
    s_nop 0
    s_and_b32 s37, s36, 0xfff
    s_cbranch_scc0 L_zc_11_ok
    s_mov_b32 s92, 0
L_zc_11:
    buffer_load_dword v227, v238, s[24:27], s68 offen sc1
    s_add_u32 s92, s92, 1
    s_waitcnt vmcnt(0)
    v_cmp_ne_u32 s[36:37], s100, v227
    s_nop 0
    s_and_b32 s37, s36, 0xfff
    s_cbranch_scc0 L_zc_11_ok
    s_sleep 1
    s_cmp_lt_u32 s92, 200000
    s_cbranch_scc1 L_zc_11
    s_branch L_zc_11_ok
L_zc_12_s:
    s_waitcnt vmcnt(11)
    v_cmp_ne_u32 s[36:37], s100, v227
    s_nop 0
    s_and_b32 s37, s36, 0xffff
    s_cbranch_scc0 L_zc_12_ok
    s_mov_b32 s92, 0
L_zc_12:
    buffer_load_dword v227, v238, s[24:27], s68 offen sc1
    s_add_u32 s92, s92, 1
    s_waitcnt vmcnt(0)
    v_cmp_ne_u32 s[36:37], s100, v227
    s_nop 0
    s_and_b32 s37, s36, 0xffff
    s_cbranch_scc0 L_zc_12_ok
    s_sleep 1
    s_cmp_lt_u32 s92, 200000
    s_cbranch_scc1 L_zc_12
    s_branch L_zc_12_ok
L_zc_13_s:
    s_mov_b32 s92, 0
L_zc_13:
    buffer_load_dword v227, v238, s[24:27], s68 offen sc1
    s_add_u32 s92, s92, 1
    s_waitcnt vmcnt(0)
    v_cmp_ne_u32 s[36:37], s100, v227
    s_nop 0
    s_and_b32 s37, s36, 0xfffff
    s_cbranch_scc0 L_zc_13_ok
    s_sleep 1
    s_cmp_lt_u32 s92, 200000
    s_cbranch_scc1 L_zc_13
    s_branch L_zc_13_ok
L_zc_14_s:
    s_mov_b32 s92, 0
L_zc_14:
    buffer_load_dword v227, v238, s[24:27], s68 offen sc1
    s_add_u32 s92, s92, 1
    s_waitcnt vmcnt(0)
    v_cmp_ne_u32 s[36:37], s100, v227
    s_nop 0
    s_and_b32 s37, s36, 0xffffff
    s_cbranch_scc0 L_zc_14_ok
    s_sleep 1
    s_cmp_lt_u32 s92, 200000
    s_cbranch_scc1 L_zc_14
    s_branch L_zc_14_ok
L_zc_15_s:
    s_mov_b32 s92, 0
L_zc_15:
    buffer_load_dword v227, v238, s[24:27], s68 offen sc1
    s_add_u32 s92, s92, 1
    s_waitcnt vmcnt(0)
    v_cmp_ne_u32 s[36:37], s100, v227
    s_nop 0
    s_and_b32 s37, s36, 0xfffffff
    s_cbranch_scc0 L_zc_15_ok
    s_sleep 1
    s_cmp_lt_u32 s92, 200000
    s_cbranch_scc1 L_zc_15
    s_branch L_zc_15_ok
L_zc_16_s:
    s_mov_b32 s92, 0
L_zc_16:
    buffer_load_dword v227, v238, s[24:27], s68 offen sc1
    s_add_u32 s92, s92, 1
    s_waitcnt vmcnt(0)
    v_cmp_ne_u32 s[36:37], s100, v227
    s_nop 0
    s_and_b32 s37, s36, -1
    s_cbranch_scc0 L_zc_16_ok
    s_sleep 1
    s_cmp_lt_u32 s92, 200000
    s_cbranch_scc1 L_zc_16
    s_branch L_zc_16_ok
L_poll_17_s:
    s_mov_b32 s56, 0
L_poll_17:
    buffer_load_dword v11, v12, s[24:27], s93 offen sc1
    s_add_u32 s56, s56, 1
    s_waitcnt vmcnt(0)
    v_cmp_ne_u32 vcc, s100, v11
    s_cbranch_vccz L_poll_17_ok
    s_sleep 1
    s_cmp_lt_u32 s56, 200000
    s_cbranch_scc1 L_poll_17
    s_branch L_poll_17_ok
L_poll_18_s:
    s_mov_b32 s56, 0
L_poll_18:
    buffer_load_dword v10, v7, s[24:27], s77 offen sc1
    s_add_u32 s56, s56, 1
    s_waitcnt vmcnt(0)
    v_cmp_ne_u32 vcc, s100, v10
    s_cbranch_vccz L_poll_18_ok
    s_sleep 1
    s_cmp_lt_u32 s56, 200000
    s_cbranch_scc1 L_poll_18
    s_branch L_poll_18_ok
L_sv_s:
    s_mov_b32 s56, 0
L_sv:
    buffer_load_dwordx4 v[208:211], v8, s[24:27], s78 offen sc1
    buffer_load_dwordx4 v[212:215], v8, s[24:27], s89 offen sc1
    s_add_u32 s56, s56, 1
    s_waitcnt vmcnt(0)
    v_max3_u32 v200, v208, v211, v212
    v_max_u32 v200, v200, v215
    v_cmp_eq_u32 vcc, -1, v200
    s_cbranch_vccz L_sv_ok
    s_cmp_lt_u32 s56, 200000
    s_cbranch_scc1 L_sv
    s_branch L_sv_ok
L_exit:
    s_endpgm
.section .rodata,"a"
.p2align 6
.amdhsa_kernel recurrent_scan__ssm_conv_s4d__mixer_gmlp__prompt_kernel
  .amdhsa_next_free_vgpr 512
  .amdhsa_next_free_sgpr 102
  .amdhsa_accum_offset 256
  .amdhsa_group_segment_fixed_size 0
  .amdhsa_kernarg_size 120
  .amdhsa_user_sgpr_count 2
  .amdhsa_user_sgpr_kernarg_segment_ptr 1
  .amdhsa_system_sgpr_workgroup_id_x 1
  .amdhsa_float_denorm_mode_32 3
.end_amdhsa_kernel
```
